```python
import torch

def _softmax(x, axis=-1):
    return torch.softmax(x, dim=axis)
def _gelu(x):
    return torch.nn.functional.gelu(x, approximate="tanh")
def _silu(x):
    return torch.nn.functional.silu(x)
def _sigmoid(x):
    return torch.sigmoid(x)
def _layernorm(x, axis=-1, eps=1e-5):
    m = x.mean(dim=axis, keepdim=True)
    v = x.var(dim=axis, keepdim=True, unbiased=False)
    return (x - m) / torch.sqrt(v + eps)
def _scatter_add(tgt, idx, src, axis=0):
    return tgt.clone().index_add_(axis, idx, src)
def _segment_sum(src, seg, n):
    out = torch.zeros((n,) + src.shape[1:], dtype=src.dtype)
    return out.index_add_(0, seg, src)
def _pad(x, pw):
    flat = tuple(v for pair in reversed(pw) for v in pair)
    return torch.nn.functional.pad(x, flat)

kernel_name = 'gated_mix__grouped_kv_mqa__mixer_channel_mlp__prompt'

def setup_inputs():

    _w = (lambda a: (lambda t: t.to(torch.bfloat16) if t.is_floating_point() else t)(torch.as_tensor(a)))
    def _A_setup():
        B, S, D, H = 1, 2048, 576, 32
        Dh = D // H
        return {
            "x": _w((lambda *s: torch.randn(*s, dtype=torch.bfloat16) * 0.05)(B, S, D)),
            "wq": _w((lambda *s: torch.randn(*s, dtype=torch.bfloat16) * 0.8)(D, H * Dh)),
            "wk": _w((lambda *s: torch.randn(*s, dtype=torch.bfloat16) * 0.8)(D, Dh)),
            "wv": _w((lambda *s: torch.randn(*s, dtype=torch.bfloat16) * 0.2)(D, Dh)),
            "wo": _w((lambda *s: torch.randn(*s, dtype=torch.bfloat16) * 0.2)(H * Dh, D)),
        }
    _A_in = _A_setup()

    def _B_setup():
        B, S, D, F = 1, 2048, 576, 4608
        return {
            "x": _w((lambda *s: torch.randn(*s, dtype=torch.bfloat16) * 0.05)(B, S, D)),
            "w1": _w((lambda *s: torch.randn(*s, dtype=torch.bfloat16) * 0.8)(D, F) * (D ** -0.5)),
            "b1": _w((lambda *s: torch.randn(*s, dtype=torch.bfloat16) * 0.8)(F)),
            "w2": _w((lambda *s: torch.randn(*s, dtype=torch.bfloat16) * 0.05)(F, D) * (F ** -0.5)),
            "b2": _w((lambda *s: torch.randn(*s, dtype=torch.bfloat16) * 0.05)(D)),
        }
    _B_in = _B_setup()

    return {
        "A_x": _A_in["x"],
        "A_wq": _A_in["wq"],
        "A_wk": _A_in["wk"],
        "A_wv": _A_in["wv"],
        "A_wo": _A_in["wo"],
        "B_x": _B_in["x"],
        "B_w1": _B_in["w1"],
        "B_b1": _B_in["b1"],
        "B_w2": _B_in["w2"],
        "B_b2": _B_in["b2"],
        "gate_w": _w((lambda *s: torch.randn(*s, dtype=torch.bfloat16) * 0.05)(576) * 16.0),
    }

def reference(A_x, A_wq, A_wk, A_wv, A_wo, B_x, B_w1, B_b1, B_w2, B_b2, gate_w):
    def _A_ref(x, wq, wk, wv, wo):
        B, S, D = x.shape
        H = 32
        Dh = D // H
        q = (lambda x, *d: x.permute(*d))((x @ wq).reshape(B, S, H, Dh), 0, 2, 1, 3)
        k = x @ wk
        v = x @ wv
        scores = torch.einsum("bhqd,bkd->bhqk", q, k) * (Dh ** -0.5)
        p = _softmax(scores, axis=-1)
        o = torch.einsum("bhqk,bkd->bhqd", p, v)
        return (lambda x, *d: x.permute(*d))(o, 0, 2, 1, 3).reshape(B, S, H * Dh) @ wo

    def _B_ref(x, w1, b1, w2, b2):
        y = _layernorm(x, axis=-1)
        h = _gelu(torch.einsum("bsd,df->bsf", y, w1) + b1)
        return torch.einsum("bsf,fd->bsd", h, w2) + b2

    x = A_x
    g = _sigmoid((x * gate_w).sum(-1, keepdims=True))
    a = _A_ref(x, A_wq, A_wk, A_wv, A_wo)
    b = _B_ref(x, B_w1, B_b1, B_w2, B_b2)
    return g * a + (1 - g) * b
```

```asm
; @launch grid=(256,1,1) block=(512,1,1) lds=163120
.amdgcn_target "amdgcn-amd-amdhsa--gfx950"
.text
.globl gated_mix__grouped_kv_mqa__mixer_channel_mlp__prompt_kernel
.p2align 8
.type gated_mix__grouped_kv_mqa__mixer_channel_mlp__prompt_kernel,@function
gated_mix__grouped_kv_mqa__mixer_channel_mlp__prompt_kernel:
  s_cmp_ge_u32 s2, 256
  s_cbranch_scc1 K_END

  s_and_b32 s29, s2, 3
  s_lshl_b32 s29, s29, 1
  s_bfe_u32 s35, s2, 0x10003
  s_or_b32 s29, s29, s35
  s_bfe_u32 s28, s2, 0x10002
  s_lshl_b32 s28, s28, 4
  s_lshr_b32 s35, s2, 4
  s_or_b32 s28, s28, s35

  s_lshl_b32 s3, s28, 3
  s_or_b32 s3, s3, s29
  v_lshrrev_b32 v2, 6, v0
  v_and_b32 v1, 63, v0
  s_nop 0
  v_readfirstlane_b32 s30, v2

  s_load_dwordx4 s[48:51], s[0:1], 0
  s_load_dwordx4 s[52:55], s[0:1], 16
  s_load_dwordx2 s[56:57], s[0:1], 80
  s_load_dwordx4 s[60:63], s[0:1], 96
  s_load_dwordx2 s[58:59], s[0:1], 48

  s_cmp_ge_u32 s30, 4
  s_cbranch_scc1 K_ATT
  s_mov_b32 s40, 59652324
  v_add_u32 v26, 0, v1
  v_mul_hi_u32 v27, v26, s40
  v_mul_u32_u24 v3, 72, v27
  v_sub_u32 v26, v26, v3
  v_lshrrev_b32 v28, 1, v27
  v_xor_b32 v28, v28, v26
  v_bfi_b32 v28, 7, v28, v26
  v_mul_u32_u24 v27, 1152, v27
  v_lshl_add_u32 v4, v28, 4, v27
  v_xor_b32 v28, 4, v28
  v_lshl_add_u32 v30, v28, 4, v27

  v_add_u32 v26, 64, v1
  v_mul_hi_u32 v27, v26, s40
  v_mul_u32_u24 v3, 72, v27
  v_sub_u32 v26, v26, v3
  v_lshrrev_b32 v28, 1, v27
  v_xor_b32 v28, v28, v26
  v_bfi_b32 v28, 7, v28, v26
  v_mul_u32_u24 v27, 1152, v27
  v_lshl_add_u32 v5, v28, 4, v27
  v_xor_b32 v28, 4, v28
  v_lshl_add_u32 v31, v28, 4, v27

  v_add_u32 v26, 128, v1
  v_mul_hi_u32 v27, v26, s40
  v_mul_u32_u24 v3, 72, v27
  v_sub_u32 v26, v26, v3
  v_lshrrev_b32 v28, 1, v27
  v_xor_b32 v28, v28, v26
  v_bfi_b32 v28, 7, v28, v26
  v_mul_u32_u24 v27, 1152, v27
  v_lshl_add_u32 v6, v28, 4, v27
  v_xor_b32 v28, 4, v28
  v_lshl_add_u32 v32, v28, 4, v27

  v_add_u32 v26, 192, v1
  v_mul_hi_u32 v27, v26, s40
  v_mul_u32_u24 v3, 72, v27
  v_sub_u32 v26, v26, v3
  v_lshrrev_b32 v28, 1, v27
  v_xor_b32 v28, v28, v26
  v_bfi_b32 v28, 7, v28, v26
  v_mul_u32_u24 v27, 1152, v27
  v_lshl_add_u32 v7, v28, 4, v27
  v_xor_b32 v28, 4, v28
  v_lshl_add_u32 v33, v28, 4, v27

  v_add_u32 v26, 256, v1
  v_mul_hi_u32 v27, v26, s40
  v_mul_u32_u24 v3, 72, v27
  v_sub_u32 v26, v26, v3
  v_lshrrev_b32 v28, 1, v27
  v_xor_b32 v28, v28, v26
  v_bfi_b32 v28, 7, v28, v26
  v_mul_u32_u24 v27, 1152, v27
  v_lshl_add_u32 v8, v28, 4, v27
  v_xor_b32 v28, 4, v28
  v_lshl_add_u32 v34, v28, 4, v27

  v_add_u32 v26, 320, v1
  v_mul_hi_u32 v27, v26, s40
  v_mul_u32_u24 v3, 72, v27
  v_sub_u32 v26, v26, v3
  v_lshrrev_b32 v28, 1, v27
  v_xor_b32 v28, v28, v26
  v_bfi_b32 v28, 7, v28, v26
  v_mul_u32_u24 v27, 1152, v27
  v_lshl_add_u32 v9, v28, 4, v27
  v_xor_b32 v28, 4, v28
  v_lshl_add_u32 v35, v28, 4, v27

  v_add_u32 v26, 384, v1
  v_mul_hi_u32 v27, v26, s40
  v_mul_u32_u24 v3, 72, v27
  v_sub_u32 v26, v26, v3
  v_lshrrev_b32 v28, 1, v27
  v_xor_b32 v28, v28, v26
  v_bfi_b32 v28, 7, v28, v26
  v_mul_u32_u24 v27, 1152, v27
  v_lshl_add_u32 v10, v28, 4, v27
  v_xor_b32 v28, 4, v28
  v_lshl_add_u32 v36, v28, 4, v27

  v_add_u32 v26, 448, v1
  v_mul_hi_u32 v27, v26, s40
  v_mul_u32_u24 v3, 72, v27
  v_sub_u32 v26, v26, v3
  v_lshrrev_b32 v28, 1, v27
  v_xor_b32 v28, v28, v26
  v_bfi_b32 v28, 7, v28, v26
  v_mul_u32_u24 v27, 1152, v27
  v_lshl_add_u32 v11, v28, 4, v27
  v_xor_b32 v28, 4, v28
  v_lshl_add_u32 v37, v28, 4, v27

  v_add_u32 v26, 512, v1
  v_mul_hi_u32 v27, v26, s40
  v_mul_u32_u24 v3, 72, v27
  v_sub_u32 v26, v26, v3
  v_lshrrev_b32 v28, 1, v27
  v_xor_b32 v28, v28, v26
  v_bfi_b32 v28, 7, v28, v26
  v_mul_u32_u24 v27, 1152, v27
  v_lshl_add_u32 v12, v28, 4, v27
  v_xor_b32 v28, 4, v28
  v_lshl_add_u32 v38, v28, 4, v27

  s_mul_i32 s45, s28, 73728
  s_mul_i32 s46, s30, 18432
  s_add_u32 s45, s45, s46
  s_waitcnt lgkmcnt(0)
  s_add_u32 s42, s48, s45
  s_addc_u32 s43, s49, 0

  s_mov_b32 s24, s42
  s_and_b32 s25, s43, 0xffff
  s_mov_b32 s26, 18432
  s_mov_b32 s27, 0x00020000

  s_mov_b32 s44, 9216
  s_add_u32 m0, s46, 0
  s_nop 0
  buffer_load_dwordx4 v4, s[24:27], 0 offen lds

  s_add_u32 m0, s46, 1024
  s_nop 0
  buffer_load_dwordx4 v5, s[24:27], 0 offen lds

  s_add_u32 m0, s46, 2048
  s_nop 0
  buffer_load_dwordx4 v6, s[24:27], 0 offen lds

  s_add_u32 m0, s46, 3072
  s_nop 0
  buffer_load_dwordx4 v7, s[24:27], 0 offen lds

  s_add_u32 m0, s46, 4096
  s_nop 0
  buffer_load_dwordx4 v8, s[24:27], 0 offen lds

  s_add_u32 m0, s46, 5120
  s_nop 0
  buffer_load_dwordx4 v9, s[24:27], 0 offen lds

  s_add_u32 m0, s46, 6144
  s_nop 0
  buffer_load_dwordx4 v10, s[24:27], 0 offen lds

  s_add_u32 m0, s46, 7168
  s_nop 0
  buffer_load_dwordx4 v11, s[24:27], 0 offen lds

  s_add_u32 m0, s46, 8192
  s_nop 0
  buffer_load_dwordx4 v12, s[24:27], 0 offen lds

  s_add_u32 m0, s46, 9216
  s_nop 0
  buffer_load_dwordx4 v30, s[24:27], s44 offen lds

  s_add_u32 m0, s46, 10240
  s_nop 0
  buffer_load_dwordx4 v31, s[24:27], s44 offen lds

  s_add_u32 m0, s46, 11264
  s_nop 0
  buffer_load_dwordx4 v32, s[24:27], s44 offen lds

  s_add_u32 m0, s46, 12288
  s_nop 0
  buffer_load_dwordx4 v33, s[24:27], s44 offen lds

  s_add_u32 m0, s46, 13312
  s_nop 0
  buffer_load_dwordx4 v34, s[24:27], s44 offen lds

  s_add_u32 m0, s46, 14336
  s_nop 0
  buffer_load_dwordx4 v35, s[24:27], s44 offen lds

  s_add_u32 m0, s46, 15360
  s_nop 0
  buffer_load_dwordx4 v36, s[24:27], s44 offen lds

  s_add_u32 m0, s46, 16384
  s_nop 0
  buffer_load_dwordx4 v37, s[24:27], s44 offen lds

  s_add_u32 m0, s46, 17408
  s_nop 0
  buffer_load_dwordx4 v38, s[24:27], s44 offen lds

  s_cmp_lg_u32 s30, 3
  s_cbranch_scc1 E_NOGW
  v_lshlrev_b32 v3, 4, v1
  s_mov_b32 m0, 161200
  s_nop 0
  global_load_lds_dwordx4 v3, s[56:57]
  s_mov_b64 exec, 0xff
  global_load_lds_dwordx4 v3, s[56:57] offset:1024
  s_mov_b64 exec, -1
  v_mov_b32 v4, 0x3f803f80
  v_mov_b32 v5, 0x3f803f80
  v_mov_b32 v6, 0x3f803f80
  v_mov_b32 v7, 0x3f803f80
  v_add_u32 v3, 73728, v3
  ds_write_b128 v3, v[4:7]
  s_mov_b64 exec, 0xff
  ds_write_b128 v3, v[4:7] offset:1024
  s_mov_b64 exec, -1

E_NOGW:
  v_mov_b32 v3, 161088
  v_mov_b32 v20, 0
  v_mov_b32 v21, 0
  v_mov_b32 v22, 0
  v_mov_b32 v23, 0
  ds_write_b128 v3, v[20:23]
  ds_write_b128 v3, v[20:23] offset:16
  ds_write_b128 v3, v[20:23] offset:32
  ds_write_b128 v3, v[20:23] offset:48
  ds_write_b128 v3, v[20:23] offset:64
  ds_write_b128 v3, v[20:23] offset:80
  ds_write_b128 v3, v[20:23] offset:96

  s_waitcnt lgkmcnt(0)
  s_barrier
  v_lshrrev_b32 v16, 4, v1
  v_and_b32 v17, 15, v1
  v_lshlrev_b32 v18, 2, v16
  v_xor_b32 v18, v17, v18
  v_lshlrev_b32 v18, 4, v18
  s_lshl_b32 s36, s30, 8
  v_add_u32 v18, s36, v18
  v_mul_u32_u24 v19, 9216, v16
  v_add_u32 v13, v19, v18
  v_lshrrev_b32 v20, 1, v1
  v_and_b32 v21, 1, v1
  v_lshlrev_b32 v21, 4, v21
  s_lshl_b32 s36, s30, 5
  s_add_u32 s36, s36, 1024
  v_add_u32 v21, s36, v21
  v_mul_u32_u24 v22, 9216, v20
  v_add_u32 v14, v22, v21
  s_mul_i32 s35, s29, 1152
  s_add_u32 s58, s58, s35
  s_addc_u32 s59, s59, 0
  s_sub_u32 s36, 5308416, s35

  s_mov_b32 s8, s58
  s_and_b32 s9, s59, 0xffff
  s_mov_b32 s10, s36
  s_mov_b32 s11, 0x00020000

  s_mul_i32 s33, s30, 9216
  s_add_u32 s33, s33, 74880
  s_mov_b32 s4, s8
  s_mov_b32 s5, s9
  s_mov_b32 s6, s10
  s_mov_b32 s7, s11
  s_mov_b32 s31, 0
  s_mov_b32 s32, 36864

  v_mov_b32 v84, 161088
  v_mov_b32 v85, 1
  s_setprio 3

  s_and_b32 s37, s30, 1
  v_lshrrev_b32 v26, 5, v1
  v_and_b32 v27, 31, v1
  s_lshl_b32 s36, s37, 5
  v_add_u32 v28, s36, v27
  v_mul_u32_u24 v28, 1152, v28
  v_bfe_u32 v29, v27, 1, 3
  v_add_u32 v30, 0, v26
  v_xor_b32 v30, v30, v29
  v_lshl_add_u32 v4, v30, 4, v28
  v_add_u32 v30, 2, v26
  v_xor_b32 v30, v30, v29
  v_lshl_add_u32 v5, v30, 4, v28
  v_add_u32 v30, 4, v26
  v_xor_b32 v30, v30, v29
  v_lshl_add_u32 v6, v30, 4, v28
  v_add_u32 v30, 6, v26
  v_xor_b32 v30, v30, v29
  v_lshl_add_u32 v7, v30, 4, v28
  v_and_b32 v27, 31, v1
  v_cmp_eq_u32 s[46:47], 1, v27
  v_mov_b32 v28, 161200
  v_mov_b32 v29, 73728
  v_lshrrev_b32 v26, 5, v1
  v_cndmask_b32 v28, v28, v29, s[46:47]
  v_lshl_add_u32 v82, v26, 4, v28
  v_bfe_u32 v27, v1, 4, 1
  v_bfe_u32 v28, v1, 2, 2
  v_and_b32 v29, 3, v1
  v_lshl_add_u32 v30, v26, 3, v28
  v_mul_u32_u24 v31, 40, v30
  v_lshl_add_u32 v31, v27, 5, v31
  v_lshl_add_u32 v31, v29, 3, v31
  v_add_u32 v77, 130176, v31
  v_lshlrev_b32 v78, 4, v1
  v_lshlrev_b32 v79, 2, v1
  v_mov_b32 v80, 0
  v_mov_b32 v81, 0

  s_load_dwordx2 s[48:49], s[0:1], 32
  s_load_dwordx2 s[54:55], s[0:1], 56
  s_load_dwordx4 s[56:59], s[0:1], 64

  v_lshrrev_b32 v16, 4, v1
  v_and_b32 v17, 15, v1
  v_lshlrev_b32 v18, 2, v16
  v_xor_b32 v18, v17, v18
  v_lshlrev_b32 v18, 4, v18
  s_lshl_b32 s36, s30, 8
  v_add_u32 v18, s36, v18
  v_mul_u32_u24 v19, 1152, v16
  v_add_u32 v92, v19, v18
  v_mov_b32 v94, v92
  v_mov_b32 v96, 0x80000000
  v_cmp_gt_u32 s[40:41], 2, v16
  v_lshrrev_b32 v20, 1, v1
  v_and_b32 v21, 1, v1
  v_cndmask_b32 v95, v96, v92, s[40:41]
  v_lshlrev_b32 v21, 4, v21
  s_lshl_b32 s36, s30, 5
  s_add_u32 s36, s36, 1024
  v_add_u32 v21, s36, v21
  v_mul_u32_u24 v22, 1152, v20
  v_add_u32 v93, v22, v21
  s_waitcnt lgkmcnt(0)

  s_mul_i32 s35, s29, 663552
  s_add_u32 s56, s56, s35
  s_addc_u32 s57, s57, 0

  s_mov_b32 s12, s56
  s_and_b32 s13, s57, 0xffff
  s_mov_b32 s14, 663552
  s_mov_b32 s15, 0x00020000

  s_mul_i32 s35, s29, 82944
  s_add_u32 s48, s48, s35
  s_addc_u32 s49, s49, 0

  s_mov_b32 s16, s48
  s_and_b32 s17, s49, 0xffff
  s_mov_b32 s18, 82944
  s_mov_b32 s19, 0x00020000

  s_mov_b32 s20, s62
  s_and_b32 s21, s63, 0xffff
  s_mov_b32 s22, 268435456
  s_mov_b32 s23, 0x00020000

  v_and_b32 v22, 31, v1
  v_lshlrev_b32 v22, 1, v22
  v_cmp_gt_u32 vcc, 32, v1
  v_and_b32 v23, 15, v1
  v_lshlrev_b32 v23, 1, v23
  v_cndmask_b32 v22, v96, v22, vcc
  v_cmp_gt_u32 vcc, 16, v1
  s_mul_i32 s35, s29, 1152
  s_lshl_b32 s36, s30, 8
  v_cndmask_b32 v23, v96, v23, vcc
  s_add_u32 s35, s35, s36

  s_mov_b32 s24, s54
  s_and_b32 s25, s55, 0xffff
  s_mov_b32 s26, 9216
  s_mov_b32 s27, 0x00020000

  buffer_load_ushort v100, v22, s[24:27], s35 offen offset:0
  buffer_load_ushort v101, v22, s[24:27], s35 offen offset:64
  buffer_load_ushort v102, v22, s[24:27], s35 offen offset:128
  buffer_load_ushort v103, v22, s[24:27], s35 offen offset:192
  s_mul_i32 s35, s29, 1152
  s_lshl_b32 s37, s30, 5
  s_add_u32 s35, s35, s37
  s_add_u32 s35, s35, 1024
  buffer_load_ushort v104, v23, s[24:27], s35 offen
  s_cmp_eq_u32 s29, 0
  s_cselect_b32 s38, 1152, 0

  s_mov_b32 s24, s58
  s_and_b32 s25, s59, 0xffff
  s_mov_b32 s26, s38
  s_mov_b32 s27, 0x00020000

  buffer_load_ushort v105, v22, s[24:27], s36 offen offset:0
  buffer_load_ushort v106, v22, s[24:27], s36 offen offset:64
  buffer_load_ushort v107, v22, s[24:27], s36 offen offset:128
  buffer_load_ushort v108, v22, s[24:27], s36 offen offset:192
  s_add_u32 s37, s37, 1024
  buffer_load_ushort v109, v23, s[24:27], s37 offen

  v_add_u32 v22, 0, v20
  v_mul_u32_u24 v23, 2731, v22
  v_lshrrev_b32 v23, 16, v23
  v_mul_u32_u24 v24, 24, v23
  v_sub_u32 v24, v22, v24
  v_mul_u32_u24 v23, 18, v23
  v_add_u32 v23, v23, v24
  v_mul_u32_u24 v23, 1152, v23
  v_add_u32 v23, v23, v21
  v_cmp_gt_u32 vcc, 18, v24
  s_nop 1
  v_cndmask_b32 v97, v96, v23, vcc

  v_add_u32 v22, 32, v20
  v_mul_u32_u24 v23, 2731, v22
  v_lshrrev_b32 v23, 16, v23
  v_mul_u32_u24 v24, 24, v23
  v_sub_u32 v24, v22, v24
  v_mul_u32_u24 v23, 18, v23
  v_add_u32 v23, v23, v24
  v_mul_u32_u24 v23, 1152, v23
  v_add_u32 v23, v23, v21
  v_cmp_gt_u32 vcc, 18, v24
  s_nop 1
  v_cndmask_b32 v98, v96, v23, vcc

  v_add_u32 v22, 64, v20
  v_mul_u32_u24 v23, 2731, v22
  v_lshrrev_b32 v23, 16, v23
  v_mul_u32_u24 v24, 24, v23
  v_sub_u32 v24, v22, v24
  v_mul_u32_u24 v23, 18, v23
  v_add_u32 v23, v23, v24
  v_mul_u32_u24 v23, 1152, v23
  v_add_u32 v23, v23, v21
  v_cmp_gt_u32 vcc, 18, v24
  s_nop 1
  v_cndmask_b32 v99, v96, v23, vcc

  v_lshrrev_b32 v16, 5, v1
  v_bfe_u32 v17, v1, 4, 1
  v_bfe_u32 v18, v1, 2, 2
  v_and_b32 v19, 3, v1
  v_lshl_add_u32 v20, v16, 3, v18
  v_lshlrev_b32 v20, 8, v20
  v_lshl_add_u32 v20, v17, 5, v20
  v_lshl_add_u32 v20, v19, 3, v20
  v_add_u32 v20, s33, v20

  v_xor_b32 v21, 0, v18
  v_lshl_add_u32 v8, v21, 6, v20
  v_xor_b32 v21, 1, v18
  v_lshl_add_u32 v9, v21, 6, v20
  v_xor_b32 v21, 2, v18
  v_lshl_add_u32 v10, v21, 6, v20
  v_xor_b32 v21, 3, v18
  v_lshl_add_u32 v11, v21, 6, v20
  v_lshrrev_b32 v21, 4, v1
  v_lshl_add_u32 v21, v21, 3, v18
  v_lshlrev_b32 v21, 5, v21
  v_lshl_add_u32 v21, v19, 3, v21
  v_add_u32 v12, s33, v21

  s_and_b32 s37, s30, 1
  s_waitcnt vmcnt(10)
  s_mov_b64 exec, 1
  ds_add_u32 v84, v85 offset:64
  s_mov_b64 exec, -1

  s_mov_b32 s39, 0x40000
WAITC_1:
  ds_read_b32 v3, v84 offset:64
  s_waitcnt lgkmcnt(0)
  v_readfirstlane_b32 s38, v3
  s_cmp_ge_u32 s38, 4
  s_cbranch_scc1 WAITD_2
  s_sleep 1
  s_sub_u32 s39, s39, 1
  s_cmp_lg_u32 s39, 0
  s_cbranch_scc1 WAITC_1

WAITD_2:
  v_lshrrev_b32 v16, 4, v1
  v_and_b32 v17, 15, v1
  s_lshl_b32 s35, s30, 4
  v_add_u32 v18, s35, v16
  v_lshlrev_b32 v76, 3, v18
  v_add_u32 v76, 162608, v76
  v_mul_u32_u24 v18, 1152, v18
  v_lshl_add_u32 v72, v17, 4, v18

  ds_read_b128 v[112:115], v72 offset:0
  ds_read_b128 v[116:119], v72 offset:256
  ds_read_b128 v[120:123], v72 offset:512
  ds_read_b128 v[124:127], v72 offset:768
  ds_read_b128 v[128:131], v72 offset:1024
  ds_read_b128 v[132:135], v72 offset:4608
  ds_read_b128 v[136:139], v72 offset:4864
  ds_read_b128 v[140:143], v72 offset:5120
  ds_read_b128 v[144:147], v72 offset:5376
  ds_read_b128 v[148:151], v72 offset:5632
  s_waitcnt lgkmcnt(0)
  ds_read_b128 v[152:155], v72 offset:9216
  ds_read_b128 v[156:159], v72 offset:9472
  ds_read_b128 v[160:163], v72 offset:9728
  ds_read_b128 v[164:167], v72 offset:9984
  ds_read_b128 v[168:171], v72 offset:10240
  ds_read_b128 v[172:175], v72 offset:13824
  ds_read_b128 v[176:179], v72 offset:14080
  ds_read_b128 v[180:183], v72 offset:14336
  ds_read_b128 v[184:187], v72 offset:14592
  ds_read_b128 v[188:191], v72 offset:14848
  s_waitcnt lgkmcnt(5)
  s_cmp_lt_u32 s29, 2
  s_cbranch_scc1 S_PROD
  s_cmp_ge_u32 s30, 2
  s_cbranch_scc1 S_CH1
  ds_read_b128 v[16:19], v4 offset:0
  ds_read_b128 v[40:43], v82 offset:0
  ds_read_b128 v[20:23], v5 offset:0
  ds_read_b128 v[44:47], v82 offset:32
  ds_read_b128 v[24:27], v6 offset:0
  ds_read_b128 v[48:51], v82 offset:64
  s_waitcnt lgkmcnt(4)
  v_mfma_f32_32x32x16_bf16 v[192:207], v[40:43], v[16:19], 0
  ds_read_b128 v[28:31], v7 offset:0
  ds_read_b128 v[52:55], v82 offset:96
  s_waitcnt lgkmcnt(4)
  v_mfma_f32_32x32x16_bf16 v[192:207], v[44:47], v[20:23], v[192:207]
  ds_read_b128 v[16:19], v4 offset:128
  ds_read_b128 v[40:43], v82 offset:128
  s_waitcnt lgkmcnt(4)
  v_mfma_f32_32x32x16_bf16 v[192:207], v[48:51], v[24:27], v[192:207]
  ds_read_b128 v[20:23], v5 offset:128
  ds_read_b128 v[44:47], v82 offset:160
  s_waitcnt lgkmcnt(4)
  v_mfma_f32_32x32x16_bf16 v[192:207], v[52:55], v[28:31], v[192:207]
  ds_read_b128 v[24:27], v6 offset:128
  ds_read_b128 v[48:51], v82 offset:192
  s_waitcnt lgkmcnt(4)
  v_mfma_f32_32x32x16_bf16 v[192:207], v[40:43], v[16:19], v[192:207]
  ds_read_b128 v[28:31], v7 offset:128
  ds_read_b128 v[52:55], v82 offset:224
  s_waitcnt lgkmcnt(4)
  v_mfma_f32_32x32x16_bf16 v[192:207], v[44:47], v[20:23], v[192:207]
  ds_read_b128 v[16:19], v4 offset:256
  ds_read_b128 v[40:43], v82 offset:256
  s_waitcnt lgkmcnt(4)
  v_mfma_f32_32x32x16_bf16 v[192:207], v[48:51], v[24:27], v[192:207]
  ds_read_b128 v[20:23], v5 offset:256
  ds_read_b128 v[44:47], v82 offset:288
  s_waitcnt lgkmcnt(4)
  v_mfma_f32_32x32x16_bf16 v[192:207], v[52:55], v[28:31], v[192:207]
  ds_read_b128 v[24:27], v6 offset:256
  ds_read_b128 v[48:51], v82 offset:320
  s_waitcnt lgkmcnt(4)
  v_mfma_f32_32x32x16_bf16 v[192:207], v[40:43], v[16:19], v[192:207]
  ds_read_b128 v[28:31], v7 offset:256
  ds_read_b128 v[52:55], v82 offset:352
  s_waitcnt lgkmcnt(4)
  v_mfma_f32_32x32x16_bf16 v[192:207], v[44:47], v[20:23], v[192:207]
  ds_read_b128 v[16:19], v4 offset:384
  ds_read_b128 v[40:43], v82 offset:384
  s_waitcnt lgkmcnt(4)
  v_mfma_f32_32x32x16_bf16 v[192:207], v[48:51], v[24:27], v[192:207]
  ds_read_b128 v[20:23], v5 offset:384
  ds_read_b128 v[44:47], v82 offset:416
  s_waitcnt lgkmcnt(4)
  v_mfma_f32_32x32x16_bf16 v[192:207], v[52:55], v[28:31], v[192:207]
  ds_read_b128 v[24:27], v6 offset:384
  ds_read_b128 v[48:51], v82 offset:448
  s_waitcnt lgkmcnt(4)
  v_mfma_f32_32x32x16_bf16 v[192:207], v[40:43], v[16:19], v[192:207]
  ds_read_b128 v[28:31], v7 offset:384
  ds_read_b128 v[52:55], v82 offset:480
  s_waitcnt lgkmcnt(4)
  v_mfma_f32_32x32x16_bf16 v[192:207], v[44:47], v[20:23], v[192:207]
  ds_read_b128 v[16:19], v4 offset:512
  ds_read_b128 v[40:43], v82 offset:512
  s_waitcnt lgkmcnt(4)
  v_mfma_f32_32x32x16_bf16 v[192:207], v[48:51], v[24:27], v[192:207]
  ds_read_b128 v[20:23], v5 offset:512
  ds_read_b128 v[44:47], v82 offset:544
  s_waitcnt lgkmcnt(4)
  v_mfma_f32_32x32x16_bf16 v[192:207], v[52:55], v[28:31], v[192:207]
  ds_read_b128 v[24:27], v6 offset:512
  ds_read_b128 v[48:51], v82 offset:576
  s_waitcnt lgkmcnt(4)
  v_mfma_f32_32x32x16_bf16 v[192:207], v[40:43], v[16:19], v[192:207]
  ds_read_b128 v[28:31], v7 offset:512
  ds_read_b128 v[52:55], v82 offset:608
  s_waitcnt lgkmcnt(4)
  v_mfma_f32_32x32x16_bf16 v[192:207], v[44:47], v[20:23], v[192:207]
  ds_read_b128 v[16:19], v4 offset:640
  ds_read_b128 v[40:43], v82 offset:640
  s_waitcnt lgkmcnt(4)
  v_mfma_f32_32x32x16_bf16 v[192:207], v[48:51], v[24:27], v[192:207]
  ds_read_b128 v[20:23], v5 offset:640
  ds_read_b128 v[44:47], v82 offset:672
  s_waitcnt lgkmcnt(4)
  v_mfma_f32_32x32x16_bf16 v[192:207], v[52:55], v[28:31], v[192:207]
  ds_read_b128 v[24:27], v6 offset:640
  ds_read_b128 v[48:51], v82 offset:704
  s_waitcnt lgkmcnt(4)
  v_mfma_f32_32x32x16_bf16 v[192:207], v[40:43], v[16:19], v[192:207]
  ds_read_b128 v[28:31], v7 offset:640
  ds_read_b128 v[52:55], v82 offset:736
  s_waitcnt lgkmcnt(4)
  v_mfma_f32_32x32x16_bf16 v[192:207], v[44:47], v[20:23], v[192:207]
  ds_read_b128 v[16:19], v4 offset:768
  ds_read_b128 v[40:43], v82 offset:768
  s_waitcnt lgkmcnt(4)
  v_mfma_f32_32x32x16_bf16 v[192:207], v[48:51], v[24:27], v[192:207]
  ds_read_b128 v[20:23], v5 offset:768
  ds_read_b128 v[44:47], v82 offset:800
  s_waitcnt lgkmcnt(4)
  v_mfma_f32_32x32x16_bf16 v[192:207], v[52:55], v[28:31], v[192:207]
  ds_read_b128 v[24:27], v6 offset:768
  ds_read_b128 v[48:51], v82 offset:832
  s_waitcnt lgkmcnt(4)
  v_mfma_f32_32x32x16_bf16 v[192:207], v[40:43], v[16:19], v[192:207]
  ds_read_b128 v[28:31], v7 offset:768
  ds_read_b128 v[52:55], v82 offset:864
  s_waitcnt lgkmcnt(4)
  v_mfma_f32_32x32x16_bf16 v[192:207], v[44:47], v[20:23], v[192:207]
  ds_read_b128 v[16:19], v4 offset:896
  ds_read_b128 v[40:43], v82 offset:896
  s_waitcnt lgkmcnt(4)
  v_mfma_f32_32x32x16_bf16 v[192:207], v[48:51], v[24:27], v[192:207]
  ds_read_b128 v[20:23], v5 offset:896
  ds_read_b128 v[44:47], v82 offset:928
  s_waitcnt lgkmcnt(4)
  v_mfma_f32_32x32x16_bf16 v[192:207], v[52:55], v[28:31], v[192:207]
  ds_read_b128 v[24:27], v6 offset:896
  ds_read_b128 v[48:51], v82 offset:960
  s_waitcnt lgkmcnt(4)
  v_mfma_f32_32x32x16_bf16 v[192:207], v[40:43], v[16:19], v[192:207]
  ds_read_b128 v[28:31], v7 offset:896
  ds_read_b128 v[52:55], v82 offset:992
  s_waitcnt lgkmcnt(4)
  v_mfma_f32_32x32x16_bf16 v[192:207], v[44:47], v[20:23], v[192:207]
  ds_read_b128 v[16:19], v4 offset:1024
  ds_read_b128 v[40:43], v82 offset:1024
  s_waitcnt lgkmcnt(4)
  v_mfma_f32_32x32x16_bf16 v[192:207], v[48:51], v[24:27], v[192:207]
  ds_read_b128 v[20:23], v5 offset:1024
  ds_read_b128 v[44:47], v82 offset:1056
  s_waitcnt lgkmcnt(4)
  v_mfma_f32_32x32x16_bf16 v[192:207], v[52:55], v[28:31], v[192:207]
  ds_read_b128 v[24:27], v6 offset:1024
  ds_read_b128 v[48:51], v82 offset:1088
  s_waitcnt lgkmcnt(4)
  v_mfma_f32_32x32x16_bf16 v[192:207], v[40:43], v[16:19], v[192:207]
  ds_read_b128 v[28:31], v7 offset:1024
  ds_read_b128 v[52:55], v82 offset:1120
  s_waitcnt lgkmcnt(4)
  v_mfma_f32_32x32x16_bf16 v[192:207], v[44:47], v[20:23], v[192:207]
  s_waitcnt lgkmcnt(2)
  v_mfma_f32_32x32x16_bf16 v[192:207], v[48:51], v[24:27], v[192:207]
  s_waitcnt lgkmcnt(0)
  v_mfma_f32_32x32x16_bf16 v[192:207], v[52:55], v[28:31], v[192:207]
  v_and_b32 v26, 31, v1
  s_lshl_b32 s36, s37, 5
  v_add_u32 v27, s36, v26

  v_lshlrev_b32 v28, 2, v27
  v_add_u32 v28, 162352, v28
  v_lshlrev_b32 v29, 3, v27
  v_add_u32 v29, 162608, v29
  s_nop 7
  s_mov_b32 exec_hi, 0
  ds_write_b32 v29, v193
  s_mov_b64 exec, -1

  s_waitcnt lgkmcnt(0)
  s_mov_b64 exec, 1
  ds_add_u32 v84, v85 offset:52
  s_mov_b64 exec, -1

  v_mul_f32 v30, 0xbfb8aa3b, v192
  v_exp_f32 v30, v30
  s_nop 0
  v_add_f32 v30, 1.0, v30
  v_rcp_f32 v30, v30
  s_mov_b32 exec_hi, 0
  s_nop 0
  ds_write_b32 v28, v30
  s_mov_b64 exec, -1

  s_branch S_DONE
S_CH1:
  ds_read_b128 v[16:19], v4 offset:0
  ds_read_b128 v[20:23], v5 offset:0
  ds_read_b128 v[24:27], v6 offset:0
  s_waitcnt lgkmcnt(2)
  v_mfma_f32_32x32x16_bf16 v[192:207], v[16:19], v[16:19], 0
  ds_read_b128 v[28:31], v7 offset:0
  s_waitcnt lgkmcnt(2)
  v_mfma_f32_32x32x16_bf16 v[192:207], v[20:23], v[20:23], v[192:207]
  ds_read_b128 v[16:19], v4 offset:128
  s_waitcnt lgkmcnt(2)
  v_mfma_f32_32x32x16_bf16 v[192:207], v[24:27], v[24:27], v[192:207]
  ds_read_b128 v[20:23], v5 offset:128
  s_waitcnt lgkmcnt(2)
  v_mfma_f32_32x32x16_bf16 v[192:207], v[28:31], v[28:31], v[192:207]
  ds_read_b128 v[24:27], v6 offset:128
  s_waitcnt lgkmcnt(2)
  v_mfma_f32_32x32x16_bf16 v[192:207], v[16:19], v[16:19], v[192:207]
  ds_read_b128 v[28:31], v7 offset:128
  s_waitcnt lgkmcnt(2)
  v_mfma_f32_32x32x16_bf16 v[192:207], v[20:23], v[20:23], v[192:207]
  ds_read_b128 v[16:19], v4 offset:256
  s_waitcnt lgkmcnt(2)
  v_mfma_f32_32x32x16_bf16 v[192:207], v[24:27], v[24:27], v[192:207]
  ds_read_b128 v[20:23], v5 offset:256
  s_waitcnt lgkmcnt(2)
  v_mfma_f32_32x32x16_bf16 v[192:207], v[28:31], v[28:31], v[192:207]
  ds_read_b128 v[24:27], v6 offset:256
  s_waitcnt lgkmcnt(2)
  v_mfma_f32_32x32x16_bf16 v[192:207], v[16:19], v[16:19], v[192:207]
  ds_read_b128 v[28:31], v7 offset:256
  s_waitcnt lgkmcnt(2)
  v_mfma_f32_32x32x16_bf16 v[192:207], v[20:23], v[20:23], v[192:207]
  ds_read_b128 v[16:19], v4 offset:384
  s_waitcnt lgkmcnt(2)
  v_mfma_f32_32x32x16_bf16 v[192:207], v[24:27], v[24:27], v[192:207]
  ds_read_b128 v[20:23], v5 offset:384
  s_waitcnt lgkmcnt(2)
  v_mfma_f32_32x32x16_bf16 v[192:207], v[28:31], v[28:31], v[192:207]
  ds_read_b128 v[24:27], v6 offset:384
  s_waitcnt lgkmcnt(2)
  v_mfma_f32_32x32x16_bf16 v[192:207], v[16:19], v[16:19], v[192:207]
  ds_read_b128 v[28:31], v7 offset:384
  s_waitcnt lgkmcnt(2)
  v_mfma_f32_32x32x16_bf16 v[192:207], v[20:23], v[20:23], v[192:207]
  ds_read_b128 v[16:19], v4 offset:512
  s_waitcnt lgkmcnt(2)
  v_mfma_f32_32x32x16_bf16 v[192:207], v[24:27], v[24:27], v[192:207]
  ds_read_b128 v[20:23], v5 offset:512
  s_waitcnt lgkmcnt(2)
  v_mfma_f32_32x32x16_bf16 v[192:207], v[28:31], v[28:31], v[192:207]
  ds_read_b128 v[24:27], v6 offset:512
  s_waitcnt lgkmcnt(2)
  v_mfma_f32_32x32x16_bf16 v[192:207], v[16:19], v[16:19], v[192:207]
  ds_read_b128 v[28:31], v7 offset:512
  s_waitcnt lgkmcnt(2)
  v_mfma_f32_32x32x16_bf16 v[192:207], v[20:23], v[20:23], v[192:207]
  ds_read_b128 v[16:19], v4 offset:640
  s_waitcnt lgkmcnt(2)
  v_mfma_f32_32x32x16_bf16 v[192:207], v[24:27], v[24:27], v[192:207]
  ds_read_b128 v[20:23], v5 offset:640
  s_waitcnt lgkmcnt(2)
  v_mfma_f32_32x32x16_bf16 v[192:207], v[28:31], v[28:31], v[192:207]
  ds_read_b128 v[24:27], v6 offset:640
  s_waitcnt lgkmcnt(2)
  v_mfma_f32_32x32x16_bf16 v[192:207], v[16:19], v[16:19], v[192:207]
  ds_read_b128 v[28:31], v7 offset:640
  s_waitcnt lgkmcnt(2)
  v_mfma_f32_32x32x16_bf16 v[192:207], v[20:23], v[20:23], v[192:207]
  ds_read_b128 v[16:19], v4 offset:768
  s_waitcnt lgkmcnt(2)
  v_mfma_f32_32x32x16_bf16 v[192:207], v[24:27], v[24:27], v[192:207]
  ds_read_b128 v[20:23], v5 offset:768
  s_waitcnt lgkmcnt(2)
  v_mfma_f32_32x32x16_bf16 v[192:207], v[28:31], v[28:31], v[192:207]
  ds_read_b128 v[24:27], v6 offset:768
  s_waitcnt lgkmcnt(2)
  v_mfma_f32_32x32x16_bf16 v[192:207], v[16:19], v[16:19], v[192:207]
  ds_read_b128 v[28:31], v7 offset:768
  s_waitcnt lgkmcnt(2)
  v_mfma_f32_32x32x16_bf16 v[192:207], v[20:23], v[20:23], v[192:207]
  ds_read_b128 v[16:19], v4 offset:896
  s_waitcnt lgkmcnt(2)
  v_mfma_f32_32x32x16_bf16 v[192:207], v[24:27], v[24:27], v[192:207]
  ds_read_b128 v[20:23], v5 offset:896
  s_waitcnt lgkmcnt(2)
  v_mfma_f32_32x32x16_bf16 v[192:207], v[28:31], v[28:31], v[192:207]
  ds_read_b128 v[24:27], v6 offset:896
  s_waitcnt lgkmcnt(2)
  v_mfma_f32_32x32x16_bf16 v[192:207], v[16:19], v[16:19], v[192:207]
  ds_read_b128 v[28:31], v7 offset:896
  s_waitcnt lgkmcnt(2)
  v_mfma_f32_32x32x16_bf16 v[192:207], v[20:23], v[20:23], v[192:207]
  ds_read_b128 v[16:19], v4 offset:1024
  s_waitcnt lgkmcnt(2)
  v_mfma_f32_32x32x16_bf16 v[192:207], v[24:27], v[24:27], v[192:207]
  ds_read_b128 v[20:23], v5 offset:1024
  s_waitcnt lgkmcnt(2)
  v_mfma_f32_32x32x16_bf16 v[192:207], v[28:31], v[28:31], v[192:207]
  ds_read_b128 v[24:27], v6 offset:1024
  s_waitcnt lgkmcnt(2)
  v_mfma_f32_32x32x16_bf16 v[192:207], v[16:19], v[16:19], v[192:207]
  ds_read_b128 v[28:31], v7 offset:1024
  s_waitcnt lgkmcnt(2)
  v_mfma_f32_32x32x16_bf16 v[192:207], v[20:23], v[20:23], v[192:207]
  s_waitcnt lgkmcnt(1)
  v_mfma_f32_32x32x16_bf16 v[192:207], v[24:27], v[24:27], v[192:207]
  s_waitcnt lgkmcnt(0)
  v_mfma_f32_32x32x16_bf16 v[192:207], v[28:31], v[28:31], v[192:207]
  v_and_b32 v26, 31, v1
  s_lshl_b32 s36, s37, 5
  v_add_u32 v27, s36, v26

  v_lshlrev_b32 v29, 3, v27
  v_add_u32 v29, 162612, v29
  v_and_b32 v30, 1, v26
  v_cmp_ne_u32 s[40:41], 0, v30
  v_and_b32 v30, 2, v26
  v_cmp_ne_u32 s[42:43], 0, v30
  v_and_b32 v30, 8, v26
  v_cmp_ne_u32 s[44:45], 0, v30
  v_and_b32 v30, 16, v26
  v_cmp_ne_u32 s[46:47], 0, v30
  s_nop 1

  v_cndmask_b32 v192, v192, v193, s[40:41]
  v_cndmask_b32 v193, v194, v195, s[40:41]
  v_cndmask_b32 v194, v196, v197, s[40:41]
  v_cndmask_b32 v195, v198, v199, s[40:41]
  v_cndmask_b32 v196, v200, v201, s[40:41]
  v_cndmask_b32 v197, v202, v203, s[40:41]
  v_cndmask_b32 v198, v204, v205, s[40:41]
  v_cndmask_b32 v199, v206, v207, s[40:41]
  v_cndmask_b32 v192, v192, v193, s[42:43]
  v_cndmask_b32 v193, v194, v195, s[42:43]
  v_cndmask_b32 v194, v196, v197, s[42:43]
  v_cndmask_b32 v195, v198, v199, s[42:43]
  v_cndmask_b32 v192, v192, v193, s[44:45]
  v_cndmask_b32 v193, v194, v195, s[44:45]
  v_cndmask_b32 v192, v192, v193, s[46:47]
  v_bfe_u32 v30, v26, 2, 1
  v_lshrrev_b32 v31, 5, v1
  v_cmp_eq_u32 s[40:41], v30, v31
  s_nop 1
  s_mov_b64 exec, s[40:41]
  ds_write_b32 v29, v192
  s_mov_b64 exec, -1

  s_waitcnt lgkmcnt(0)
  s_mov_b64 exec, 1
  ds_add_u32 v84, v85 offset:52
  s_mov_b64 exec, -1

  s_branch S_DONE
S_PROD:
  s_cmp_lt_u32 s30, 2
  s_cbranch_scc1 S_KV
  ds_read_b128 v[16:19], v4 offset:0
  ds_read_b128 v[20:23], v5 offset:0
  ds_read_b128 v[24:27], v6 offset:0
  s_waitcnt lgkmcnt(2)
  v_mfma_f32_32x32x16_bf16 v[192:207], v[16:19], v[16:19], 0
  ds_read_b128 v[28:31], v7 offset:0
  s_waitcnt lgkmcnt(2)
  v_mfma_f32_32x32x16_bf16 v[192:207], v[20:23], v[20:23], v[192:207]
  ds_read_b128 v[16:19], v4 offset:128
  s_waitcnt lgkmcnt(2)
  v_mfma_f32_32x32x16_bf16 v[192:207], v[24:27], v[24:27], v[192:207]
  ds_read_b128 v[20:23], v5 offset:128
  s_waitcnt lgkmcnt(2)
  v_mfma_f32_32x32x16_bf16 v[192:207], v[28:31], v[28:31], v[192:207]
  ds_read_b128 v[24:27], v6 offset:128
  s_waitcnt lgkmcnt(2)
  v_mfma_f32_32x32x16_bf16 v[192:207], v[16:19], v[16:19], v[192:207]
  ds_read_b128 v[28:31], v7 offset:128
  s_waitcnt lgkmcnt(2)
  v_mfma_f32_32x32x16_bf16 v[192:207], v[20:23], v[20:23], v[192:207]
  ds_read_b128 v[16:19], v4 offset:256
  s_waitcnt lgkmcnt(2)
  v_mfma_f32_32x32x16_bf16 v[192:207], v[24:27], v[24:27], v[192:207]
  ds_read_b128 v[20:23], v5 offset:256
  s_waitcnt lgkmcnt(2)
  v_mfma_f32_32x32x16_bf16 v[192:207], v[28:31], v[28:31], v[192:207]
  ds_read_b128 v[24:27], v6 offset:256
  s_waitcnt lgkmcnt(2)
  v_mfma_f32_32x32x16_bf16 v[192:207], v[16:19], v[16:19], v[192:207]
  ds_read_b128 v[28:31], v7 offset:256
  s_waitcnt lgkmcnt(2)
  v_mfma_f32_32x32x16_bf16 v[192:207], v[20:23], v[20:23], v[192:207]
  ds_read_b128 v[16:19], v4 offset:384
  s_waitcnt lgkmcnt(2)
  v_mfma_f32_32x32x16_bf16 v[192:207], v[24:27], v[24:27], v[192:207]
  ds_read_b128 v[20:23], v5 offset:384
  s_waitcnt lgkmcnt(2)
  v_mfma_f32_32x32x16_bf16 v[192:207], v[28:31], v[28:31], v[192:207]
  ds_read_b128 v[24:27], v6 offset:384
  s_waitcnt lgkmcnt(2)
  v_mfma_f32_32x32x16_bf16 v[192:207], v[16:19], v[16:19], v[192:207]
  ds_read_b128 v[28:31], v7 offset:384
  s_waitcnt lgkmcnt(2)
  v_mfma_f32_32x32x16_bf16 v[192:207], v[20:23], v[20:23], v[192:207]
  ds_read_b128 v[16:19], v4 offset:512
  s_waitcnt lgkmcnt(2)
  v_mfma_f32_32x32x16_bf16 v[192:207], v[24:27], v[24:27], v[192:207]
  ds_read_b128 v[20:23], v5 offset:512
  s_waitcnt lgkmcnt(2)
  v_mfma_f32_32x32x16_bf16 v[192:207], v[28:31], v[28:31], v[192:207]
  ds_read_b128 v[24:27], v6 offset:512
  s_waitcnt lgkmcnt(2)
  v_mfma_f32_32x32x16_bf16 v[192:207], v[16:19], v[16:19], v[192:207]
  ds_read_b128 v[28:31], v7 offset:512
  s_waitcnt lgkmcnt(2)
  v_mfma_f32_32x32x16_bf16 v[192:207], v[20:23], v[20:23], v[192:207]
  ds_read_b128 v[16:19], v4 offset:640
  s_waitcnt lgkmcnt(2)
  v_mfma_f32_32x32x16_bf16 v[192:207], v[24:27], v[24:27], v[192:207]
  ds_read_b128 v[20:23], v5 offset:640
  s_waitcnt lgkmcnt(2)
  v_mfma_f32_32x32x16_bf16 v[192:207], v[28:31], v[28:31], v[192:207]
  ds_read_b128 v[24:27], v6 offset:640
  s_waitcnt lgkmcnt(2)
  v_mfma_f32_32x32x16_bf16 v[192:207], v[16:19], v[16:19], v[192:207]
  ds_read_b128 v[28:31], v7 offset:640
  s_waitcnt lgkmcnt(2)
  v_mfma_f32_32x32x16_bf16 v[192:207], v[20:23], v[20:23], v[192:207]
  ds_read_b128 v[16:19], v4 offset:768
  s_waitcnt lgkmcnt(2)
  v_mfma_f32_32x32x16_bf16 v[192:207], v[24:27], v[24:27], v[192:207]
  ds_read_b128 v[20:23], v5 offset:768
  s_waitcnt lgkmcnt(2)
  v_mfma_f32_32x32x16_bf16 v[192:207], v[28:31], v[28:31], v[192:207]
  ds_read_b128 v[24:27], v6 offset:768
  s_waitcnt lgkmcnt(2)
  v_mfma_f32_32x32x16_bf16 v[192:207], v[16:19], v[16:19], v[192:207]
  ds_read_b128 v[28:31], v7 offset:768
  s_waitcnt lgkmcnt(2)
  v_mfma_f32_32x32x16_bf16 v[192:207], v[20:23], v[20:23], v[192:207]
  ds_read_b128 v[16:19], v4 offset:896
  s_waitcnt lgkmcnt(2)
  v_mfma_f32_32x32x16_bf16 v[192:207], v[24:27], v[24:27], v[192:207]
  ds_read_b128 v[20:23], v5 offset:896
  s_waitcnt lgkmcnt(2)
  v_mfma_f32_32x32x16_bf16 v[192:207], v[28:31], v[28:31], v[192:207]
  ds_read_b128 v[24:27], v6 offset:896
  s_waitcnt lgkmcnt(2)
  v_mfma_f32_32x32x16_bf16 v[192:207], v[16:19], v[16:19], v[192:207]
  ds_read_b128 v[28:31], v7 offset:896
  s_waitcnt lgkmcnt(2)
  v_mfma_f32_32x32x16_bf16 v[192:207], v[20:23], v[20:23], v[192:207]
  ds_read_b128 v[16:19], v4 offset:1024
  s_waitcnt lgkmcnt(2)
  v_mfma_f32_32x32x16_bf16 v[192:207], v[24:27], v[24:27], v[192:207]
  ds_read_b128 v[20:23], v5 offset:1024
  s_waitcnt lgkmcnt(2)
  v_mfma_f32_32x32x16_bf16 v[192:207], v[28:31], v[28:31], v[192:207]
  ds_read_b128 v[24:27], v6 offset:1024
  s_waitcnt lgkmcnt(2)
  v_mfma_f32_32x32x16_bf16 v[192:207], v[16:19], v[16:19], v[192:207]
  ds_read_b128 v[28:31], v7 offset:1024
  s_waitcnt lgkmcnt(2)
  v_mfma_f32_32x32x16_bf16 v[192:207], v[20:23], v[20:23], v[192:207]
  s_waitcnt lgkmcnt(1)
  v_mfma_f32_32x32x16_bf16 v[192:207], v[24:27], v[24:27], v[192:207]
  s_waitcnt lgkmcnt(0)
  v_mfma_f32_32x32x16_bf16 v[192:207], v[28:31], v[28:31], v[192:207]
  v_and_b32 v26, 31, v1
  s_lshl_b32 s36, s37, 5
  v_add_u32 v27, s36, v26

  v_lshlrev_b32 v29, 3, v27
  v_add_u32 v29, 162612, v29
  v_and_b32 v30, 1, v26
  v_cmp_ne_u32 s[40:41], 0, v30
  v_and_b32 v30, 2, v26
  v_cmp_ne_u32 s[42:43], 0, v30
  v_and_b32 v30, 8, v26
  v_cmp_ne_u32 s[44:45], 0, v30
  v_and_b32 v30, 16, v26
  v_cmp_ne_u32 s[46:47], 0, v30
  s_nop 1

  v_cndmask_b32 v192, v192, v193, s[40:41]
  v_cndmask_b32 v193, v194, v195, s[40:41]
  v_cndmask_b32 v194, v196, v197, s[40:41]
  v_cndmask_b32 v195, v198, v199, s[40:41]
  v_cndmask_b32 v196, v200, v201, s[40:41]
  v_cndmask_b32 v197, v202, v203, s[40:41]
  v_cndmask_b32 v198, v204, v205, s[40:41]
  v_cndmask_b32 v199, v206, v207, s[40:41]
  v_cndmask_b32 v192, v192, v193, s[42:43]
  v_cndmask_b32 v193, v194, v195, s[42:43]
  v_cndmask_b32 v194, v196, v197, s[42:43]
  v_cndmask_b32 v195, v198, v199, s[42:43]
  v_cndmask_b32 v192, v192, v193, s[44:45]
  v_cndmask_b32 v193, v194, v195, s[44:45]
  v_cndmask_b32 v192, v192, v193, s[46:47]
  v_bfe_u32 v30, v26, 2, 1
  v_lshrrev_b32 v31, 5, v1
  v_cmp_eq_u32 s[40:41], v30, v31
  s_nop 1
  s_mov_b64 exec, s[40:41]
  ds_write_b32 v29, v192
  s_mov_b64 exec, -1

  s_waitcnt lgkmcnt(0)
  s_mov_b64 exec, 1
  ds_add_u32 v84, v85 offset:52
  s_mov_b64 exec, -1

  ds_read_b128 v[16:19], v4 offset:0
  ds_read_b128 v[40:43], v82 offset:0
  ds_read_b128 v[20:23], v5 offset:0
  ds_read_b128 v[44:47], v82 offset:32
  ds_read_b128 v[24:27], v6 offset:0
  ds_read_b128 v[48:51], v82 offset:64
  s_waitcnt lgkmcnt(4)
  v_mfma_f32_32x32x16_bf16 v[192:207], v[40:43], v[16:19], 0
  ds_read_b128 v[28:31], v7 offset:0
  ds_read_b128 v[52:55], v82 offset:96
  s_waitcnt lgkmcnt(4)
  v_mfma_f32_32x32x16_bf16 v[192:207], v[44:47], v[20:23], v[192:207]
  ds_read_b128 v[16:19], v4 offset:128
  ds_read_b128 v[40:43], v82 offset:128
  s_waitcnt lgkmcnt(4)
  v_mfma_f32_32x32x16_bf16 v[192:207], v[48:51], v[24:27], v[192:207]
  ds_read_b128 v[20:23], v5 offset:128
  ds_read_b128 v[44:47], v82 offset:160
  s_waitcnt lgkmcnt(4)
  v_mfma_f32_32x32x16_bf16 v[192:207], v[52:55], v[28:31], v[192:207]
  ds_read_b128 v[24:27], v6 offset:128
  ds_read_b128 v[48:51], v82 offset:192
  s_waitcnt lgkmcnt(4)
  v_mfma_f32_32x32x16_bf16 v[192:207], v[40:43], v[16:19], v[192:207]
  ds_read_b128 v[28:31], v7 offset:128
  ds_read_b128 v[52:55], v82 offset:224
  s_waitcnt lgkmcnt(4)
  v_mfma_f32_32x32x16_bf16 v[192:207], v[44:47], v[20:23], v[192:207]
  ds_read_b128 v[16:19], v4 offset:256
  ds_read_b128 v[40:43], v82 offset:256
  s_waitcnt lgkmcnt(4)
  v_mfma_f32_32x32x16_bf16 v[192:207], v[48:51], v[24:27], v[192:207]
  ds_read_b128 v[20:23], v5 offset:256
  ds_read_b128 v[44:47], v82 offset:288
  s_waitcnt lgkmcnt(4)
  v_mfma_f32_32x32x16_bf16 v[192:207], v[52:55], v[28:31], v[192:207]
  ds_read_b128 v[24:27], v6 offset:256
  ds_read_b128 v[48:51], v82 offset:320
  s_waitcnt lgkmcnt(4)
  v_mfma_f32_32x32x16_bf16 v[192:207], v[40:43], v[16:19], v[192:207]
  ds_read_b128 v[28:31], v7 offset:256
  ds_read_b128 v[52:55], v82 offset:352
  s_waitcnt lgkmcnt(4)
  v_mfma_f32_32x32x16_bf16 v[192:207], v[44:47], v[20:23], v[192:207]
  ds_read_b128 v[16:19], v4 offset:384
  ds_read_b128 v[40:43], v82 offset:384
  s_waitcnt lgkmcnt(4)
  v_mfma_f32_32x32x16_bf16 v[192:207], v[48:51], v[24:27], v[192:207]
  ds_read_b128 v[20:23], v5 offset:384
  ds_read_b128 v[44:47], v82 offset:416
  s_waitcnt lgkmcnt(4)
  v_mfma_f32_32x32x16_bf16 v[192:207], v[52:55], v[28:31], v[192:207]
  ds_read_b128 v[24:27], v6 offset:384
  ds_read_b128 v[48:51], v82 offset:448
  s_waitcnt lgkmcnt(4)
  v_mfma_f32_32x32x16_bf16 v[192:207], v[40:43], v[16:19], v[192:207]
  ds_read_b128 v[28:31], v7 offset:384
  ds_read_b128 v[52:55], v82 offset:480
  s_waitcnt lgkmcnt(4)
  v_mfma_f32_32x32x16_bf16 v[192:207], v[44:47], v[20:23], v[192:207]
  ds_read_b128 v[16:19], v4 offset:512
  ds_read_b128 v[40:43], v82 offset:512
  s_waitcnt lgkmcnt(4)
  v_mfma_f32_32x32x16_bf16 v[192:207], v[48:51], v[24:27], v[192:207]
  ds_read_b128 v[20:23], v5 offset:512
  ds_read_b128 v[44:47], v82 offset:544
  s_waitcnt lgkmcnt(4)
  v_mfma_f32_32x32x16_bf16 v[192:207], v[52:55], v[28:31], v[192:207]
  ds_read_b128 v[24:27], v6 offset:512
  ds_read_b128 v[48:51], v82 offset:576
  s_waitcnt lgkmcnt(4)
  v_mfma_f32_32x32x16_bf16 v[192:207], v[40:43], v[16:19], v[192:207]
  ds_read_b128 v[28:31], v7 offset:512
  ds_read_b128 v[52:55], v82 offset:608
  s_waitcnt lgkmcnt(4)
  v_mfma_f32_32x32x16_bf16 v[192:207], v[44:47], v[20:23], v[192:207]
  ds_read_b128 v[16:19], v4 offset:640
  ds_read_b128 v[40:43], v82 offset:640
  s_waitcnt lgkmcnt(4)
  v_mfma_f32_32x32x16_bf16 v[192:207], v[48:51], v[24:27], v[192:207]
  ds_read_b128 v[20:23], v5 offset:640
  ds_read_b128 v[44:47], v82 offset:672
  s_waitcnt lgkmcnt(4)
  v_mfma_f32_32x32x16_bf16 v[192:207], v[52:55], v[28:31], v[192:207]
  ds_read_b128 v[24:27], v6 offset:640
  ds_read_b128 v[48:51], v82 offset:704
  s_waitcnt lgkmcnt(4)
  v_mfma_f32_32x32x16_bf16 v[192:207], v[40:43], v[16:19], v[192:207]
  ds_read_b128 v[28:31], v7 offset:640
  ds_read_b128 v[52:55], v82 offset:736
  s_waitcnt lgkmcnt(4)
  v_mfma_f32_32x32x16_bf16 v[192:207], v[44:47], v[20:23], v[192:207]
  ds_read_b128 v[16:19], v4 offset:768
  ds_read_b128 v[40:43], v82 offset:768
  s_waitcnt lgkmcnt(4)
  v_mfma_f32_32x32x16_bf16 v[192:207], v[48:51], v[24:27], v[192:207]
  ds_read_b128 v[20:23], v5 offset:768
  ds_read_b128 v[44:47], v82 offset:800
  s_waitcnt lgkmcnt(4)
  v_mfma_f32_32x32x16_bf16 v[192:207], v[52:55], v[28:31], v[192:207]
  ds_read_b128 v[24:27], v6 offset:768
  ds_read_b128 v[48:51], v82 offset:832
  s_waitcnt lgkmcnt(4)
  v_mfma_f32_32x32x16_bf16 v[192:207], v[40:43], v[16:19], v[192:207]
  ds_read_b128 v[28:31], v7 offset:768
  ds_read_b128 v[52:55], v82 offset:864
  s_waitcnt lgkmcnt(4)
  v_mfma_f32_32x32x16_bf16 v[192:207], v[44:47], v[20:23], v[192:207]
  ds_read_b128 v[16:19], v4 offset:896
  ds_read_b128 v[40:43], v82 offset:896
  s_waitcnt lgkmcnt(4)
  v_mfma_f32_32x32x16_bf16 v[192:207], v[48:51], v[24:27], v[192:207]
  ds_read_b128 v[20:23], v5 offset:896
  ds_read_b128 v[44:47], v82 offset:928
  s_waitcnt lgkmcnt(4)
  v_mfma_f32_32x32x16_bf16 v[192:207], v[52:55], v[28:31], v[192:207]
  ds_read_b128 v[24:27], v6 offset:896
  ds_read_b128 v[48:51], v82 offset:960
  s_waitcnt lgkmcnt(4)
  v_mfma_f32_32x32x16_bf16 v[192:207], v[40:43], v[16:19], v[192:207]
  ds_read_b128 v[28:31], v7 offset:896
  ds_read_b128 v[52:55], v82 offset:992
  s_waitcnt lgkmcnt(4)
  v_mfma_f32_32x32x16_bf16 v[192:207], v[44:47], v[20:23], v[192:207]
  ds_read_b128 v[16:19], v4 offset:1024
  ds_read_b128 v[40:43], v82 offset:1024
  s_waitcnt lgkmcnt(4)
  v_mfma_f32_32x32x16_bf16 v[192:207], v[48:51], v[24:27], v[192:207]
  ds_read_b128 v[20:23], v5 offset:1024
  ds_read_b128 v[44:47], v82 offset:1056
  s_waitcnt lgkmcnt(4)
  v_mfma_f32_32x32x16_bf16 v[192:207], v[52:55], v[28:31], v[192:207]
  ds_read_b128 v[24:27], v6 offset:1024
  ds_read_b128 v[48:51], v82 offset:1088
  s_waitcnt lgkmcnt(4)
  v_mfma_f32_32x32x16_bf16 v[192:207], v[40:43], v[16:19], v[192:207]
  ds_read_b128 v[28:31], v7 offset:1024
  ds_read_b128 v[52:55], v82 offset:1120
  s_waitcnt lgkmcnt(4)
  v_mfma_f32_32x32x16_bf16 v[192:207], v[44:47], v[20:23], v[192:207]
  s_waitcnt lgkmcnt(2)
  v_mfma_f32_32x32x16_bf16 v[192:207], v[48:51], v[24:27], v[192:207]
  s_waitcnt lgkmcnt(0)
  v_mfma_f32_32x32x16_bf16 v[192:207], v[52:55], v[28:31], v[192:207]
  v_and_b32 v26, 31, v1
  s_lshl_b32 s36, s37, 5
  v_add_u32 v27, s36, v26

  v_lshlrev_b32 v28, 2, v27
  v_add_u32 v28, 162352, v28
  v_lshlrev_b32 v29, 3, v27
  v_add_u32 v29, 162608, v29
  s_nop 7
  s_mov_b32 exec_hi, 0
  ds_write_b32 v29, v193
  s_mov_b64 exec, -1

  s_waitcnt lgkmcnt(0)
  s_mov_b64 exec, 1
  ds_add_u32 v84, v85 offset:52
  s_mov_b64 exec, -1

  v_mul_f32 v30, 0xbfb8aa3b, v192
  v_exp_f32 v30, v30
  s_nop 0
  v_add_f32 v30, 1.0, v30
  v_rcp_f32 v30, v30
  s_mov_b32 exec_hi, 0
  s_nop 0
  ds_write_b32 v28, v30
  s_mov_b64 exec, -1

  s_branch S_DONE
S_KV:
  s_mov_b32 s39, 0x40000
WAITC_3:
  ds_read_b32 v3, v84 offset:80
  s_waitcnt lgkmcnt(0)
  v_readfirstlane_b32 s38, v3
  s_cmp_ge_u32 s38, 4
  s_cbranch_scc1 WAITD_4
  s_sleep 1
  s_sub_u32 s39, s39, 1
  s_cmp_lg_u32 s39, 0
  s_cbranch_scc1 WAITC_3

WAITD_4:
  v_lshrrev_b32 v83, 5, v1
  v_cmp_eq_u32 s[42:43], 0, v83
  s_lshl_b32 s46, s28, 1
  s_add_u32 s46, s46, s30
  s_lshl_b32 s47, s46, 12
  s_add_u32 s47, s47, 0
  s_cmp_eq_u32 s29, 1
  s_cbranch_scc1 S_V
  s_mov_b32 s36, 266240
  buffer_load_dword v81, v80, s[20:23], s36 offen sc1

  ds_read_b128 v[16:19], v4 offset:0
  ds_read_b64_tr_b16 v[40:41], v77 offset:0
  ds_read_b64_tr_b16 v[42:43], v77 offset:160
  ds_read_b128 v[20:23], v5 offset:0
  ds_read_b64_tr_b16 v[44:45], v77 offset:640
  ds_read_b64_tr_b16 v[46:47], v77 offset:800
  ds_read_b128 v[24:27], v6 offset:0
  ds_read_b64_tr_b16 v[48:49], v77 offset:1280
  ds_read_b64_tr_b16 v[50:51], v77 offset:1440
  s_waitcnt lgkmcnt(6)
  v_mfma_f32_32x32x16_bf16 v[192:207], v[40:43], v[16:19], 0
  ds_read_b128 v[28:31], v7 offset:0
  ds_read_b64_tr_b16 v[52:53], v77 offset:1920
  ds_read_b64_tr_b16 v[54:55], v77 offset:2080
  s_waitcnt lgkmcnt(6)
  v_mfma_f32_32x32x16_bf16 v[192:207], v[44:47], v[20:23], v[192:207]
  ds_read_b128 v[16:19], v4 offset:128
  ds_read_b64_tr_b16 v[40:41], v77 offset:2560
  ds_read_b64_tr_b16 v[42:43], v77 offset:2720
  s_waitcnt lgkmcnt(6)
  v_mfma_f32_32x32x16_bf16 v[192:207], v[48:51], v[24:27], v[192:207]
  ds_read_b128 v[20:23], v5 offset:128
  ds_read_b64_tr_b16 v[44:45], v77 offset:3200
  ds_read_b64_tr_b16 v[46:47], v77 offset:3360
  s_waitcnt lgkmcnt(6)
  v_mfma_f32_32x32x16_bf16 v[192:207], v[52:55], v[28:31], v[192:207]
  ds_read_b128 v[24:27], v6 offset:128
  ds_read_b64_tr_b16 v[48:49], v77 offset:3840
  ds_read_b64_tr_b16 v[50:51], v77 offset:4000
  s_waitcnt lgkmcnt(6)
  v_mfma_f32_32x32x16_bf16 v[192:207], v[40:43], v[16:19], v[192:207]
  ds_read_b128 v[28:31], v7 offset:128
  ds_read_b64_tr_b16 v[52:53], v77 offset:4480
  ds_read_b64_tr_b16 v[54:55], v77 offset:4640
  s_waitcnt lgkmcnt(6)
  v_mfma_f32_32x32x16_bf16 v[192:207], v[44:47], v[20:23], v[192:207]
  ds_read_b128 v[16:19], v4 offset:256
  ds_read_b64_tr_b16 v[40:41], v77 offset:5120
  ds_read_b64_tr_b16 v[42:43], v77 offset:5280
  s_waitcnt lgkmcnt(6)
  v_mfma_f32_32x32x16_bf16 v[192:207], v[48:51], v[24:27], v[192:207]
  ds_read_b128 v[20:23], v5 offset:256
  ds_read_b64_tr_b16 v[44:45], v77 offset:5760
  ds_read_b64_tr_b16 v[46:47], v77 offset:5920
  s_waitcnt lgkmcnt(6)
  v_mfma_f32_32x32x16_bf16 v[192:207], v[52:55], v[28:31], v[192:207]
  ds_read_b128 v[24:27], v6 offset:256
  ds_read_b64_tr_b16 v[48:49], v77 offset:6400
  ds_read_b64_tr_b16 v[50:51], v77 offset:6560
  s_waitcnt lgkmcnt(6)
  v_mfma_f32_32x32x16_bf16 v[192:207], v[40:43], v[16:19], v[192:207]
  ds_read_b128 v[28:31], v7 offset:256
  ds_read_b64_tr_b16 v[52:53], v77 offset:7040
  ds_read_b64_tr_b16 v[54:55], v77 offset:7200
  s_waitcnt lgkmcnt(6)
  v_mfma_f32_32x32x16_bf16 v[192:207], v[44:47], v[20:23], v[192:207]
  ds_read_b128 v[16:19], v4 offset:384
  ds_read_b64_tr_b16 v[40:41], v77 offset:7680
  ds_read_b64_tr_b16 v[42:43], v77 offset:7840
  s_waitcnt lgkmcnt(6)
  v_mfma_f32_32x32x16_bf16 v[192:207], v[48:51], v[24:27], v[192:207]
  ds_read_b128 v[20:23], v5 offset:384
  ds_read_b64_tr_b16 v[44:45], v77 offset:8320
  ds_read_b64_tr_b16 v[46:47], v77 offset:8480
  s_waitcnt lgkmcnt(6)
  v_mfma_f32_32x32x16_bf16 v[192:207], v[52:55], v[28:31], v[192:207]
  ds_read_b128 v[24:27], v6 offset:384
  ds_read_b64_tr_b16 v[48:49], v77 offset:8960
  ds_read_b64_tr_b16 v[50:51], v77 offset:9120
  s_waitcnt lgkmcnt(6)
  v_mfma_f32_32x32x16_bf16 v[192:207], v[40:43], v[16:19], v[192:207]
  ds_read_b128 v[28:31], v7 offset:384
  ds_read_b64_tr_b16 v[52:53], v77 offset:9600
  ds_read_b64_tr_b16 v[54:55], v77 offset:9760
  s_waitcnt lgkmcnt(6)
  v_mfma_f32_32x32x16_bf16 v[192:207], v[44:47], v[20:23], v[192:207]
  ds_read_b128 v[16:19], v4 offset:512
  ds_read_b64_tr_b16 v[40:41], v77 offset:10240
  ds_read_b64_tr_b16 v[42:43], v77 offset:10400
  s_waitcnt lgkmcnt(6)
  v_mfma_f32_32x32x16_bf16 v[192:207], v[48:51], v[24:27], v[192:207]
  ds_read_b128 v[20:23], v5 offset:512
  ds_read_b64_tr_b16 v[44:45], v77 offset:10880
  ds_read_b64_tr_b16 v[46:47], v77 offset:11040
  s_waitcnt lgkmcnt(6)
  v_mfma_f32_32x32x16_bf16 v[192:207], v[52:55], v[28:31], v[192:207]
  ds_read_b128 v[24:27], v6 offset:512
  ds_read_b64_tr_b16 v[48:49], v77 offset:11520
  ds_read_b64_tr_b16 v[50:51], v77 offset:11680
  s_waitcnt lgkmcnt(6)
  v_mfma_f32_32x32x16_bf16 v[192:207], v[40:43], v[16:19], v[192:207]
  ds_read_b128 v[28:31], v7 offset:512
  ds_read_b64_tr_b16 v[52:53], v77 offset:12160
  ds_read_b64_tr_b16 v[54:55], v77 offset:12320
  s_waitcnt lgkmcnt(6)
  v_mfma_f32_32x32x16_bf16 v[192:207], v[44:47], v[20:23], v[192:207]
  ds_read_b128 v[16:19], v4 offset:640
  ds_read_b64_tr_b16 v[40:41], v77 offset:12800
  ds_read_b64_tr_b16 v[42:43], v77 offset:12960
  s_waitcnt lgkmcnt(6)
  v_mfma_f32_32x32x16_bf16 v[192:207], v[48:51], v[24:27], v[192:207]
  ds_read_b128 v[20:23], v5 offset:640
  ds_read_b64_tr_b16 v[44:45], v77 offset:13440
  ds_read_b64_tr_b16 v[46:47], v77 offset:13600
  s_waitcnt lgkmcnt(6)
  v_mfma_f32_32x32x16_bf16 v[192:207], v[52:55], v[28:31], v[192:207]
  ds_read_b128 v[24:27], v6 offset:640
  ds_read_b64_tr_b16 v[48:49], v77 offset:14080
  ds_read_b64_tr_b16 v[50:51], v77 offset:14240
  s_waitcnt lgkmcnt(6)
  v_mfma_f32_32x32x16_bf16 v[192:207], v[40:43], v[16:19], v[192:207]
  ds_read_b128 v[28:31], v7 offset:640
  ds_read_b64_tr_b16 v[52:53], v77 offset:14720
  ds_read_b64_tr_b16 v[54:55], v77 offset:14880
  s_waitcnt lgkmcnt(6)
  v_mfma_f32_32x32x16_bf16 v[192:207], v[44:47], v[20:23], v[192:207]
  ds_read_b128 v[16:19], v4 offset:768
  ds_read_b64_tr_b16 v[40:41], v77 offset:15360
  ds_read_b64_tr_b16 v[42:43], v77 offset:15520
  s_waitcnt lgkmcnt(6)
  v_mfma_f32_32x32x16_bf16 v[192:207], v[48:51], v[24:27], v[192:207]
  ds_read_b128 v[20:23], v5 offset:768
  ds_read_b64_tr_b16 v[44:45], v77 offset:16000
  ds_read_b64_tr_b16 v[46:47], v77 offset:16160
  s_waitcnt lgkmcnt(6)
  v_mfma_f32_32x32x16_bf16 v[192:207], v[52:55], v[28:31], v[192:207]
  ds_read_b128 v[24:27], v6 offset:768
  ds_read_b64_tr_b16 v[48:49], v77 offset:16640
  ds_read_b64_tr_b16 v[50:51], v77 offset:16800
  s_waitcnt lgkmcnt(6)
  v_mfma_f32_32x32x16_bf16 v[192:207], v[40:43], v[16:19], v[192:207]
  ds_read_b128 v[28:31], v7 offset:768
  ds_read_b64_tr_b16 v[52:53], v77 offset:17280
  ds_read_b64_tr_b16 v[54:55], v77 offset:17440
  s_waitcnt lgkmcnt(6)
  v_mfma_f32_32x32x16_bf16 v[192:207], v[44:47], v[20:23], v[192:207]
  ds_read_b128 v[16:19], v4 offset:896
  ds_read_b64_tr_b16 v[40:41], v77 offset:17920
  ds_read_b64_tr_b16 v[42:43], v77 offset:18080
  s_waitcnt lgkmcnt(6)
  v_mfma_f32_32x32x16_bf16 v[192:207], v[48:51], v[24:27], v[192:207]
  ds_read_b128 v[20:23], v5 offset:896
  ds_read_b64_tr_b16 v[44:45], v77 offset:18560
  ds_read_b64_tr_b16 v[46:47], v77 offset:18720
  s_waitcnt lgkmcnt(6)
  v_mfma_f32_32x32x16_bf16 v[192:207], v[52:55], v[28:31], v[192:207]
  ds_read_b128 v[24:27], v6 offset:896
  ds_read_b64_tr_b16 v[48:49], v77 offset:19200
  ds_read_b64_tr_b16 v[50:51], v77 offset:19360
  s_waitcnt lgkmcnt(6)
  v_mfma_f32_32x32x16_bf16 v[192:207], v[40:43], v[16:19], v[192:207]
  ds_read_b128 v[28:31], v7 offset:896
  ds_read_b64_tr_b16 v[52:53], v77 offset:19840
  ds_read_b64_tr_b16 v[54:55], v77 offset:20000
  s_waitcnt lgkmcnt(6)
  v_mfma_f32_32x32x16_bf16 v[192:207], v[44:47], v[20:23], v[192:207]
  ds_read_b128 v[16:19], v4 offset:1024
  ds_read_b64_tr_b16 v[40:41], v77 offset:20480
  ds_read_b64_tr_b16 v[42:43], v77 offset:20640
  s_waitcnt lgkmcnt(6)
  v_mfma_f32_32x32x16_bf16 v[192:207], v[48:51], v[24:27], v[192:207]
  ds_read_b128 v[20:23], v5 offset:1024
  ds_read_b64_tr_b16 v[44:45], v77 offset:21120
  ds_read_b64_tr_b16 v[46:47], v77 offset:21280
  s_waitcnt lgkmcnt(6)
  v_mfma_f32_32x32x16_bf16 v[192:207], v[52:55], v[28:31], v[192:207]
  ds_read_b128 v[24:27], v6 offset:1024
  ds_read_b64_tr_b16 v[48:49], v77 offset:21760
  ds_read_b64_tr_b16 v[50:51], v77 offset:21920
  s_waitcnt lgkmcnt(6)
  v_mfma_f32_32x32x16_bf16 v[192:207], v[40:43], v[16:19], v[192:207]
  ds_read_b128 v[28:31], v7 offset:1024
  ds_read_b64_tr_b16 v[52:53], v77 offset:22400
  ds_read_b64_tr_b16 v[54:55], v77 offset:22560
  s_waitcnt lgkmcnt(6)
  v_mfma_f32_32x32x16_bf16 v[192:207], v[44:47], v[20:23], v[192:207]
  s_waitcnt lgkmcnt(3)
  v_mfma_f32_32x32x16_bf16 v[192:207], v[48:51], v[24:27], v[192:207]
  s_waitcnt lgkmcnt(0)
  v_mfma_f32_32x32x16_bf16 v[192:207], v[52:55], v[28:31], v[192:207]
  s_waitcnt lgkmcnt(0)
  s_mov_b64 exec, 1
  ds_add_u32 v84, v85 offset:68
  s_mov_b64 exec, -1

  s_nop 7
  v_cvt_pk_bf16_f32 v208, v192, v193
  v_cvt_pk_bf16_f32 v209, v194, v195
  v_cvt_pk_bf16_f32 v210, v196, v197
  v_cvt_pk_bf16_f32 v211, v198, v199
  v_cvt_pk_bf16_f32 v212, v200, v201
  v_cndmask_b32 v212, 0, v212, s[42:43]
  v_mov_b32 v213, 0
  v_dot2_f32_bf16 v213, v208, v208, v213
  v_dot2_f32_bf16 v213, v209, v209, v213
  v_dot2_f32_bf16 v213, v210, v210, v213
  v_dot2_f32_bf16 v213, v211, v211, v213
  v_dot2_f32_bf16 v213, v212, v212, v213
  s_nop 3
  v_mov_b32 v214, v213
  s_nop 1
  v_permlane32_swap_b32 v213, v214
  s_nop 1
  v_add_f32 v213, v213, v214

  v_mov_b32 v83, 0x3f803f80
  v_cndmask_b32 v212, v83, v212, s[42:43]
  buffer_store_dwordx4 v[208:211], v78, s[20:23], s47 offen sc1
  buffer_store_dword v212, v79, s[20:23], s47 offen offset:3072 sc1

  v_max_f32_dpp v213, v213, v213 quad_perm:[1,0,3,2] row_mask:0xf bank_mask:0xf
  s_nop 1
  v_max_f32_dpp v213, v213, v213 quad_perm:[2,3,0,1] row_mask:0xf bank_mask:0xf
  s_nop 1
  v_max_f32_dpp v213, v213, v213 row_ror:4 row_mask:0xf bank_mask:0xf
  s_nop 1
  v_max_f32_dpp v213, v213, v213 row_ror:8 row_mask:0xf bank_mask:0xf
  s_nop 1
  ds_swizzle_b32 v214, v213 offset:16415
  s_waitcnt lgkmcnt(0)
  v_max_f32 v213, v213, v214
  s_lshl_b32 s46, s46, 2
  s_add_u32 s46, s46, 262144
  s_mov_b64 exec, 1
  buffer_store_dword v213, v80, s[20:23], s46 offen sc1
  s_mov_b64 exec, -1
  s_branch S_KVST

S_V:
  ds_read_b128 v[16:19], v4 offset:0
  ds_read_b64_tr_b16 v[40:41], v77 offset:0
  ds_read_b64_tr_b16 v[42:43], v77 offset:160
  ds_read_b128 v[20:23], v5 offset:0
  ds_read_b64_tr_b16 v[44:45], v77 offset:640
  ds_read_b64_tr_b16 v[46:47], v77 offset:800
  ds_read_b128 v[24:27], v6 offset:0
  ds_read_b64_tr_b16 v[48:49], v77 offset:1280
  ds_read_b64_tr_b16 v[50:51], v77 offset:1440
  s_waitcnt lgkmcnt(6)
  v_mfma_f32_32x32x16_bf16 v[192:207], v[16:19], v[40:43], 0
  ds_read_b128 v[28:31], v7 offset:0
  ds_read_b64_tr_b16 v[52:53], v77 offset:1920
  ds_read_b64_tr_b16 v[54:55], v77 offset:2080
  s_waitcnt lgkmcnt(6)
  v_mfma_f32_32x32x16_bf16 v[192:207], v[20:23], v[44:47], v[192:207]
  ds_read_b128 v[16:19], v4 offset:128
  ds_read_b64_tr_b16 v[40:41], v77 offset:2560
  ds_read_b64_tr_b16 v[42:43], v77 offset:2720
  s_waitcnt lgkmcnt(6)
  v_mfma_f32_32x32x16_bf16 v[192:207], v[24:27], v[48:51], v[192:207]
  ds_read_b128 v[20:23], v5 offset:128
  ds_read_b64_tr_b16 v[44:45], v77 offset:3200
  ds_read_b64_tr_b16 v[46:47], v77 offset:3360
  s_waitcnt lgkmcnt(6)
  v_mfma_f32_32x32x16_bf16 v[192:207], v[28:31], v[52:55], v[192:207]
  ds_read_b128 v[24:27], v6 offset:128
  ds_read_b64_tr_b16 v[48:49], v77 offset:3840
  ds_read_b64_tr_b16 v[50:51], v77 offset:4000
  s_waitcnt lgkmcnt(6)
  v_mfma_f32_32x32x16_bf16 v[192:207], v[16:19], v[40:43], v[192:207]
  ds_read_b128 v[28:31], v7 offset:128
  ds_read_b64_tr_b16 v[52:53], v77 offset:4480
  ds_read_b64_tr_b16 v[54:55], v77 offset:4640
  s_waitcnt lgkmcnt(6)
  v_mfma_f32_32x32x16_bf16 v[192:207], v[20:23], v[44:47], v[192:207]
  ds_read_b128 v[16:19], v4 offset:256
  ds_read_b64_tr_b16 v[40:41], v77 offset:5120
  ds_read_b64_tr_b16 v[42:43], v77 offset:5280
  s_waitcnt lgkmcnt(6)
  v_mfma_f32_32x32x16_bf16 v[192:207], v[24:27], v[48:51], v[192:207]
  ds_read_b128 v[20:23], v5 offset:256
  ds_read_b64_tr_b16 v[44:45], v77 offset:5760
  ds_read_b64_tr_b16 v[46:47], v77 offset:5920
  s_waitcnt lgkmcnt(6)
  v_mfma_f32_32x32x16_bf16 v[192:207], v[28:31], v[52:55], v[192:207]
  ds_read_b128 v[24:27], v6 offset:256
  ds_read_b64_tr_b16 v[48:49], v77 offset:6400
  ds_read_b64_tr_b16 v[50:51], v77 offset:6560
  s_waitcnt lgkmcnt(6)
  v_mfma_f32_32x32x16_bf16 v[192:207], v[16:19], v[40:43], v[192:207]
  ds_read_b128 v[28:31], v7 offset:256
  ds_read_b64_tr_b16 v[52:53], v77 offset:7040
  ds_read_b64_tr_b16 v[54:55], v77 offset:7200
  s_waitcnt lgkmcnt(6)
  v_mfma_f32_32x32x16_bf16 v[192:207], v[20:23], v[44:47], v[192:207]
  ds_read_b128 v[16:19], v4 offset:384
  ds_read_b64_tr_b16 v[40:41], v77 offset:7680
  ds_read_b64_tr_b16 v[42:43], v77 offset:7840
  s_waitcnt lgkmcnt(6)
  v_mfma_f32_32x32x16_bf16 v[192:207], v[24:27], v[48:51], v[192:207]
  ds_read_b128 v[20:23], v5 offset:384
  ds_read_b64_tr_b16 v[44:45], v77 offset:8320
  ds_read_b64_tr_b16 v[46:47], v77 offset:8480
  s_waitcnt lgkmcnt(6)
  v_mfma_f32_32x32x16_bf16 v[192:207], v[28:31], v[52:55], v[192:207]
  ds_read_b128 v[24:27], v6 offset:384
  ds_read_b64_tr_b16 v[48:49], v77 offset:8960
  ds_read_b64_tr_b16 v[50:51], v77 offset:9120
  s_waitcnt lgkmcnt(6)
  v_mfma_f32_32x32x16_bf16 v[192:207], v[16:19], v[40:43], v[192:207]
  ds_read_b128 v[28:31], v7 offset:384
  ds_read_b64_tr_b16 v[52:53], v77 offset:9600
  ds_read_b64_tr_b16 v[54:55], v77 offset:9760
  s_waitcnt lgkmcnt(6)
  v_mfma_f32_32x32x16_bf16 v[192:207], v[20:23], v[44:47], v[192:207]
  ds_read_b128 v[16:19], v4 offset:512
  ds_read_b64_tr_b16 v[40:41], v77 offset:10240
  ds_read_b64_tr_b16 v[42:43], v77 offset:10400
  s_waitcnt lgkmcnt(6)
  v_mfma_f32_32x32x16_bf16 v[192:207], v[24:27], v[48:51], v[192:207]
  ds_read_b128 v[20:23], v5 offset:512
  ds_read_b64_tr_b16 v[44:45], v77 offset:10880
  ds_read_b64_tr_b16 v[46:47], v77 offset:11040
  s_waitcnt lgkmcnt(6)
  v_mfma_f32_32x32x16_bf16 v[192:207], v[28:31], v[52:55], v[192:207]
  ds_read_b128 v[24:27], v6 offset:512
  ds_read_b64_tr_b16 v[48:49], v77 offset:11520
  ds_read_b64_tr_b16 v[50:51], v77 offset:11680
  s_waitcnt lgkmcnt(6)
  v_mfma_f32_32x32x16_bf16 v[192:207], v[16:19], v[40:43], v[192:207]
  ds_read_b128 v[28:31], v7 offset:512
  ds_read_b64_tr_b16 v[52:53], v77 offset:12160
  ds_read_b64_tr_b16 v[54:55], v77 offset:12320
  s_waitcnt lgkmcnt(6)
  v_mfma_f32_32x32x16_bf16 v[192:207], v[20:23], v[44:47], v[192:207]
  ds_read_b128 v[16:19], v4 offset:640
  ds_read_b64_tr_b16 v[40:41], v77 offset:12800
  ds_read_b64_tr_b16 v[42:43], v77 offset:12960
  s_waitcnt lgkmcnt(6)
  v_mfma_f32_32x32x16_bf16 v[192:207], v[24:27], v[48:51], v[192:207]
  ds_read_b128 v[20:23], v5 offset:640
  ds_read_b64_tr_b16 v[44:45], v77 offset:13440
  ds_read_b64_tr_b16 v[46:47], v77 offset:13600
  s_waitcnt lgkmcnt(6)
  v_mfma_f32_32x32x16_bf16 v[192:207], v[28:31], v[52:55], v[192:207]
  ds_read_b128 v[24:27], v6 offset:640
  ds_read_b64_tr_b16 v[48:49], v77 offset:14080
  ds_read_b64_tr_b16 v[50:51], v77 offset:14240
  s_waitcnt lgkmcnt(6)
  v_mfma_f32_32x32x16_bf16 v[192:207], v[16:19], v[40:43], v[192:207]
  ds_read_b128 v[28:31], v7 offset:640
  ds_read_b64_tr_b16 v[52:53], v77 offset:14720
  ds_read_b64_tr_b16 v[54:55], v77 offset:14880
  s_waitcnt lgkmcnt(6)
  v_mfma_f32_32x32x16_bf16 v[192:207], v[20:23], v[44:47], v[192:207]
  ds_read_b128 v[16:19], v4 offset:768
  ds_read_b64_tr_b16 v[40:41], v77 offset:15360
  ds_read_b64_tr_b16 v[42:43], v77 offset:15520
  s_waitcnt lgkmcnt(6)
  v_mfma_f32_32x32x16_bf16 v[192:207], v[24:27], v[48:51], v[192:207]
  ds_read_b128 v[20:23], v5 offset:768
  ds_read_b64_tr_b16 v[44:45], v77 offset:16000
  ds_read_b64_tr_b16 v[46:47], v77 offset:16160
  s_waitcnt lgkmcnt(6)
  v_mfma_f32_32x32x16_bf16 v[192:207], v[28:31], v[52:55], v[192:207]
  ds_read_b128 v[24:27], v6 offset:768
  ds_read_b64_tr_b16 v[48:49], v77 offset:16640
  ds_read_b64_tr_b16 v[50:51], v77 offset:16800
  s_waitcnt lgkmcnt(6)
  v_mfma_f32_32x32x16_bf16 v[192:207], v[16:19], v[40:43], v[192:207]
  ds_read_b128 v[28:31], v7 offset:768
  ds_read_b64_tr_b16 v[52:53], v77 offset:17280
  ds_read_b64_tr_b16 v[54:55], v77 offset:17440
  s_waitcnt lgkmcnt(6)
  v_mfma_f32_32x32x16_bf16 v[192:207], v[20:23], v[44:47], v[192:207]
  ds_read_b128 v[16:19], v4 offset:896
  ds_read_b64_tr_b16 v[40:41], v77 offset:17920
  ds_read_b64_tr_b16 v[42:43], v77 offset:18080
  s_waitcnt lgkmcnt(6)
  v_mfma_f32_32x32x16_bf16 v[192:207], v[24:27], v[48:51], v[192:207]
  ds_read_b128 v[20:23], v5 offset:896
  ds_read_b64_tr_b16 v[44:45], v77 offset:18560
  ds_read_b64_tr_b16 v[46:47], v77 offset:18720
  s_waitcnt lgkmcnt(6)
  v_mfma_f32_32x32x16_bf16 v[192:207], v[28:31], v[52:55], v[192:207]
  ds_read_b128 v[24:27], v6 offset:896
  ds_read_b64_tr_b16 v[48:49], v77 offset:19200
  ds_read_b64_tr_b16 v[50:51], v77 offset:19360
  s_waitcnt lgkmcnt(6)
  v_mfma_f32_32x32x16_bf16 v[192:207], v[16:19], v[40:43], v[192:207]
  ds_read_b128 v[28:31], v7 offset:896
  ds_read_b64_tr_b16 v[52:53], v77 offset:19840
  ds_read_b64_tr_b16 v[54:55], v77 offset:20000
  s_waitcnt lgkmcnt(6)
  v_mfma_f32_32x32x16_bf16 v[192:207], v[20:23], v[44:47], v[192:207]
  ds_read_b128 v[16:19], v4 offset:1024
  ds_read_b64_tr_b16 v[40:41], v77 offset:20480
  ds_read_b64_tr_b16 v[42:43], v77 offset:20640
  s_waitcnt lgkmcnt(6)
  v_mfma_f32_32x32x16_bf16 v[192:207], v[24:27], v[48:51], v[192:207]
  ds_read_b128 v[20:23], v5 offset:1024
  ds_read_b64_tr_b16 v[44:45], v77 offset:21120
  ds_read_b64_tr_b16 v[46:47], v77 offset:21280
  s_waitcnt lgkmcnt(6)
  v_mfma_f32_32x32x16_bf16 v[192:207], v[28:31], v[52:55], v[192:207]
  ds_read_b128 v[24:27], v6 offset:1024
  ds_read_b64_tr_b16 v[48:49], v77 offset:21760
  ds_read_b64_tr_b16 v[50:51], v77 offset:21920
  s_waitcnt lgkmcnt(6)
  v_mfma_f32_32x32x16_bf16 v[192:207], v[16:19], v[40:43], v[192:207]
  ds_read_b128 v[28:31], v7 offset:1024
  ds_read_b64_tr_b16 v[52:53], v77 offset:22400
  ds_read_b64_tr_b16 v[54:55], v77 offset:22560
  s_waitcnt lgkmcnt(6)
  v_mfma_f32_32x32x16_bf16 v[192:207], v[20:23], v[44:47], v[192:207]
  s_waitcnt lgkmcnt(3)
  v_mfma_f32_32x32x16_bf16 v[192:207], v[24:27], v[48:51], v[192:207]
  s_waitcnt lgkmcnt(0)
  v_mfma_f32_32x32x16_bf16 v[192:207], v[28:31], v[52:55], v[192:207]
  s_waitcnt lgkmcnt(0)
  s_mov_b64 exec, 1
  ds_add_u32 v84, v85 offset:68
  s_mov_b64 exec, -1

  v_and_b32 v83, 31, v1
  v_mov_b32 v81, 0x3f803f80
  v_cmp_eq_u32 s[40:41], 18, v83
  v_cmp_lt_u32 s[44:45], 18, v83
  s_nop 3

  v_cvt_pk_bf16_f32 v208, v192, v193
  v_cvt_pk_bf16_f32 v209, v194, v195
  v_cvt_pk_bf16_f32 v210, v196, v197
  v_cvt_pk_bf16_f32 v211, v198, v199
  v_cvt_pk_bf16_f32 v212, v200, v201
  v_cvt_pk_bf16_f32 v213, v202, v203
  v_cvt_pk_bf16_f32 v214, v204, v205
  v_cvt_pk_bf16_f32 v215, v206, v207
  v_cndmask_b32 v208, v208, v81, s[40:41]
  v_cndmask_b32 v209, v209, v81, s[40:41]
  v_cndmask_b32 v210, v210, v81, s[40:41]
  v_cndmask_b32 v211, v211, v81, s[40:41]
  v_cndmask_b32 v212, v212, v81, s[40:41]
  v_cndmask_b32 v213, v213, v81, s[40:41]
  v_cndmask_b32 v214, v214, v81, s[40:41]
  v_cndmask_b32 v215, v215, v81, s[40:41]
  v_cndmask_b32 v208, v208, 0, s[44:45]
  v_cndmask_b32 v209, v209, 0, s[44:45]
  v_cndmask_b32 v210, v210, 0, s[44:45]
  v_cndmask_b32 v211, v211, 0, s[44:45]
  v_cndmask_b32 v212, v212, 0, s[44:45]
  v_cndmask_b32 v213, v213, 0, s[44:45]
  v_cndmask_b32 v214, v214, 0, s[44:45]
  v_cndmask_b32 v215, v215, 0, s[44:45]
  buffer_store_dwordx4 v[208:211], v78, s[20:23], s47 offen offset:1024 sc1
  buffer_store_dwordx4 v[212:215], v78, s[20:23], s47 offen offset:2048 sc1

S_KVST:
  s_waitcnt vmcnt(0)
  s_mov_b64 exec, 1
  ds_add_rtn_u32 v83, v84, v85 offset:72
  s_waitcnt lgkmcnt(0)
  v_readfirstlane_b32 s46, v83
  s_cmp_lg_u32 s46, 1
  s_cbranch_scc1 S_FLD
  v_mov_b32 v83, 1
  s_cmp_lg_u32 s3, 0
  s_cbranch_scc1 S_FLV
  v_add_u32 v83, 1, v81
  v_cmp_eq_u32 s[40:41], 0, v83
  s_mov_b32 s46, 266240
  s_nop 0
  v_cndmask_b32 v83, v83, 1, s[40:41]
  s_nop 0
  buffer_store_dword v83, v80, s[20:23], s46 offen sc1

S_FLV:
  s_lshl_b32 s46, s28, 3
  s_lshl_b32 s47, s29, 2
  s_add_u32 s46, s46, s47
  v_mov_b32 v3, s46
  global_store_dword v3, v83, s[60:61] sc1

S_FLD:
  s_mov_b64 exec, -1
S_DONE:
  s_setprio 0
  v_and_b32 v17, 15, v1
  v_cmp_gt_u32 s[40:41], 8, v17
  s_mov_b32 s42, 0x3ae38e39

  s_waitcnt lgkmcnt(0)
  s_mov_b64 exec, 1
  ds_add_u32 v84, v85 offset:76
  s_mov_b64 exec, -1

  s_mov_b32 s39, 0x40000
WAITC_5:
  ds_read_b32 v15, v84 offset:52
  s_waitcnt lgkmcnt(0)
  v_readfirstlane_b32 s38, v15
  s_cmp_ge_u32 s38, 4
  s_cbranch_scc1 WAITD_6
  s_sleep 1
  s_sub_u32 s39, s39, 1
  s_cmp_lg_u32 s39, 0
  s_cbranch_scc1 WAITC_5

WAITD_6:
  ds_read_b64 v[56:57], v76 offset:0
  ds_read_b64 v[58:59], v76 offset:32
  ds_read_b64 v[60:61], v76 offset:64
  ds_read_b64 v[62:63], v76 offset:96
  s_waitcnt lgkmcnt(0)
  v_mul_f32 v56, s42, v56
  v_mul_f32 v58, s42, v58
  v_mul_f32 v60, s42, v60
  v_mul_f32 v62, s42, v62
  v_mul_f32 v64, v56, v56
  v_mul_f32 v65, v58, v58
  v_mul_f32 v66, v60, v60
  v_mul_f32 v67, v62, v62
  v_fma_f32 v57, v57, s42, -v64
  v_fma_f32 v59, v59, s42, -v65
  v_fma_f32 v61, v61, s42, -v66
  v_fma_f32 v63, v63, s42, -v67
  v_max_f32 v57, 0, v57
  v_max_f32 v59, 0, v59
  v_max_f32 v61, 0, v61
  v_max_f32 v63, 0, v63
  v_add_f32 v57, 0x3727c5ac, v57
  v_add_f32 v59, 0x3727c5ac, v59
  v_add_f32 v61, 0x3727c5ac, v61
  v_add_f32 v63, 0x3727c5ac, v63
  v_rsq_f32 v57, v57
  v_rsq_f32 v59, v59
  v_rsq_f32 v61, v61
  v_rsq_f32 v63, v63
  s_nop 0
  v_mul_f32 v56, v56, v57
  v_mul_f32 v58, v58, v59
  v_mul_f32 v60, v60, v61
  v_mul_f32 v62, v62, v63
  v_sub_f32 v56, 0, v56
  v_sub_f32 v58, 0, v58
  v_sub_f32 v60, 0, v60
  v_sub_f32 v62, 0, v62
  v_lshlrev_b32 v16, 16, v112
  v_and_b32 v17, 0xffff0000, v112
  v_lshlrev_b32 v18, 16, v113
  v_and_b32 v19, 0xffff0000, v113
  v_lshlrev_b32 v20, 16, v114
  v_and_b32 v21, 0xffff0000, v114
  v_lshlrev_b32 v22, 16, v115
  v_and_b32 v23, 0xffff0000, v115
  v_lshlrev_b32 v24, 16, v116
  v_and_b32 v25, 0xffff0000, v116
  v_lshlrev_b32 v26, 16, v117
  v_and_b32 v27, 0xffff0000, v117
  v_lshlrev_b32 v28, 16, v118
  v_and_b32 v29, 0xffff0000, v118
  v_lshlrev_b32 v30, 16, v119
  v_and_b32 v31, 0xffff0000, v119
  v_lshlrev_b32 v32, 16, v120
  v_and_b32 v33, 0xffff0000, v120
  v_lshlrev_b32 v34, 16, v121
  v_and_b32 v35, 0xffff0000, v121
  v_lshlrev_b32 v36, 16, v122
  v_and_b32 v37, 0xffff0000, v122
  v_lshlrev_b32 v38, 16, v123
  v_and_b32 v39, 0xffff0000, v123
  v_lshlrev_b32 v40, 16, v124
  v_and_b32 v41, 0xffff0000, v124
  v_lshlrev_b32 v42, 16, v125
  v_and_b32 v43, 0xffff0000, v125
  v_lshlrev_b32 v44, 16, v126
  v_and_b32 v45, 0xffff0000, v126
  v_lshlrev_b32 v46, 16, v127
  v_and_b32 v47, 0xffff0000, v127
  v_lshlrev_b32 v48, 16, v128
  v_and_b32 v49, 0xffff0000, v128
  v_lshlrev_b32 v50, 16, v129
  v_and_b32 v51, 0xffff0000, v129
  v_lshlrev_b32 v52, 16, v130
  v_and_b32 v53, 0xffff0000, v130
  v_lshlrev_b32 v54, 16, v131
  v_and_b32 v55, 0xffff0000, v131
  v_fma_f32 v16, v16, v57, v56
  v_fma_f32 v17, v17, v57, v56
  v_fma_f32 v18, v18, v57, v56
  v_fma_f32 v19, v19, v57, v56
  v_fma_f32 v20, v20, v57, v56
  v_fma_f32 v21, v21, v57, v56
  v_fma_f32 v22, v22, v57, v56
  v_fma_f32 v23, v23, v57, v56
  v_fma_f32 v24, v24, v57, v56
  v_fma_f32 v25, v25, v57, v56
  v_fma_f32 v26, v26, v57, v56
  v_fma_f32 v27, v27, v57, v56
  v_fma_f32 v28, v28, v57, v56
  v_fma_f32 v29, v29, v57, v56
  v_fma_f32 v30, v30, v57, v56
  v_fma_f32 v31, v31, v57, v56
  v_fma_f32 v32, v32, v57, v56
  v_fma_f32 v33, v33, v57, v56
  v_fma_f32 v34, v34, v57, v56
  v_fma_f32 v35, v35, v57, v56
  v_fma_f32 v36, v36, v57, v56
  v_fma_f32 v37, v37, v57, v56
  v_fma_f32 v38, v38, v57, v56
  v_fma_f32 v39, v39, v57, v56
  v_fma_f32 v40, v40, v57, v56
  v_fma_f32 v41, v41, v57, v56
  v_fma_f32 v42, v42, v57, v56
  v_fma_f32 v43, v43, v57, v56
  v_fma_f32 v44, v44, v57, v56
  v_fma_f32 v45, v45, v57, v56
  v_fma_f32 v46, v46, v57, v56
  v_fma_f32 v47, v47, v57, v56
  v_fma_f32 v48, v48, v57, v56
  v_fma_f32 v49, v49, v57, v56
  v_fma_f32 v50, v50, v57, v56
  v_fma_f32 v51, v51, v57, v56
  v_fma_f32 v52, v52, v57, v56
  v_fma_f32 v53, v53, v57, v56
  v_fma_f32 v54, v54, v57, v56
  v_fma_f32 v55, v55, v57, v56
  v_cvt_pk_bf16_f32 v112, v16, v17
  v_cvt_pk_bf16_f32 v113, v18, v19
  v_cvt_pk_bf16_f32 v114, v20, v21
  v_cvt_pk_bf16_f32 v115, v22, v23
  v_cvt_pk_bf16_f32 v116, v24, v25
  v_cvt_pk_bf16_f32 v117, v26, v27
  v_cvt_pk_bf16_f32 v118, v28, v29
  v_cvt_pk_bf16_f32 v119, v30, v31
  v_cvt_pk_bf16_f32 v120, v32, v33
  v_cvt_pk_bf16_f32 v121, v34, v35
  v_cvt_pk_bf16_f32 v122, v36, v37
  v_cvt_pk_bf16_f32 v123, v38, v39
  v_cvt_pk_bf16_f32 v124, v40, v41
  v_cvt_pk_bf16_f32 v125, v42, v43
  v_cvt_pk_bf16_f32 v126, v44, v45
  v_cvt_pk_bf16_f32 v127, v46, v47
  v_cvt_pk_bf16_f32 v128, v48, v49
  v_cvt_pk_bf16_f32 v129, v50, v51
  v_cvt_pk_bf16_f32 v130, v52, v53
  v_cvt_pk_bf16_f32 v131, v54, v55
  v_lshlrev_b32 v16, 16, v132
  v_and_b32 v17, 0xffff0000, v132
  v_lshlrev_b32 v18, 16, v133
  v_and_b32 v19, 0xffff0000, v133
  v_lshlrev_b32 v20, 16, v134
  v_and_b32 v21, 0xffff0000, v134
  v_lshlrev_b32 v22, 16, v135
  v_and_b32 v23, 0xffff0000, v135
  v_lshlrev_b32 v24, 16, v136
  v_and_b32 v25, 0xffff0000, v136
  v_lshlrev_b32 v26, 16, v137
  v_and_b32 v27, 0xffff0000, v137
  v_lshlrev_b32 v28, 16, v138
  v_and_b32 v29, 0xffff0000, v138
  v_lshlrev_b32 v30, 16, v139
  v_and_b32 v31, 0xffff0000, v139
  v_lshlrev_b32 v32, 16, v140
  v_and_b32 v33, 0xffff0000, v140
  v_lshlrev_b32 v34, 16, v141
  v_and_b32 v35, 0xffff0000, v141
  v_lshlrev_b32 v36, 16, v142
  v_and_b32 v37, 0xffff0000, v142
  v_lshlrev_b32 v38, 16, v143
  v_and_b32 v39, 0xffff0000, v143
  v_lshlrev_b32 v40, 16, v144
  v_and_b32 v41, 0xffff0000, v144
  v_lshlrev_b32 v42, 16, v145
  v_and_b32 v43, 0xffff0000, v145
  v_lshlrev_b32 v44, 16, v146
  v_and_b32 v45, 0xffff0000, v146
  v_lshlrev_b32 v46, 16, v147
  v_and_b32 v47, 0xffff0000, v147
  v_lshlrev_b32 v48, 16, v148
  v_and_b32 v49, 0xffff0000, v148
  v_lshlrev_b32 v50, 16, v149
  v_and_b32 v51, 0xffff0000, v149
  v_lshlrev_b32 v52, 16, v150
  v_and_b32 v53, 0xffff0000, v150
  v_lshlrev_b32 v54, 16, v151
  v_and_b32 v55, 0xffff0000, v151
  v_fma_f32 v16, v16, v59, v58
  v_fma_f32 v17, v17, v59, v58
  v_fma_f32 v18, v18, v59, v58
  v_fma_f32 v19, v19, v59, v58
  v_fma_f32 v20, v20, v59, v58
  v_fma_f32 v21, v21, v59, v58
  v_fma_f32 v22, v22, v59, v58
  v_fma_f32 v23, v23, v59, v58
  v_fma_f32 v24, v24, v59, v58
  v_fma_f32 v25, v25, v59, v58
  v_fma_f32 v26, v26, v59, v58
  v_fma_f32 v27, v27, v59, v58
  v_fma_f32 v28, v28, v59, v58
  v_fma_f32 v29, v29, v59, v58
  v_fma_f32 v30, v30, v59, v58
  v_fma_f32 v31, v31, v59, v58
  v_fma_f32 v32, v32, v59, v58
  v_fma_f32 v33, v33, v59, v58
  v_fma_f32 v34, v34, v59, v58
  v_fma_f32 v35, v35, v59, v58
  v_fma_f32 v36, v36, v59, v58
  v_fma_f32 v37, v37, v59, v58
  v_fma_f32 v38, v38, v59, v58
  v_fma_f32 v39, v39, v59, v58
  v_fma_f32 v40, v40, v59, v58
  v_fma_f32 v41, v41, v59, v58
  v_fma_f32 v42, v42, v59, v58
  v_fma_f32 v43, v43, v59, v58
  v_fma_f32 v44, v44, v59, v58
  v_fma_f32 v45, v45, v59, v58
  v_fma_f32 v46, v46, v59, v58
  v_fma_f32 v47, v47, v59, v58
  v_fma_f32 v48, v48, v59, v58
  v_fma_f32 v49, v49, v59, v58
  v_fma_f32 v50, v50, v59, v58
  v_fma_f32 v51, v51, v59, v58
  v_fma_f32 v52, v52, v59, v58
  v_fma_f32 v53, v53, v59, v58
  v_fma_f32 v54, v54, v59, v58
  v_fma_f32 v55, v55, v59, v58
  v_cvt_pk_bf16_f32 v132, v16, v17
  v_cvt_pk_bf16_f32 v133, v18, v19
  v_cvt_pk_bf16_f32 v134, v20, v21
  v_cvt_pk_bf16_f32 v135, v22, v23
  v_cvt_pk_bf16_f32 v136, v24, v25
  v_cvt_pk_bf16_f32 v137, v26, v27
  v_cvt_pk_bf16_f32 v138, v28, v29
  v_cvt_pk_bf16_f32 v139, v30, v31
  v_cvt_pk_bf16_f32 v140, v32, v33
  v_cvt_pk_bf16_f32 v141, v34, v35
  v_cvt_pk_bf16_f32 v142, v36, v37
  v_cvt_pk_bf16_f32 v143, v38, v39
  v_cvt_pk_bf16_f32 v144, v40, v41
  v_cvt_pk_bf16_f32 v145, v42, v43
  v_cvt_pk_bf16_f32 v146, v44, v45
  v_cvt_pk_bf16_f32 v147, v46, v47
  v_cvt_pk_bf16_f32 v148, v48, v49
  v_cvt_pk_bf16_f32 v149, v50, v51
  v_cvt_pk_bf16_f32 v150, v52, v53
  v_cvt_pk_bf16_f32 v151, v54, v55
  v_lshlrev_b32 v16, 16, v152
  v_and_b32 v17, 0xffff0000, v152
  v_lshlrev_b32 v18, 16, v153
  v_and_b32 v19, 0xffff0000, v153
  v_lshlrev_b32 v20, 16, v154
  v_and_b32 v21, 0xffff0000, v154
  v_lshlrev_b32 v22, 16, v155
  v_and_b32 v23, 0xffff0000, v155
  v_lshlrev_b32 v24, 16, v156
  v_and_b32 v25, 0xffff0000, v156
  v_lshlrev_b32 v26, 16, v157
  v_and_b32 v27, 0xffff0000, v157
  v_lshlrev_b32 v28, 16, v158
  v_and_b32 v29, 0xffff0000, v158
  v_lshlrev_b32 v30, 16, v159
  v_and_b32 v31, 0xffff0000, v159
  v_lshlrev_b32 v32, 16, v160
  v_and_b32 v33, 0xffff0000, v160
  v_lshlrev_b32 v34, 16, v161
  v_and_b32 v35, 0xffff0000, v161
  v_lshlrev_b32 v36, 16, v162
  v_and_b32 v37, 0xffff0000, v162
  v_lshlrev_b32 v38, 16, v163
  v_and_b32 v39, 0xffff0000, v163
  v_lshlrev_b32 v40, 16, v164
  v_and_b32 v41, 0xffff0000, v164
  v_lshlrev_b32 v42, 16, v165
  v_and_b32 v43, 0xffff0000, v165
  v_lshlrev_b32 v44, 16, v166
  v_and_b32 v45, 0xffff0000, v166
  v_lshlrev_b32 v46, 16, v167
  v_and_b32 v47, 0xffff0000, v167
  v_lshlrev_b32 v48, 16, v168
  v_and_b32 v49, 0xffff0000, v168
  v_lshlrev_b32 v50, 16, v169
  v_and_b32 v51, 0xffff0000, v169
  v_lshlrev_b32 v52, 16, v170
  v_and_b32 v53, 0xffff0000, v170
  v_lshlrev_b32 v54, 16, v171
  v_and_b32 v55, 0xffff0000, v171
  v_fma_f32 v16, v16, v61, v60
  v_fma_f32 v17, v17, v61, v60
  v_fma_f32 v18, v18, v61, v60
  v_fma_f32 v19, v19, v61, v60
  v_fma_f32 v20, v20, v61, v60
  v_fma_f32 v21, v21, v61, v60
  v_fma_f32 v22, v22, v61, v60
  v_fma_f32 v23, v23, v61, v60
  v_fma_f32 v24, v24, v61, v60
  v_fma_f32 v25, v25, v61, v60
  v_fma_f32 v26, v26, v61, v60
  v_fma_f32 v27, v27, v61, v60
  v_fma_f32 v28, v28, v61, v60
  v_fma_f32 v29, v29, v61, v60
  v_fma_f32 v30, v30, v61, v60
  v_fma_f32 v31, v31, v61, v60
  v_fma_f32 v32, v32, v61, v60
  v_fma_f32 v33, v33, v61, v60
  v_fma_f32 v34, v34, v61, v60
  v_fma_f32 v35, v35, v61, v60
  v_fma_f32 v36, v36, v61, v60
  v_fma_f32 v37, v37, v61, v60
  v_fma_f32 v38, v38, v61, v60
  v_fma_f32 v39, v39, v61, v60
  v_fma_f32 v40, v40, v61, v60
  v_fma_f32 v41, v41, v61, v60
  v_fma_f32 v42, v42, v61, v60
  v_fma_f32 v43, v43, v61, v60
  v_fma_f32 v44, v44, v61, v60
  v_fma_f32 v45, v45, v61, v60
  v_fma_f32 v46, v46, v61, v60
  v_fma_f32 v47, v47, v61, v60
  v_fma_f32 v48, v48, v61, v60
  v_fma_f32 v49, v49, v61, v60
  v_fma_f32 v50, v50, v61, v60
  v_fma_f32 v51, v51, v61, v60
  v_fma_f32 v52, v52, v61, v60
  v_fma_f32 v53, v53, v61, v60
  v_fma_f32 v54, v54, v61, v60
  v_fma_f32 v55, v55, v61, v60
  v_cvt_pk_bf16_f32 v152, v16, v17
  v_cvt_pk_bf16_f32 v153, v18, v19
  v_cvt_pk_bf16_f32 v154, v20, v21
  v_cvt_pk_bf16_f32 v155, v22, v23
  v_cvt_pk_bf16_f32 v156, v24, v25
  v_cvt_pk_bf16_f32 v157, v26, v27
  v_cvt_pk_bf16_f32 v158, v28, v29
  v_cvt_pk_bf16_f32 v159, v30, v31
  v_cvt_pk_bf16_f32 v160, v32, v33
  v_cvt_pk_bf16_f32 v161, v34, v35
  v_cvt_pk_bf16_f32 v162, v36, v37
  v_cvt_pk_bf16_f32 v163, v38, v39
  v_cvt_pk_bf16_f32 v164, v40, v41
  v_cvt_pk_bf16_f32 v165, v42, v43
  v_cvt_pk_bf16_f32 v166, v44, v45
  v_cvt_pk_bf16_f32 v167, v46, v47
  v_cvt_pk_bf16_f32 v168, v48, v49
  v_cvt_pk_bf16_f32 v169, v50, v51
  v_cvt_pk_bf16_f32 v170, v52, v53
  v_cvt_pk_bf16_f32 v171, v54, v55
  v_lshlrev_b32 v16, 16, v172
  v_and_b32 v17, 0xffff0000, v172
  v_lshlrev_b32 v18, 16, v173
  v_and_b32 v19, 0xffff0000, v173
  v_lshlrev_b32 v20, 16, v174
  v_and_b32 v21, 0xffff0000, v174
  v_lshlrev_b32 v22, 16, v175
  v_and_b32 v23, 0xffff0000, v175
  v_lshlrev_b32 v24, 16, v176
  v_and_b32 v25, 0xffff0000, v176
  v_lshlrev_b32 v26, 16, v177
  v_and_b32 v27, 0xffff0000, v177
  v_lshlrev_b32 v28, 16, v178
  v_and_b32 v29, 0xffff0000, v178
  v_lshlrev_b32 v30, 16, v179
  v_and_b32 v31, 0xffff0000, v179
  v_lshlrev_b32 v32, 16, v180
  v_and_b32 v33, 0xffff0000, v180
  v_lshlrev_b32 v34, 16, v181
  v_and_b32 v35, 0xffff0000, v181
  v_lshlrev_b32 v36, 16, v182
  v_and_b32 v37, 0xffff0000, v182
  v_lshlrev_b32 v38, 16, v183
  v_and_b32 v39, 0xffff0000, v183
  v_lshlrev_b32 v40, 16, v184
  v_and_b32 v41, 0xffff0000, v184
  v_lshlrev_b32 v42, 16, v185
  v_and_b32 v43, 0xffff0000, v185
  v_lshlrev_b32 v44, 16, v186
  v_and_b32 v45, 0xffff0000, v186
  v_lshlrev_b32 v46, 16, v187
  v_and_b32 v47, 0xffff0000, v187
  v_lshlrev_b32 v48, 16, v188
  v_and_b32 v49, 0xffff0000, v188
  v_lshlrev_b32 v50, 16, v189
  v_and_b32 v51, 0xffff0000, v189
  v_lshlrev_b32 v52, 16, v190
  v_and_b32 v53, 0xffff0000, v190
  v_lshlrev_b32 v54, 16, v191
  v_and_b32 v55, 0xffff0000, v191
  v_fma_f32 v16, v16, v63, v62
  v_fma_f32 v17, v17, v63, v62
  v_fma_f32 v18, v18, v63, v62
  v_fma_f32 v19, v19, v63, v62
  v_fma_f32 v20, v20, v63, v62
  v_fma_f32 v21, v21, v63, v62
  v_fma_f32 v22, v22, v63, v62
  v_fma_f32 v23, v23, v63, v62
  v_fma_f32 v24, v24, v63, v62
  v_fma_f32 v25, v25, v63, v62
  v_fma_f32 v26, v26, v63, v62
  v_fma_f32 v27, v27, v63, v62
  v_fma_f32 v28, v28, v63, v62
  v_fma_f32 v29, v29, v63, v62
  v_fma_f32 v30, v30, v63, v62
  v_fma_f32 v31, v31, v63, v62
  v_fma_f32 v32, v32, v63, v62
  v_fma_f32 v33, v33, v63, v62
  v_fma_f32 v34, v34, v63, v62
  v_fma_f32 v35, v35, v63, v62
  v_fma_f32 v36, v36, v63, v62
  v_fma_f32 v37, v37, v63, v62
  v_fma_f32 v38, v38, v63, v62
  v_fma_f32 v39, v39, v63, v62
  v_fma_f32 v40, v40, v63, v62
  v_fma_f32 v41, v41, v63, v62
  v_fma_f32 v42, v42, v63, v62
  v_fma_f32 v43, v43, v63, v62
  v_fma_f32 v44, v44, v63, v62
  v_fma_f32 v45, v45, v63, v62
  v_fma_f32 v46, v46, v63, v62
  v_fma_f32 v47, v47, v63, v62
  v_fma_f32 v48, v48, v63, v62
  v_fma_f32 v49, v49, v63, v62
  v_fma_f32 v50, v50, v63, v62
  v_fma_f32 v51, v51, v63, v62
  v_fma_f32 v52, v52, v63, v62
  v_fma_f32 v53, v53, v63, v62
  v_fma_f32 v54, v54, v63, v62
  v_fma_f32 v55, v55, v63, v62
  v_cvt_pk_bf16_f32 v172, v16, v17
  v_cvt_pk_bf16_f32 v173, v18, v19
  v_cvt_pk_bf16_f32 v174, v20, v21
  v_cvt_pk_bf16_f32 v175, v22, v23
  v_cvt_pk_bf16_f32 v176, v24, v25
  v_cvt_pk_bf16_f32 v177, v26, v27
  v_cvt_pk_bf16_f32 v178, v28, v29
  v_cvt_pk_bf16_f32 v179, v30, v31
  v_cvt_pk_bf16_f32 v180, v32, v33
  v_cvt_pk_bf16_f32 v181, v34, v35
  v_cvt_pk_bf16_f32 v182, v36, v37
  v_cvt_pk_bf16_f32 v183, v38, v39
  v_cvt_pk_bf16_f32 v184, v40, v41
  v_cvt_pk_bf16_f32 v185, v42, v43
  v_cvt_pk_bf16_f32 v186, v44, v45
  v_cvt_pk_bf16_f32 v187, v46, v47
  v_cvt_pk_bf16_f32 v188, v48, v49
  v_cvt_pk_bf16_f32 v189, v50, v51
  v_cvt_pk_bf16_f32 v190, v52, v53
  v_cvt_pk_bf16_f32 v191, v54, v55
  s_mov_b32 s39, 0x40000
WAITC_7:
  ds_read_b32 v15, v84 offset:76
  s_waitcnt lgkmcnt(0)
  v_readfirstlane_b32 s38, v15
  s_cmp_ge_u32 s38, 8
  s_cbranch_scc1 WAITD_8
  s_sleep 1
  s_sub_u32 s39, s39, 1
  s_cmp_lg_u32 s39, 0
  s_cbranch_scc1 WAITC_7

WAITD_8:
  ds_write_b128 v72, v[112:115] offset:0
  ds_write_b128 v72, v[116:119] offset:256
  ds_write_b128 v72, v[120:123] offset:512
  ds_write_b128 v72, v[124:127] offset:768
  s_mov_b64 exec, s[40:41]
  ds_write_b128 v72, v[128:131] offset:1024
  s_mov_b64 exec, -1
  ds_write_b128 v72, v[132:135] offset:4608
  ds_write_b128 v72, v[136:139] offset:4864
  ds_write_b128 v72, v[140:143] offset:5120
  ds_write_b128 v72, v[144:147] offset:5376
  s_mov_b64 exec, s[40:41]
  ds_write_b128 v72, v[148:151] offset:5632
  s_mov_b64 exec, -1
  ds_write_b128 v72, v[152:155] offset:9216
  ds_write_b128 v72, v[156:159] offset:9472
  ds_write_b128 v72, v[160:163] offset:9728
  ds_write_b128 v72, v[164:167] offset:9984
  s_mov_b64 exec, s[40:41]
  ds_write_b128 v72, v[168:171] offset:10240
  s_mov_b64 exec, -1
  ds_write_b128 v72, v[172:175] offset:13824
  ds_write_b128 v72, v[176:179] offset:14080
  ds_write_b128 v72, v[180:183] offset:14336
  ds_write_b128 v72, v[184:187] offset:14592
  s_mov_b64 exec, s[40:41]
  ds_write_b128 v72, v[188:191] offset:14848
  s_mov_b64 exec, -1
  s_waitcnt lgkmcnt(0)
  s_mov_b64 exec, 1
  ds_add_u32 v84, v85 offset:0
  s_mov_b64 exec, -1

  v_and_b32 v16, 31, v1
  v_mul_u32_u24 v17, 1152, v16
  v_bfe_u32 v18, v16, 1, 3
  v_lshrrev_b32 v19, 5, v1

  v_add_u32 v20, 0, v19
  v_xor_b32 v20, v20, v18
  v_lshl_add_u32 v2, v20, 4, v17
  v_add_u32 v20, 2, v19
  v_xor_b32 v20, v20, v18
  v_lshl_add_u32 v3, v20, 4, v17
  v_add_u32 v20, 4, v19
  v_xor_b32 v20, v20, v18
  v_lshl_add_u32 v4, v20, 4, v17
  v_add_u32 v20, 6, v19
  v_xor_b32 v20, v20, v18
  v_lshl_add_u32 v5, v20, 4, v17
  v_and_b32 v16, 15, v1
  v_mul_u32_u24 v17, 1152, v16
  v_bfe_u32 v18, v16, 1, 3
  v_lshrrev_b32 v19, 4, v1

  v_add_u32 v20, 0, v19
  v_xor_b32 v20, v20, v18
  v_lshl_add_u32 v6, v20, 4, v17
  v_add_u32 v20, 4, v19
  v_xor_b32 v20, v20, v18
  v_lshl_add_u32 v7, v20, 4, v17
  s_waitcnt vmcnt(0)
  v_mov_b32 v16, v100
  v_mov_b32 v17, 0
  v_mov_b32 v18, 0
  v_mov_b32 v19, 0
  v_mov_b32 v20, v101
  v_mov_b32 v21, 0
  v_mov_b32 v22, 0
  v_mov_b32 v23, 0
  v_mov_b32 v24, v102
  v_mov_b32 v25, 0
  v_mov_b32 v26, 0
  v_mov_b32 v27, 0
  v_mov_b32 v28, v103
  v_mov_b32 v29, 0
  v_mov_b32 v30, 0
  v_mov_b32 v31, 0
  v_mov_b32 v64, v104
  v_mov_b32 v65, 0
  v_mov_b32 v66, 0
  v_mov_b32 v67, 0
  v_mov_b32 v15, 0x3f80
  v_cmp_gt_u32 vcc, 32, v1
  v_mov_b32 v33, 0
  v_mov_b32 v34, 0
  v_cndmask_b32 v32, 0, v15, vcc
  v_mov_b32 v35, 0
  v_cmp_gt_u32 vcc, 16, v1
  v_mov_b32 v69, 0
  v_mov_b32 v70, 0
  v_cndmask_b32 v68, 0, v15, vcc
  v_mov_b32 v71, 0
  s_nop 1

  v_mfma_f32_32x32x16_bf16 v[112:127], v[16:19], v[32:35], 0
  v_mfma_f32_32x32x16_bf16 v[128:143], v[16:19], v[32:35], 0
  v_mfma_f32_32x32x16_bf16 v[144:159], v[20:23], v[32:35], 0
  v_mfma_f32_32x32x16_bf16 v[160:175], v[20:23], v[32:35], 0
  v_mfma_f32_32x32x16_bf16 v[176:191], v[24:27], v[32:35], 0
  v_mfma_f32_32x32x16_bf16 v[192:207], v[24:27], v[32:35], 0
  v_mfma_f32_32x32x16_bf16 v[208:223], v[28:31], v[32:35], 0
  v_mfma_f32_32x32x16_bf16 v[224:239], v[28:31], v[32:35], 0
  v_mfma_f32_16x16x32_bf16 v[240:243], v[64:67], v[68:71], 0
  v_mfma_f32_16x16x32_bf16 v[244:247], v[64:67], v[68:71], 0
  v_mfma_f32_16x16x32_bf16 v[248:251], v[64:67], v[68:71], 0
  v_mfma_f32_16x16x32_bf16 v[252:255], v[64:67], v[68:71], 0
  s_mov_b32 s39, 0x40000
WAITC_9:
  ds_read_b32 v15, v84 offset:44
  s_waitcnt lgkmcnt(0)
  v_readfirstlane_b32 s38, v15
  s_cmp_ge_u32 s38, 4
  s_cbranch_scc1 WAITD_10
  s_sleep 1
  s_sub_u32 s39, s39, 1
  s_cmp_lg_u32 s39, 0
  s_cbranch_scc1 WAITC_9

WAITD_10:
  s_add_u32 m0, s33, 0
  s_nop 0
  buffer_load_dwordx4 v13, s[4:7], s31 offen lds
  s_add_u32 s31, s31, s32
  s_add_u32 m0, s33, 1024
  s_nop 0
  buffer_load_dwordx4 v13, s[4:7], s31 offen lds
  s_add_u32 s31, s31, s32
  s_add_u32 m0, s33, 2048
  s_nop 0
  buffer_load_dwordx4 v13, s[4:7], s31 offen lds
  s_add_u32 s31, s31, s32
  s_add_u32 m0, s33, 3072
  s_nop 0
  buffer_load_dwordx4 v13, s[4:7], s31 offen lds
  s_add_u32 s31, s31, s32
  s_add_u32 m0, s33, 4096
  s_nop 0
  buffer_load_dwordx4 v13, s[4:7], s31 offen lds
  s_add_u32 s31, s31, s32
  s_add_u32 m0, s33, 5120
  s_nop 0
  buffer_load_dwordx4 v13, s[4:7], s31 offen lds
  s_add_u32 s31, s31, s32
  s_add_u32 m0, s33, 6144
  s_nop 0
  buffer_load_dwordx4 v13, s[4:7], s31 offen lds
  s_add_u32 s31, s31, s32
  s_add_u32 m0, s33, 7168
  s_nop 0
  buffer_load_dwordx4 v13, s[4:7], s31 offen lds
  s_add_u32 s31, s31, s32
  s_add_u32 m0, s33, 8192
  s_lshl_b32 s35, s32, 3
  s_sub_u32 s35, s31, s35
  buffer_load_dwordx4 v14, s[4:7], s35 offen lds
  s_mov_b32 s39, 0x40000
WAITC_11:
  ds_read_b32 v15, v84 offset:0
  s_waitcnt lgkmcnt(0)
  v_readfirstlane_b32 s38, v15
  s_cmp_ge_u32 s38, 4
  s_cbranch_scc1 WAITD_12
  s_sleep 1
  s_sub_u32 s39, s39, 1
  s_cmp_lg_u32 s39, 0
  s_cbranch_scc1 WAITC_11

WAITD_12:
  s_waitcnt vmcnt(0)
  ds_read_b128 v[32:35], v2 offset:0
  ds_read_b128 v[36:39], v2 offset:36864
  ds_read_b64_tr_b16 v[16:17], v8 offset:0
  ds_read_b64_tr_b16 v[18:19], v8 offset:1024
  ds_read_b64_tr_b16 v[20:21], v9 offset:0
  ds_read_b64_tr_b16 v[22:23], v9 offset:1024
  ds_read_b64_tr_b16 v[24:25], v10 offset:0
  ds_read_b64_tr_b16 v[26:27], v10 offset:1024
  ds_read_b64_tr_b16 v[28:29], v11 offset:0
  ds_read_b64_tr_b16 v[30:31], v11 offset:1024
  s_add_u32 m0, s33, 36864
  s_nop 0
  buffer_load_dwordx4 v13, s[4:7], s31 offen lds
  s_add_u32 s31, s31, s32
  s_add_u32 m0, s33, 37888
  s_nop 0
  buffer_load_dwordx4 v13, s[4:7], s31 offen lds
  s_add_u32 s31, s31, s32
  s_add_u32 m0, s33, 38912
  s_nop 0
  buffer_load_dwordx4 v13, s[4:7], s31 offen lds
  s_add_u32 s31, s31, s32
  s_add_u32 m0, s33, 39936
  s_nop 0
  buffer_load_dwordx4 v13, s[4:7], s31 offen lds
  s_add_u32 s31, s31, s32
  s_add_u32 m0, s33, 40960
  s_nop 0
  buffer_load_dwordx4 v13, s[4:7], s31 offen lds
  s_add_u32 s31, s31, s32
  s_add_u32 m0, s33, 41984
  s_nop 0
  buffer_load_dwordx4 v13, s[4:7], s31 offen lds
  s_add_u32 s31, s31, s32
  s_add_u32 m0, s33, 43008
  s_nop 0
  buffer_load_dwordx4 v13, s[4:7], s31 offen lds
  s_add_u32 s31, s31, s32
  s_add_u32 m0, s33, 44032
  s_nop 0
  buffer_load_dwordx4 v13, s[4:7], s31 offen lds
  s_add_u32 s31, s31, s32
  s_add_u32 m0, s33, 45056
  s_lshl_b32 s35, s32, 3
  s_sub_u32 s35, s31, s35
  buffer_load_dwordx4 v14, s[4:7], s35 offen lds
  s_mov_b32 s34, 8
.p2align 6
G1_LOOP:
  s_waitcnt vmcnt(9) lgkmcnt(0)
  v_mfma_f32_32x32x16_bf16 v[112:127], v[16:19], v[32:35], v[112:127]
  ds_read_b128 v[56:59], v3 offset:0
  ds_read_b128 v[60:63], v3 offset:36864
  ds_read_b64_tr_b16 v[40:41], v8 offset:4096
  v_mfma_f32_32x32x16_bf16 v[128:143], v[16:19], v[36:39], v[128:143]
  ds_read_b64_tr_b16 v[42:43], v8 offset:5120
  ds_read_b64_tr_b16 v[44:45], v9 offset:4096
  ds_read_b64_tr_b16 v[46:47], v9 offset:5120
  v_mfma_f32_32x32x16_bf16 v[144:159], v[20:23], v[32:35], v[144:159]
  ds_read_b64_tr_b16 v[48:49], v10 offset:4096
  ds_read_b64_tr_b16 v[50:51], v10 offset:5120
  ds_read_b64_tr_b16 v[52:53], v11 offset:4096
  v_mfma_f32_32x32x16_bf16 v[160:175], v[20:23], v[36:39], v[160:175]
  ds_read_b64_tr_b16 v[54:55], v11 offset:5120
  ds_read_b64_tr_b16 v[64:65], v12 offset:8192
  ds_read_b64_tr_b16 v[66:67], v12 offset:8320
  v_mfma_f32_32x32x16_bf16 v[176:191], v[24:27], v[32:35], v[176:191]
  ds_read_b128 v[68:71], v6 offset:0
  ds_read_b128 v[72:75], v6 offset:18432
  ds_read_b128 v[76:79], v6 offset:36864
  s_add_u32 m0, s33, 0
  s_nop 0
  buffer_load_dwordx4 v13, s[4:7], s31 offen lds
  s_add_u32 s31, s31, s32
  v_mfma_f32_32x32x16_bf16 v[192:207], v[24:27], v[36:39], v[192:207]
  ds_read_b128 v[80:83], v6 offset:55296
  s_add_u32 m0, s33, 1024
  s_nop 0
  buffer_load_dwordx4 v13, s[4:7], s31 offen lds
  s_add_u32 s31, s31, s32
  v_mfma_f32_32x32x16_bf16 v[208:223], v[28:31], v[32:35], v[208:223]
  s_add_u32 m0, s33, 2048
  s_nop 0
  buffer_load_dwordx4 v13, s[4:7], s31 offen lds
  s_add_u32 s31, s31, s32
  v_mfma_f32_32x32x16_bf16 v[224:239], v[28:31], v[36:39], v[224:239]
  s_add_u32 m0, s33, 3072
  s_nop 0
  buffer_load_dwordx4 v13, s[4:7], s31 offen lds
  s_add_u32 s31, s31, s32
  s_waitcnt vmcnt(9) lgkmcnt(0)
  v_mfma_f32_32x32x16_bf16 v[112:127], v[40:43], v[56:59], v[112:127]
  ds_read_b128 v[32:35], v4 offset:0
  ds_read_b128 v[36:39], v4 offset:36864
  ds_read_b64_tr_b16 v[16:17], v8 offset:36864
  v_mfma_f32_32x32x16_bf16 v[128:143], v[40:43], v[60:63], v[128:143]
  ds_read_b64_tr_b16 v[18:19], v8 offset:37888
  ds_read_b64_tr_b16 v[20:21], v9 offset:36864
  ds_read_b64_tr_b16 v[22:23], v9 offset:37888
  v_mfma_f32_32x32x16_bf16 v[144:159], v[44:47], v[56:59], v[144:159]
  ds_read_b64_tr_b16 v[24:25], v10 offset:36864
  ds_read_b64_tr_b16 v[26:27], v10 offset:37888
  ds_read_b64_tr_b16 v[28:29], v11 offset:36864
  s_add_u32 m0, s33, 4096
  s_nop 0
  buffer_load_dwordx4 v13, s[4:7], s31 offen lds
  s_add_u32 s31, s31, s32
  v_mfma_f32_32x32x16_bf16 v[160:175], v[44:47], v[60:63], v[160:175]
  ds_read_b64_tr_b16 v[30:31], v11 offset:37888
  s_add_u32 m0, s33, 5120
  s_nop 0
  buffer_load_dwordx4 v13, s[4:7], s31 offen lds
  s_add_u32 s31, s31, s32
  v_mfma_f32_32x32x16_bf16 v[176:191], v[48:51], v[56:59], v[176:191]
  s_add_u32 m0, s33, 6144
  s_nop 0
  buffer_load_dwordx4 v13, s[4:7], s31 offen lds
  s_add_u32 s31, s31, s32
  v_mfma_f32_32x32x16_bf16 v[192:207], v[48:51], v[60:63], v[192:207]
  s_add_u32 m0, s33, 7168
  s_nop 0
  buffer_load_dwordx4 v13, s[4:7], s31 offen lds
  s_add_u32 s31, s31, s32
  v_mfma_f32_32x32x16_bf16 v[208:223], v[52:55], v[56:59], v[208:223]
  s_add_u32 m0, s33, 8192
  s_lshl_b32 s35, s32, 3
  s_sub_u32 s35, s31, s35
  buffer_load_dwordx4 v14, s[4:7], s35 offen lds
  v_mfma_f32_32x32x16_bf16 v[224:239], v[52:55], v[60:63], v[224:239]
  v_mfma_f32_16x16x32_bf16 v[240:243], v[64:67], v[68:71], v[240:243]
  v_mfma_f32_16x16x32_bf16 v[244:247], v[64:67], v[72:75], v[244:247]
  v_mfma_f32_16x16x32_bf16 v[248:251], v[64:67], v[76:79], v[248:251]
  v_mfma_f32_16x16x32_bf16 v[252:255], v[64:67], v[80:83], v[252:255]
  s_waitcnt vmcnt(9) lgkmcnt(0)
  v_mfma_f32_32x32x16_bf16 v[112:127], v[16:19], v[32:35], v[112:127]
  ds_read_b128 v[56:59], v5 offset:0
  ds_read_b128 v[60:63], v5 offset:36864
  ds_read_b64_tr_b16 v[40:41], v8 offset:40960
  v_mfma_f32_32x32x16_bf16 v[128:143], v[16:19], v[36:39], v[128:143]
  ds_read_b64_tr_b16 v[42:43], v8 offset:41984
  ds_read_b64_tr_b16 v[44:45], v9 offset:40960
  ds_read_b64_tr_b16 v[46:47], v9 offset:41984
  v_mfma_f32_32x32x16_bf16 v[144:159], v[20:23], v[32:35], v[144:159]
  ds_read_b64_tr_b16 v[48:49], v10 offset:40960
  ds_read_b64_tr_b16 v[50:51], v10 offset:41984
  ds_read_b64_tr_b16 v[52:53], v11 offset:40960
  v_mfma_f32_32x32x16_bf16 v[160:175], v[20:23], v[36:39], v[160:175]
  ds_read_b64_tr_b16 v[54:55], v11 offset:41984
  ds_read_b64_tr_b16 v[64:65], v12 offset:45056
  ds_read_b64_tr_b16 v[66:67], v12 offset:45184
  v_mfma_f32_32x32x16_bf16 v[176:191], v[24:27], v[32:35], v[176:191]
  ds_read_b128 v[68:71], v7 offset:0
  ds_read_b128 v[72:75], v7 offset:18432
  ds_read_b128 v[76:79], v7 offset:36864
  s_add_u32 m0, s33, 36864
  s_nop 0
  buffer_load_dwordx4 v13, s[4:7], s31 offen lds
  s_add_u32 s31, s31, s32
  v_mfma_f32_32x32x16_bf16 v[192:207], v[24:27], v[36:39], v[192:207]
  ds_read_b128 v[80:83], v7 offset:55296
  s_add_u32 m0, s33, 37888
  s_nop 0
  buffer_load_dwordx4 v13, s[4:7], s31 offen lds
  s_add_u32 s31, s31, s32
  v_mfma_f32_32x32x16_bf16 v[208:223], v[28:31], v[32:35], v[208:223]
  s_add_u32 m0, s33, 38912
  s_nop 0
  buffer_load_dwordx4 v13, s[4:7], s31 offen lds
  s_add_u32 s31, s31, s32
  v_mfma_f32_32x32x16_bf16 v[224:239], v[28:31], v[36:39], v[224:239]
  s_add_u32 m0, s33, 39936
  s_nop 0
  buffer_load_dwordx4 v13, s[4:7], s31 offen lds
  s_add_u32 s31, s31, s32
  s_waitcnt vmcnt(9) lgkmcnt(0)
  v_mfma_f32_32x32x16_bf16 v[112:127], v[40:43], v[56:59], v[112:127]
  ds_read_b128 v[32:35], v2 offset:128
  ds_read_b128 v[36:39], v2 offset:36992
  ds_read_b64_tr_b16 v[16:17], v8 offset:0
  v_mfma_f32_32x32x16_bf16 v[128:143], v[40:43], v[60:63], v[128:143]
  ds_read_b64_tr_b16 v[18:19], v8 offset:1024
  ds_read_b64_tr_b16 v[20:21], v9 offset:0
  ds_read_b64_tr_b16 v[22:23], v9 offset:1024
  v_mfma_f32_32x32x16_bf16 v[144:159], v[44:47], v[56:59], v[144:159]
  ds_read_b64_tr_b16 v[24:25], v10 offset:0
  ds_read_b64_tr_b16 v[26:27], v10 offset:1024
  ds_read_b64_tr_b16 v[28:29], v11 offset:0
  s_add_u32 m0, s33, 40960
  s_nop 0
  buffer_load_dwordx4 v13, s[4:7], s31 offen lds
  s_add_u32 s31, s31, s32
  v_mfma_f32_32x32x16_bf16 v[160:175], v[44:47], v[60:63], v[160:175]
  ds_read_b64_tr_b16 v[30:31], v11 offset:1024
  s_add_u32 m0, s33, 41984
  s_nop 0
  buffer_load_dwordx4 v13, s[4:7], s31 offen lds
  s_add_u32 s31, s31, s32
  v_mfma_f32_32x32x16_bf16 v[176:191], v[48:51], v[56:59], v[176:191]
  s_add_u32 m0, s33, 43008
  s_nop 0
  buffer_load_dwordx4 v13, s[4:7], s31 offen lds
  s_add_u32 s31, s31, s32
  v_mfma_f32_32x32x16_bf16 v[192:207], v[48:51], v[60:63], v[192:207]
  s_add_u32 m0, s33, 44032
  s_nop 0
  buffer_load_dwordx4 v13, s[4:7], s31 offen lds
  s_add_u32 s31, s31, s32
  v_mfma_f32_32x32x16_bf16 v[208:223], v[52:55], v[56:59], v[208:223]
  s_add_u32 m0, s33, 45056
  s_lshl_b32 s35, s32, 3
  s_sub_u32 s35, s31, s35
  buffer_load_dwordx4 v14, s[4:7], s35 offen lds
  v_mfma_f32_32x32x16_bf16 v[224:239], v[52:55], v[60:63], v[224:239]
  v_mfma_f32_16x16x32_bf16 v[240:243], v[64:67], v[68:71], v[240:243]
  v_mfma_f32_16x16x32_bf16 v[244:247], v[64:67], v[72:75], v[244:247]
  v_mfma_f32_16x16x32_bf16 v[248:251], v[64:67], v[76:79], v[248:251]
  v_mfma_f32_16x16x32_bf16 v[252:255], v[64:67], v[80:83], v[252:255]
  v_add_u32 v2, 128, v2
  v_add_u32 v3, 128, v3
  v_add_u32 v4, 128, v4
  v_add_u32 v5, 128, v5
  v_add_u32 v6, 128, v6
  v_add_u32 v7, 128, v7
  s_sub_u32 s34, s34, 1
  s_cmp_lg_u32 s34, 0
  s_cbranch_scc1 G1_LOOP

  s_mov_b32 s4, s12
  s_mov_b32 s5, s13
  s_mov_b32 s6, s14
  s_mov_b32 s7, s15
  s_mov_b32 s31, 0
  s_mov_b32 s32, 4608

  s_waitcnt vmcnt(9) lgkmcnt(0)
  v_mfma_f32_32x32x16_bf16 v[112:127], v[16:19], v[32:35], v[112:127]
  ds_read_b128 v[56:59], v3 offset:0
  ds_read_b128 v[60:63], v3 offset:36864
  ds_read_b64_tr_b16 v[40:41], v8 offset:4096
  v_mfma_f32_32x32x16_bf16 v[128:143], v[16:19], v[36:39], v[128:143]
  ds_read_b64_tr_b16 v[42:43], v8 offset:5120
  ds_read_b64_tr_b16 v[44:45], v9 offset:4096
  ds_read_b64_tr_b16 v[46:47], v9 offset:5120
  v_mfma_f32_32x32x16_bf16 v[144:159], v[20:23], v[32:35], v[144:159]
  ds_read_b64_tr_b16 v[48:49], v10 offset:4096
  ds_read_b64_tr_b16 v[50:51], v10 offset:5120
  ds_read_b64_tr_b16 v[52:53], v11 offset:4096
  v_mfma_f32_32x32x16_bf16 v[160:175], v[20:23], v[36:39], v[160:175]
  ds_read_b64_tr_b16 v[54:55], v11 offset:5120
  ds_read_b64_tr_b16 v[64:65], v12 offset:8192
  ds_read_b64_tr_b16 v[66:67], v12 offset:8320
  v_mfma_f32_32x32x16_bf16 v[176:191], v[24:27], v[32:35], v[176:191]
  ds_read_b128 v[68:71], v6 offset:0
  ds_read_b128 v[72:75], v6 offset:18432
  ds_read_b128 v[76:79], v6 offset:36864
  s_add_u32 m0, s33, 0
  s_nop 0
  buffer_load_dwordx4 v92, s[4:7], s31 offen lds
  s_add_u32 s31, s31, s32
  v_mfma_f32_32x32x16_bf16 v[192:207], v[24:27], v[36:39], v[192:207]
  ds_read_b128 v[80:83], v6 offset:55296
  s_add_u32 m0, s33, 1024
  s_nop 0
  buffer_load_dwordx4 v92, s[4:7], s31 offen lds
  s_add_u32 s31, s31, s32
  v_mfma_f32_32x32x16_bf16 v[208:223], v[28:31], v[32:35], v[208:223]
  s_add_u32 m0, s33, 2048
  s_nop 0
  buffer_load_dwordx4 v92, s[4:7], s31 offen lds
  s_add_u32 s31, s31, s32
  v_mfma_f32_32x32x16_bf16 v[224:239], v[28:31], v[36:39], v[224:239]
  s_add_u32 m0, s33, 3072
  s_nop 0
  buffer_load_dwordx4 v92, s[4:7], s31 offen lds
  s_add_u32 s31, s31, s32
  s_waitcnt vmcnt(9) lgkmcnt(0)
  v_mfma_f32_32x32x16_bf16 v[112:127], v[40:43], v[56:59], v[112:127]
  ds_read_b128 v[32:35], v4 offset:0
  ds_read_b128 v[36:39], v4 offset:36864
  ds_read_b64_tr_b16 v[16:17], v8 offset:36864
  v_mfma_f32_32x32x16_bf16 v[128:143], v[40:43], v[60:63], v[128:143]
  ds_read_b64_tr_b16 v[18:19], v8 offset:37888
  ds_read_b64_tr_b16 v[20:21], v9 offset:36864
  ds_read_b64_tr_b16 v[22:23], v9 offset:37888
  v_mfma_f32_32x32x16_bf16 v[144:159], v[44:47], v[56:59], v[144:159]
  ds_read_b64_tr_b16 v[24:25], v10 offset:36864
  ds_read_b64_tr_b16 v[26:27], v10 offset:37888
  ds_read_b64_tr_b16 v[28:29], v11 offset:36864
  s_add_u32 m0, s33, 4096
  s_nop 0
  buffer_load_dwordx4 v92, s[4:7], s31 offen lds
  s_add_u32 s31, s31, s32
  v_mfma_f32_32x32x16_bf16 v[160:175], v[44:47], v[60:63], v[160:175]
  ds_read_b64_tr_b16 v[30:31], v11 offset:37888
  s_add_u32 m0, s33, 5120
  s_nop 0
  buffer_load_dwordx4 v92, s[4:7], s31 offen lds
  s_add_u32 s31, s31, s32
  v_mfma_f32_32x32x16_bf16 v[176:191], v[48:51], v[56:59], v[176:191]
  s_add_u32 m0, s33, 6144
  s_nop 0
  buffer_load_dwordx4 v92, s[4:7], s31 offen lds
  s_add_u32 s31, s31, s32
  v_mfma_f32_32x32x16_bf16 v[192:207], v[48:51], v[60:63], v[192:207]
  s_add_u32 m0, s33, 7168
  s_nop 0
  buffer_load_dwordx4 v92, s[4:7], s31 offen lds
  s_add_u32 s31, s31, s32
  v_mfma_f32_32x32x16_bf16 v[208:223], v[52:55], v[56:59], v[208:223]
  s_add_u32 m0, s33, 8192
  s_lshl_b32 s35, s32, 3
  s_sub_u32 s35, s31, s35
  buffer_load_dwordx4 v93, s[4:7], s35 offen lds
  v_mfma_f32_32x32x16_bf16 v[224:239], v[52:55], v[60:63], v[224:239]
  v_mfma_f32_16x16x32_bf16 v[240:243], v[64:67], v[68:71], v[240:243]
  v_mfma_f32_16x16x32_bf16 v[244:247], v[64:67], v[72:75], v[244:247]
  v_mfma_f32_16x16x32_bf16 v[248:251], v[64:67], v[76:79], v[248:251]
  v_mfma_f32_16x16x32_bf16 v[252:255], v[64:67], v[80:83], v[252:255]
  s_waitcnt vmcnt(9) lgkmcnt(0)
  v_mfma_f32_32x32x16_bf16 v[112:127], v[16:19], v[32:35], v[112:127]
  ds_read_b128 v[56:59], v5 offset:0
  ds_read_b128 v[60:63], v5 offset:36864
  ds_read_b64_tr_b16 v[40:41], v8 offset:40960
  v_mfma_f32_32x32x16_bf16 v[128:143], v[16:19], v[36:39], v[128:143]
  ds_read_b64_tr_b16 v[42:43], v8 offset:41984
  ds_read_b64_tr_b16 v[44:45], v9 offset:40960
  ds_read_b64_tr_b16 v[46:47], v9 offset:41984
  v_mfma_f32_32x32x16_bf16 v[144:159], v[20:23], v[32:35], v[144:159]
  ds_read_b64_tr_b16 v[48:49], v10 offset:40960
  ds_read_b64_tr_b16 v[50:51], v10 offset:41984
  ds_read_b64_tr_b16 v[52:53], v11 offset:40960
  v_mfma_f32_32x32x16_bf16 v[160:175], v[20:23], v[36:39], v[160:175]
  ds_read_b64_tr_b16 v[54:55], v11 offset:41984
  ds_read_b64_tr_b16 v[64:65], v12 offset:45056
  ds_read_b64_tr_b16 v[66:67], v12 offset:45184
  v_mfma_f32_32x32x16_bf16 v[176:191], v[24:27], v[32:35], v[176:191]
  ds_read_b128 v[68:71], v7 offset:0
  ds_read_b128 v[72:75], v7 offset:18432
  ds_read_b128 v[76:79], v7 offset:36864
  s_add_u32 m0, s33, 36864
  s_nop 0
  buffer_load_dwordx4 v92, s[4:7], s31 offen lds
  s_add_u32 s31, s31, s32
  v_mfma_f32_32x32x16_bf16 v[192:207], v[24:27], v[36:39], v[192:207]
  ds_read_b128 v[80:83], v7 offset:55296
  s_add_u32 m0, s33, 37888
  s_nop 0
  buffer_load_dwordx4 v92, s[4:7], s31 offen lds
  s_add_u32 s31, s31, s32
  v_mfma_f32_32x32x16_bf16 v[208:223], v[28:31], v[32:35], v[208:223]
  s_add_u32 m0, s33, 38912
  s_nop 0
  buffer_load_dwordx4 v92, s[4:7], s31 offen lds
  s_add_u32 s31, s31, s32
  v_mfma_f32_32x32x16_bf16 v[224:239], v[28:31], v[36:39], v[224:239]
  s_add_u32 m0, s33, 39936
  s_nop 0
  buffer_load_dwordx4 v92, s[4:7], s31 offen lds
  s_add_u32 s31, s31, s32
  s_waitcnt vmcnt(9) lgkmcnt(0)
  v_mfma_f32_32x32x16_bf16 v[112:127], v[40:43], v[56:59], v[112:127]
  s_add_u32 m0, s33, 40960
  s_nop 0
  buffer_load_dwordx4 v92, s[4:7], s31 offen lds
  s_add_u32 s31, s31, s32
  v_mfma_f32_32x32x16_bf16 v[128:143], v[40:43], v[60:63], v[128:143]
  s_add_u32 m0, s33, 41984
  s_nop 0
  buffer_load_dwordx4 v92, s[4:7], s31 offen lds
  s_add_u32 s31, s31, s32
  v_mfma_f32_32x32x16_bf16 v[144:159], v[44:47], v[56:59], v[144:159]
  s_add_u32 m0, s33, 43008
  s_nop 0
  buffer_load_dwordx4 v92, s[4:7], s31 offen lds
  s_add_u32 s31, s31, s32
  v_mfma_f32_32x32x16_bf16 v[160:175], v[44:47], v[60:63], v[160:175]
  s_add_u32 m0, s33, 44032
  s_nop 0
  buffer_load_dwordx4 v92, s[4:7], s31 offen lds
  s_add_u32 s31, s31, s32
  v_mfma_f32_32x32x16_bf16 v[176:191], v[48:51], v[56:59], v[176:191]
  s_add_u32 m0, s33, 45056
  s_lshl_b32 s35, s32, 3
  s_sub_u32 s35, s31, s35
  buffer_load_dwordx4 v93, s[4:7], s35 offen lds
  v_mfma_f32_32x32x16_bf16 v[192:207], v[48:51], v[60:63], v[192:207]
  v_mfma_f32_32x32x16_bf16 v[208:223], v[52:55], v[56:59], v[208:223]
  v_mfma_f32_32x32x16_bf16 v[224:239], v[52:55], v[60:63], v[224:239]
  v_mfma_f32_16x16x32_bf16 v[240:243], v[64:67], v[68:71], v[240:243]
  v_mfma_f32_16x16x32_bf16 v[244:247], v[64:67], v[72:75], v[244:247]
  v_mfma_f32_16x16x32_bf16 v[248:251], v[64:67], v[76:79], v[248:251]
  v_mfma_f32_16x16x32_bf16 v[252:255], v[64:67], v[80:83], v[252:255]
  s_waitcnt lgkmcnt(0)
  s_mov_b64 exec, 1
  ds_add_u32 v84, v85 offset:4
  s_mov_b64 exec, -1

  s_setprio 3
  s_mov_b32 s44, 0xbdd2d3e8
  s_mov_b32 s45, 0xbdd2d3e8
  v_mov_b32 v30, 0xc0135761
  v_mov_b32 v31, 0xc0135761
  v_and_b32 v16, 31, v1
  v_lshlrev_b32 v16, 2, v16
  v_add_u32 v16, 162352, v16
  v_and_b32 v17, 15, v1
  v_lshlrev_b32 v17, 2, v17
  v_add_u32 v17, 162352, v17
  ds_read_b32 v86, v16
  ds_read_b32 v87, v16 offset:128
  ds_read_b32 v88, v17
  ds_read_b32 v89, v17 offset:64
  ds_read_b32 v90, v17 offset:128
  ds_read_b32 v91, v17 offset:192
  s_nop 7

  v_lshlrev_b32 v24, 4, v1
  s_mul_i32 s35, s30, 16640
  v_add_u32 v24, s35, v24
  v_bfe_u32 v25, v1, 4, 1
  v_lshlrev_b32 v25, 9, v25
  v_and_b32 v26, 15, v1
  v_lshl_add_u32 v25, v26, 4, v25
  v_lshrrev_b32 v26, 5, v1
  v_lshl_add_u32 v25, v26, 3, v25
  s_add_u32 s35, s30, 32
  s_mul_i32 s35, s35, 2080
  v_add_u32 v25, s35, v25

  v_pk_mul_f32 v[16:17], v[112:113], v[112:113]
  v_pk_mul_f32 v[20:21], v[114:115], v[114:115]
  v_pk_fma_f32 v[16:17], v[16:17], s[44:45], v[30:31]
  v_pk_fma_f32 v[20:21], v[20:21], s[44:45], v[30:31]
  v_pk_mul_f32 v[16:17], v[16:17], v[112:113]
  v_pk_mul_f32 v[20:21], v[20:21], v[114:115]
  v_exp_f32 v16, v16
  v_exp_f32 v17, v17
  v_exp_f32 v20, v20
  v_exp_f32 v21, v21
  v_pk_add_f32 v[16:17], v[16:17], 1.0 op_sel_hi:[1,0]
  v_pk_add_f32 v[20:21], v[20:21], 1.0 op_sel_hi:[1,0]
  v_rcp_f32 v16, v16
  v_rcp_f32 v17, v17
  v_rcp_f32 v20, v20
  v_rcp_f32 v21, v21
  v_pk_mul_f32 v[16:17], v[16:17], v[112:113]
  v_pk_mul_f32 v[20:21], v[20:21], v[114:115]
  v_cvt_pk_bf16_f32 v112, v16, v17
  v_cvt_pk_bf16_f32 v113, v20, v21
  v_pk_mul_f32 v[16:17], v[116:117], v[116:117]
  v_pk_mul_f32 v[20:21], v[118:119], v[118:119]
  v_pk_fma_f32 v[16:17], v[16:17], s[44:45], v[30:31]
  v_pk_fma_f32 v[20:21], v[20:21], s[44:45], v[30:31]
  v_pk_mul_f32 v[16:17], v[16:17], v[116:117]
  v_pk_mul_f32 v[20:21], v[20:21], v[118:119]
  v_exp_f32 v16, v16
  v_exp_f32 v17, v17
  v_exp_f32 v20, v20
  v_exp_f32 v21, v21
  v_pk_add_f32 v[16:17], v[16:17], 1.0 op_sel_hi:[1,0]
  v_pk_add_f32 v[20:21], v[20:21], 1.0 op_sel_hi:[1,0]
  v_rcp_f32 v16, v16
  v_rcp_f32 v17, v17
  v_rcp_f32 v20, v20
  v_rcp_f32 v21, v21
  v_pk_mul_f32 v[16:17], v[16:17], v[116:117]
  v_pk_mul_f32 v[20:21], v[20:21], v[118:119]
  v_cvt_pk_bf16_f32 v114, v16, v17
  v_cvt_pk_bf16_f32 v115, v20, v21
  v_pk_mul_f32 v[16:17], v[120:121], v[120:121]
  v_pk_mul_f32 v[20:21], v[122:123], v[122:123]
  v_pk_fma_f32 v[16:17], v[16:17], s[44:45], v[30:31]
  v_pk_fma_f32 v[20:21], v[20:21], s[44:45], v[30:31]
  v_pk_mul_f32 v[16:17], v[16:17], v[120:121]
  v_pk_mul_f32 v[20:21], v[20:21], v[122:123]
  v_exp_f32 v16, v16
  v_exp_f32 v17, v17
  v_exp_f32 v20, v20
  v_exp_f32 v21, v21
  v_pk_add_f32 v[16:17], v[16:17], 1.0 op_sel_hi:[1,0]
  v_pk_add_f32 v[20:21], v[20:21], 1.0 op_sel_hi:[1,0]
  v_rcp_f32 v16, v16
  v_rcp_f32 v17, v17
  v_rcp_f32 v20, v20
  v_rcp_f32 v21, v21
  v_pk_mul_f32 v[16:17], v[16:17], v[120:121]
  v_pk_mul_f32 v[20:21], v[20:21], v[122:123]
  v_cvt_pk_bf16_f32 v116, v16, v17
  v_cvt_pk_bf16_f32 v117, v20, v21
  v_pk_mul_f32 v[16:17], v[124:125], v[124:125]
  v_pk_mul_f32 v[20:21], v[126:127], v[126:127]
  v_pk_fma_f32 v[16:17], v[16:17], s[44:45], v[30:31]
  v_pk_fma_f32 v[20:21], v[20:21], s[44:45], v[30:31]
  v_pk_mul_f32 v[16:17], v[16:17], v[124:125]
  v_pk_mul_f32 v[20:21], v[20:21], v[126:127]
  v_exp_f32 v16, v16
  v_exp_f32 v17, v17
  v_exp_f32 v20, v20
  v_exp_f32 v21, v21
  v_pk_add_f32 v[16:17], v[16:17], 1.0 op_sel_hi:[1,0]
  v_pk_add_f32 v[20:21], v[20:21], 1.0 op_sel_hi:[1,0]
  v_rcp_f32 v16, v16
  v_rcp_f32 v17, v17
  v_rcp_f32 v20, v20
  v_rcp_f32 v21, v21
  v_pk_mul_f32 v[16:17], v[16:17], v[124:125]
  v_pk_mul_f32 v[20:21], v[20:21], v[126:127]
  v_cvt_pk_bf16_f32 v118, v16, v17
  v_cvt_pk_bf16_f32 v119, v20, v21
  s_mov_b32 s39, 0x40000
WAITC_13:
  ds_read_b32 v26, v84 offset:4
  s_waitcnt lgkmcnt(0)
  v_readfirstlane_b32 s38, v26
  s_cmp_ge_u32 s38, 4
  s_cbranch_scc1 WAITD_14
  s_sleep 1
  s_sub_u32 s39, s39, 1
  s_cmp_lg_u32 s39, 0
  s_cbranch_scc1 WAITC_13

WAITD_14:
  ds_write_b128 v24, v[112:115] offset:0
  ds_write_b128 v24, v[116:119] offset:2080
  v_pk_mul_f32 v[16:17], v[128:129], v[128:129]
  v_pk_mul_f32 v[20:21], v[130:131], v[130:131]
  v_pk_fma_f32 v[16:17], v[16:17], s[44:45], v[30:31]
  v_pk_fma_f32 v[20:21], v[20:21], s[44:45], v[30:31]
  v_pk_mul_f32 v[16:17], v[16:17], v[128:129]
  v_pk_mul_f32 v[20:21], v[20:21], v[130:131]
  v_exp_f32 v16, v16
  v_exp_f32 v17, v17
  v_exp_f32 v20, v20
  v_exp_f32 v21, v21
  v_pk_add_f32 v[16:17], v[16:17], 1.0 op_sel_hi:[1,0]
  v_pk_add_f32 v[20:21], v[20:21], 1.0 op_sel_hi:[1,0]
  v_rcp_f32 v16, v16
  v_rcp_f32 v17, v17
  v_rcp_f32 v20, v20
  v_rcp_f32 v21, v21
  v_pk_mul_f32 v[16:17], v[16:17], v[128:129]
  v_pk_mul_f32 v[20:21], v[20:21], v[130:131]
  v_cvt_pk_bf16_f32 v128, v16, v17
  v_cvt_pk_bf16_f32 v129, v20, v21
  v_pk_mul_f32 v[16:17], v[132:133], v[132:133]
  v_pk_mul_f32 v[20:21], v[134:135], v[134:135]
  v_pk_fma_f32 v[16:17], v[16:17], s[44:45], v[30:31]
  v_pk_fma_f32 v[20:21], v[20:21], s[44:45], v[30:31]
  v_pk_mul_f32 v[16:17], v[16:17], v[132:133]
  v_pk_mul_f32 v[20:21], v[20:21], v[134:135]
  v_exp_f32 v16, v16
  v_exp_f32 v17, v17
  v_exp_f32 v20, v20
  v_exp_f32 v21, v21
  v_pk_add_f32 v[16:17], v[16:17], 1.0 op_sel_hi:[1,0]
  v_pk_add_f32 v[20:21], v[20:21], 1.0 op_sel_hi:[1,0]
  v_rcp_f32 v16, v16
  v_rcp_f32 v17, v17
  v_rcp_f32 v20, v20
  v_rcp_f32 v21, v21
  v_pk_mul_f32 v[16:17], v[16:17], v[132:133]
  v_pk_mul_f32 v[20:21], v[20:21], v[134:135]
  v_cvt_pk_bf16_f32 v130, v16, v17
  v_cvt_pk_bf16_f32 v131, v20, v21
  v_pk_mul_f32 v[16:17], v[136:137], v[136:137]
  v_pk_mul_f32 v[20:21], v[138:139], v[138:139]
  v_pk_fma_f32 v[16:17], v[16:17], s[44:45], v[30:31]
  v_pk_fma_f32 v[20:21], v[20:21], s[44:45], v[30:31]
  v_pk_mul_f32 v[16:17], v[16:17], v[136:137]
  v_pk_mul_f32 v[20:21], v[20:21], v[138:139]
  v_exp_f32 v16, v16
  v_exp_f32 v17, v17
  v_exp_f32 v20, v20
  v_exp_f32 v21, v21
  v_pk_add_f32 v[16:17], v[16:17], 1.0 op_sel_hi:[1,0]
  v_pk_add_f32 v[20:21], v[20:21], 1.0 op_sel_hi:[1,0]
  v_rcp_f32 v16, v16
  v_rcp_f32 v17, v17
  v_rcp_f32 v20, v20
  v_rcp_f32 v21, v21
  v_pk_mul_f32 v[16:17], v[16:17], v[136:137]
  v_pk_mul_f32 v[20:21], v[20:21], v[138:139]
  v_cvt_pk_bf16_f32 v132, v16, v17
  v_cvt_pk_bf16_f32 v133, v20, v21
  v_pk_mul_f32 v[16:17], v[140:141], v[140:141]
  v_pk_mul_f32 v[20:21], v[142:143], v[142:143]
  v_pk_fma_f32 v[16:17], v[16:17], s[44:45], v[30:31]
  v_pk_fma_f32 v[20:21], v[20:21], s[44:45], v[30:31]
  v_pk_mul_f32 v[16:17], v[16:17], v[140:141]
  v_pk_mul_f32 v[20:21], v[20:21], v[142:143]
  v_exp_f32 v16, v16
  v_exp_f32 v17, v17
  v_exp_f32 v20, v20
  v_exp_f32 v21, v21
  v_pk_add_f32 v[16:17], v[16:17], 1.0 op_sel_hi:[1,0]
  v_pk_add_f32 v[20:21], v[20:21], 1.0 op_sel_hi:[1,0]
  v_rcp_f32 v16, v16
  v_rcp_f32 v17, v17
  v_rcp_f32 v20, v20
  v_rcp_f32 v21, v21
  v_pk_mul_f32 v[16:17], v[16:17], v[140:141]
  v_pk_mul_f32 v[20:21], v[20:21], v[142:143]
  v_cvt_pk_bf16_f32 v134, v16, v17
  v_cvt_pk_bf16_f32 v135, v20, v21
  ds_write_b128 v24, v[128:131] offset:1024
  ds_write_b128 v24, v[132:135] offset:3104
  v_pk_mul_f32 v[16:17], v[144:145], v[144:145]
  v_pk_mul_f32 v[20:21], v[146:147], v[146:147]
  v_pk_fma_f32 v[16:17], v[16:17], s[44:45], v[30:31]
  v_pk_fma_f32 v[20:21], v[20:21], s[44:45], v[30:31]
  v_pk_mul_f32 v[16:17], v[16:17], v[144:145]
  v_pk_mul_f32 v[20:21], v[20:21], v[146:147]
  v_exp_f32 v16, v16
  v_exp_f32 v17, v17
  v_exp_f32 v20, v20
  v_exp_f32 v21, v21
  v_pk_add_f32 v[16:17], v[16:17], 1.0 op_sel_hi:[1,0]
  v_pk_add_f32 v[20:21], v[20:21], 1.0 op_sel_hi:[1,0]
  v_rcp_f32 v16, v16
  v_rcp_f32 v17, v17
  v_rcp_f32 v20, v20
  v_rcp_f32 v21, v21
  v_pk_mul_f32 v[16:17], v[16:17], v[144:145]
  v_pk_mul_f32 v[20:21], v[20:21], v[146:147]
  v_cvt_pk_bf16_f32 v144, v16, v17
  v_cvt_pk_bf16_f32 v145, v20, v21
  v_pk_mul_f32 v[16:17], v[148:149], v[148:149]
  v_pk_mul_f32 v[20:21], v[150:151], v[150:151]
  v_pk_fma_f32 v[16:17], v[16:17], s[44:45], v[30:31]
  v_pk_fma_f32 v[20:21], v[20:21], s[44:45], v[30:31]
  v_pk_mul_f32 v[16:17], v[16:17], v[148:149]
  v_pk_mul_f32 v[20:21], v[20:21], v[150:151]
  v_exp_f32 v16, v16
  v_exp_f32 v17, v17
  v_exp_f32 v20, v20
  v_exp_f32 v21, v21
  v_pk_add_f32 v[16:17], v[16:17], 1.0 op_sel_hi:[1,0]
  v_pk_add_f32 v[20:21], v[20:21], 1.0 op_sel_hi:[1,0]
  v_rcp_f32 v16, v16
  v_rcp_f32 v17, v17
  v_rcp_f32 v20, v20
  v_rcp_f32 v21, v21
  v_pk_mul_f32 v[16:17], v[16:17], v[148:149]
  v_pk_mul_f32 v[20:21], v[20:21], v[150:151]
  v_cvt_pk_bf16_f32 v146, v16, v17
  v_cvt_pk_bf16_f32 v147, v20, v21
  v_pk_mul_f32 v[16:17], v[152:153], v[152:153]
  v_pk_mul_f32 v[20:21], v[154:155], v[154:155]
  v_pk_fma_f32 v[16:17], v[16:17], s[44:45], v[30:31]
  v_pk_fma_f32 v[20:21], v[20:21], s[44:45], v[30:31]
  v_pk_mul_f32 v[16:17], v[16:17], v[152:153]
  v_pk_mul_f32 v[20:21], v[20:21], v[154:155]
  v_exp_f32 v16, v16
  v_exp_f32 v17, v17
  v_exp_f32 v20, v20
  v_exp_f32 v21, v21
  v_pk_add_f32 v[16:17], v[16:17], 1.0 op_sel_hi:[1,0]
  v_pk_add_f32 v[20:21], v[20:21], 1.0 op_sel_hi:[1,0]
  v_rcp_f32 v16, v16
  v_rcp_f32 v17, v17
  v_rcp_f32 v20, v20
  v_rcp_f32 v21, v21
  v_pk_mul_f32 v[16:17], v[16:17], v[152:153]
  v_pk_mul_f32 v[20:21], v[20:21], v[154:155]
  v_cvt_pk_bf16_f32 v148, v16, v17
  v_cvt_pk_bf16_f32 v149, v20, v21
  v_pk_mul_f32 v[16:17], v[156:157], v[156:157]
  v_pk_mul_f32 v[20:21], v[158:159], v[158:159]
  v_pk_fma_f32 v[16:17], v[16:17], s[44:45], v[30:31]
  v_pk_fma_f32 v[20:21], v[20:21], s[44:45], v[30:31]
  v_pk_mul_f32 v[16:17], v[16:17], v[156:157]
  v_pk_mul_f32 v[20:21], v[20:21], v[158:159]
  v_exp_f32 v16, v16
  v_exp_f32 v17, v17
  v_exp_f32 v20, v20
  v_exp_f32 v21, v21
  v_pk_add_f32 v[16:17], v[16:17], 1.0 op_sel_hi:[1,0]
  v_pk_add_f32 v[20:21], v[20:21], 1.0 op_sel_hi:[1,0]
  v_rcp_f32 v16, v16
  v_rcp_f32 v17, v17
  v_rcp_f32 v20, v20
  v_rcp_f32 v21, v21
  v_pk_mul_f32 v[16:17], v[16:17], v[156:157]
  v_pk_mul_f32 v[20:21], v[20:21], v[158:159]
  v_cvt_pk_bf16_f32 v150, v16, v17
  v_cvt_pk_bf16_f32 v151, v20, v21
  ds_write_b128 v24, v[144:147] offset:4160
  ds_write_b128 v24, v[148:151] offset:6240
  v_pk_mul_f32 v[16:17], v[160:161], v[160:161]
  v_pk_mul_f32 v[20:21], v[162:163], v[162:163]
  v_pk_fma_f32 v[16:17], v[16:17], s[44:45], v[30:31]
  v_pk_fma_f32 v[20:21], v[20:21], s[44:45], v[30:31]
  v_pk_mul_f32 v[16:17], v[16:17], v[160:161]
  v_pk_mul_f32 v[20:21], v[20:21], v[162:163]
  v_exp_f32 v16, v16
  v_exp_f32 v17, v17
  v_exp_f32 v20, v20
  v_exp_f32 v21, v21
  v_pk_add_f32 v[16:17], v[16:17], 1.0 op_sel_hi:[1,0]
  v_pk_add_f32 v[20:21], v[20:21], 1.0 op_sel_hi:[1,0]
  v_rcp_f32 v16, v16
  v_rcp_f32 v17, v17
  v_rcp_f32 v20, v20
  v_rcp_f32 v21, v21
  v_pk_mul_f32 v[16:17], v[16:17], v[160:161]
  v_pk_mul_f32 v[20:21], v[20:21], v[162:163]
  v_cvt_pk_bf16_f32 v160, v16, v17
  v_cvt_pk_bf16_f32 v161, v20, v21
  v_pk_mul_f32 v[16:17], v[164:165], v[164:165]
  v_pk_mul_f32 v[20:21], v[166:167], v[166:167]
  v_pk_fma_f32 v[16:17], v[16:17], s[44:45], v[30:31]
  v_pk_fma_f32 v[20:21], v[20:21], s[44:45], v[30:31]
  v_pk_mul_f32 v[16:17], v[16:17], v[164:165]
  v_pk_mul_f32 v[20:21], v[20:21], v[166:167]
  v_exp_f32 v16, v16
  v_exp_f32 v17, v17
  v_exp_f32 v20, v20
  v_exp_f32 v21, v21
  v_pk_add_f32 v[16:17], v[16:17], 1.0 op_sel_hi:[1,0]
  v_pk_add_f32 v[20:21], v[20:21], 1.0 op_sel_hi:[1,0]
  v_rcp_f32 v16, v16
  v_rcp_f32 v17, v17
  v_rcp_f32 v20, v20
  v_rcp_f32 v21, v21
  v_pk_mul_f32 v[16:17], v[16:17], v[164:165]
  v_pk_mul_f32 v[20:21], v[20:21], v[166:167]
  v_cvt_pk_bf16_f32 v162, v16, v17
  v_cvt_pk_bf16_f32 v163, v20, v21
  v_pk_mul_f32 v[16:17], v[168:169], v[168:169]
  v_pk_mul_f32 v[20:21], v[170:171], v[170:171]
  v_pk_fma_f32 v[16:17], v[16:17], s[44:45], v[30:31]
  v_pk_fma_f32 v[20:21], v[20:21], s[44:45], v[30:31]
  v_pk_mul_f32 v[16:17], v[16:17], v[168:169]
  v_pk_mul_f32 v[20:21], v[20:21], v[170:171]
  v_exp_f32 v16, v16
  v_exp_f32 v17, v17
  v_exp_f32 v20, v20
  v_exp_f32 v21, v21
  v_pk_add_f32 v[16:17], v[16:17], 1.0 op_sel_hi:[1,0]
  v_pk_add_f32 v[20:21], v[20:21], 1.0 op_sel_hi:[1,0]
  v_rcp_f32 v16, v16
  v_rcp_f32 v17, v17
  v_rcp_f32 v20, v20
  v_rcp_f32 v21, v21
  v_pk_mul_f32 v[16:17], v[16:17], v[168:169]
  v_pk_mul_f32 v[20:21], v[20:21], v[170:171]
  v_cvt_pk_bf16_f32 v164, v16, v17
  v_cvt_pk_bf16_f32 v165, v20, v21
  v_pk_mul_f32 v[16:17], v[172:173], v[172:173]
  v_pk_mul_f32 v[20:21], v[174:175], v[174:175]
  v_pk_fma_f32 v[16:17], v[16:17], s[44:45], v[30:31]
  v_pk_fma_f32 v[20:21], v[20:21], s[44:45], v[30:31]
  v_pk_mul_f32 v[16:17], v[16:17], v[172:173]
  v_pk_mul_f32 v[20:21], v[20:21], v[174:175]
  v_exp_f32 v16, v16
  v_exp_f32 v17, v17
  v_exp_f32 v20, v20
  v_exp_f32 v21, v21
  v_pk_add_f32 v[16:17], v[16:17], 1.0 op_sel_hi:[1,0]
  v_pk_add_f32 v[20:21], v[20:21], 1.0 op_sel_hi:[1,0]
  v_rcp_f32 v16, v16
  v_rcp_f32 v17, v17
  v_rcp_f32 v20, v20
  v_rcp_f32 v21, v21
  v_pk_mul_f32 v[16:17], v[16:17], v[172:173]
  v_pk_mul_f32 v[20:21], v[20:21], v[174:175]
  v_cvt_pk_bf16_f32 v166, v16, v17
  v_cvt_pk_bf16_f32 v167, v20, v21
  ds_write_b128 v24, v[160:163] offset:5184
  ds_write_b128 v24, v[164:167] offset:7264
  v_pk_mul_f32 v[16:17], v[176:177], v[176:177]
  v_pk_mul_f32 v[20:21], v[178:179], v[178:179]
  v_pk_fma_f32 v[16:17], v[16:17], s[44:45], v[30:31]
  v_pk_fma_f32 v[20:21], v[20:21], s[44:45], v[30:31]
  v_pk_mul_f32 v[16:17], v[16:17], v[176:177]
  v_pk_mul_f32 v[20:21], v[20:21], v[178:179]
  v_exp_f32 v16, v16
  v_exp_f32 v17, v17
  v_exp_f32 v20, v20
  v_exp_f32 v21, v21
  v_pk_add_f32 v[16:17], v[16:17], 1.0 op_sel_hi:[1,0]
  v_pk_add_f32 v[20:21], v[20:21], 1.0 op_sel_hi:[1,0]
  v_rcp_f32 v16, v16
  v_rcp_f32 v17, v17
  v_rcp_f32 v20, v20
  v_rcp_f32 v21, v21
  v_pk_mul_f32 v[16:17], v[16:17], v[176:177]
  v_pk_mul_f32 v[20:21], v[20:21], v[178:179]
  v_cvt_pk_bf16_f32 v176, v16, v17
  v_cvt_pk_bf16_f32 v177, v20, v21
  v_pk_mul_f32 v[16:17], v[180:181], v[180:181]
  v_pk_mul_f32 v[20:21], v[182:183], v[182:183]
  v_pk_fma_f32 v[16:17], v[16:17], s[44:45], v[30:31]
  v_pk_fma_f32 v[20:21], v[20:21], s[44:45], v[30:31]
  v_pk_mul_f32 v[16:17], v[16:17], v[180:181]
  v_pk_mul_f32 v[20:21], v[20:21], v[182:183]
  v_exp_f32 v16, v16
  v_exp_f32 v17, v17
  v_exp_f32 v20, v20
  v_exp_f32 v21, v21
  v_pk_add_f32 v[16:17], v[16:17], 1.0 op_sel_hi:[1,0]
  v_pk_add_f32 v[20:21], v[20:21], 1.0 op_sel_hi:[1,0]
  v_rcp_f32 v16, v16
  v_rcp_f32 v17, v17
  v_rcp_f32 v20, v20
  v_rcp_f32 v21, v21
  v_pk_mul_f32 v[16:17], v[16:17], v[180:181]
  v_pk_mul_f32 v[20:21], v[20:21], v[182:183]
  v_cvt_pk_bf16_f32 v178, v16, v17
  v_cvt_pk_bf16_f32 v179, v20, v21
  v_pk_mul_f32 v[16:17], v[184:185], v[184:185]
  v_pk_mul_f32 v[20:21], v[186:187], v[186:187]
  v_pk_fma_f32 v[16:17], v[16:17], s[44:45], v[30:31]
  v_pk_fma_f32 v[20:21], v[20:21], s[44:45], v[30:31]
  v_pk_mul_f32 v[16:17], v[16:17], v[184:185]
  v_pk_mul_f32 v[20:21], v[20:21], v[186:187]
  v_exp_f32 v16, v16
  v_exp_f32 v17, v17
  v_exp_f32 v20, v20
  v_exp_f32 v21, v21
  v_pk_add_f32 v[16:17], v[16:17], 1.0 op_sel_hi:[1,0]
  v_pk_add_f32 v[20:21], v[20:21], 1.0 op_sel_hi:[1,0]
  v_rcp_f32 v16, v16
  v_rcp_f32 v17, v17
  v_rcp_f32 v20, v20
  v_rcp_f32 v21, v21
  v_pk_mul_f32 v[16:17], v[16:17], v[184:185]
  v_pk_mul_f32 v[20:21], v[20:21], v[186:187]
  v_cvt_pk_bf16_f32 v180, v16, v17
  v_cvt_pk_bf16_f32 v181, v20, v21
  v_pk_mul_f32 v[16:17], v[188:189], v[188:189]
  v_pk_mul_f32 v[20:21], v[190:191], v[190:191]
  v_pk_fma_f32 v[16:17], v[16:17], s[44:45], v[30:31]
  v_pk_fma_f32 v[20:21], v[20:21], s[44:45], v[30:31]
  v_pk_mul_f32 v[16:17], v[16:17], v[188:189]
  v_pk_mul_f32 v[20:21], v[20:21], v[190:191]
  v_exp_f32 v16, v16
  v_exp_f32 v17, v17
  v_exp_f32 v20, v20
  v_exp_f32 v21, v21
  v_pk_add_f32 v[16:17], v[16:17], 1.0 op_sel_hi:[1,0]
  v_pk_add_f32 v[20:21], v[20:21], 1.0 op_sel_hi:[1,0]
  v_rcp_f32 v16, v16
  v_rcp_f32 v17, v17
  v_rcp_f32 v20, v20
  v_rcp_f32 v21, v21
  v_pk_mul_f32 v[16:17], v[16:17], v[188:189]
  v_pk_mul_f32 v[20:21], v[20:21], v[190:191]
  v_cvt_pk_bf16_f32 v182, v16, v17
  v_cvt_pk_bf16_f32 v183, v20, v21
  ds_write_b128 v24, v[176:179] offset:8320
  ds_write_b128 v24, v[180:183] offset:10400
  v_pk_mul_f32 v[16:17], v[192:193], v[192:193]
  v_pk_mul_f32 v[20:21], v[194:195], v[194:195]
  v_pk_fma_f32 v[16:17], v[16:17], s[44:45], v[30:31]
  v_pk_fma_f32 v[20:21], v[20:21], s[44:45], v[30:31]
  v_pk_mul_f32 v[16:17], v[16:17], v[192:193]
  v_pk_mul_f32 v[20:21], v[20:21], v[194:195]
  v_exp_f32 v16, v16
  v_exp_f32 v17, v17
  v_exp_f32 v20, v20
  v_exp_f32 v21, v21
  v_pk_add_f32 v[16:17], v[16:17], 1.0 op_sel_hi:[1,0]
  v_pk_add_f32 v[20:21], v[20:21], 1.0 op_sel_hi:[1,0]
  v_rcp_f32 v16, v16
  v_rcp_f32 v17, v17
  v_rcp_f32 v20, v20
  v_rcp_f32 v21, v21
  v_pk_mul_f32 v[16:17], v[16:17], v[192:193]
  v_pk_mul_f32 v[20:21], v[20:21], v[194:195]
  v_cvt_pk_bf16_f32 v192, v16, v17
  v_cvt_pk_bf16_f32 v193, v20, v21
  v_pk_mul_f32 v[16:17], v[196:197], v[196:197]
  v_pk_mul_f32 v[20:21], v[198:199], v[198:199]
  v_pk_fma_f32 v[16:17], v[16:17], s[44:45], v[30:31]
  v_pk_fma_f32 v[20:21], v[20:21], s[44:45], v[30:31]
  v_pk_mul_f32 v[16:17], v[16:17], v[196:197]
  v_pk_mul_f32 v[20:21], v[20:21], v[198:199]
  v_exp_f32 v16, v16
  v_exp_f32 v17, v17
  v_exp_f32 v20, v20
  v_exp_f32 v21, v21
  v_pk_add_f32 v[16:17], v[16:17], 1.0 op_sel_hi:[1,0]
  v_pk_add_f32 v[20:21], v[20:21], 1.0 op_sel_hi:[1,0]
  v_rcp_f32 v16, v16
  v_rcp_f32 v17, v17
  v_rcp_f32 v20, v20
  v_rcp_f32 v21, v21
  v_pk_mul_f32 v[16:17], v[16:17], v[196:197]
  v_pk_mul_f32 v[20:21], v[20:21], v[198:199]
  v_cvt_pk_bf16_f32 v194, v16, v17
  v_cvt_pk_bf16_f32 v195, v20, v21
  v_pk_mul_f32 v[16:17], v[200:201], v[200:201]
  v_pk_mul_f32 v[20:21], v[202:203], v[202:203]
  v_pk_fma_f32 v[16:17], v[16:17], s[44:45], v[30:31]
  v_pk_fma_f32 v[20:21], v[20:21], s[44:45], v[30:31]
  v_pk_mul_f32 v[16:17], v[16:17], v[200:201]
  v_pk_mul_f32 v[20:21], v[20:21], v[202:203]
  v_exp_f32 v16, v16
  v_exp_f32 v17, v17
  v_exp_f32 v20, v20
  v_exp_f32 v21, v21
  v_pk_add_f32 v[16:17], v[16:17], 1.0 op_sel_hi:[1,0]
  v_pk_add_f32 v[20:21], v[20:21], 1.0 op_sel_hi:[1,0]
  v_rcp_f32 v16, v16
  v_rcp_f32 v17, v17
  v_rcp_f32 v20, v20
  v_rcp_f32 v21, v21
  v_pk_mul_f32 v[16:17], v[16:17], v[200:201]
  v_pk_mul_f32 v[20:21], v[20:21], v[202:203]
  v_cvt_pk_bf16_f32 v196, v16, v17
  v_cvt_pk_bf16_f32 v197, v20, v21
  v_pk_mul_f32 v[16:17], v[204:205], v[204:205]
  v_pk_mul_f32 v[20:21], v[206:207], v[206:207]
  v_pk_fma_f32 v[16:17], v[16:17], s[44:45], v[30:31]
  v_pk_fma_f32 v[20:21], v[20:21], s[44:45], v[30:31]
  v_pk_mul_f32 v[16:17], v[16:17], v[204:205]
  v_pk_mul_f32 v[20:21], v[20:21], v[206:207]
  v_exp_f32 v16, v16
  v_exp_f32 v17, v17
  v_exp_f32 v20, v20
  v_exp_f32 v21, v21
  v_pk_add_f32 v[16:17], v[16:17], 1.0 op_sel_hi:[1,0]
  v_pk_add_f32 v[20:21], v[20:21], 1.0 op_sel_hi:[1,0]
  v_rcp_f32 v16, v16
  v_rcp_f32 v17, v17
  v_rcp_f32 v20, v20
  v_rcp_f32 v21, v21
  v_pk_mul_f32 v[16:17], v[16:17], v[204:205]
  v_pk_mul_f32 v[20:21], v[20:21], v[206:207]
  v_cvt_pk_bf16_f32 v198, v16, v17
  v_cvt_pk_bf16_f32 v199, v20, v21
  ds_write_b128 v24, v[192:195] offset:9344
  ds_write_b128 v24, v[196:199] offset:11424
  v_pk_mul_f32 v[16:17], v[208:209], v[208:209]
  v_pk_mul_f32 v[20:21], v[210:211], v[210:211]
  v_pk_fma_f32 v[16:17], v[16:17], s[44:45], v[30:31]
  v_pk_fma_f32 v[20:21], v[20:21], s[44:45], v[30:31]
  v_pk_mul_f32 v[16:17], v[16:17], v[208:209]
  v_pk_mul_f32 v[20:21], v[20:21], v[210:211]
  v_exp_f32 v16, v16
  v_exp_f32 v17, v17
  v_exp_f32 v20, v20
  v_exp_f32 v21, v21
  v_pk_add_f32 v[16:17], v[16:17], 1.0 op_sel_hi:[1,0]
  v_pk_add_f32 v[20:21], v[20:21], 1.0 op_sel_hi:[1,0]
  v_rcp_f32 v16, v16
  v_rcp_f32 v17, v17
  v_rcp_f32 v20, v20
  v_rcp_f32 v21, v21
  v_pk_mul_f32 v[16:17], v[16:17], v[208:209]
  v_pk_mul_f32 v[20:21], v[20:21], v[210:211]
  v_cvt_pk_bf16_f32 v208, v16, v17
  v_cvt_pk_bf16_f32 v209, v20, v21
  v_pk_mul_f32 v[16:17], v[212:213], v[212:213]
  v_pk_mul_f32 v[20:21], v[214:215], v[214:215]
  v_pk_fma_f32 v[16:17], v[16:17], s[44:45], v[30:31]
  v_pk_fma_f32 v[20:21], v[20:21], s[44:45], v[30:31]
  v_pk_mul_f32 v[16:17], v[16:17], v[212:213]
  v_pk_mul_f32 v[20:21], v[20:21], v[214:215]
  v_exp_f32 v16, v16
  v_exp_f32 v17, v17
  v_exp_f32 v20, v20
  v_exp_f32 v21, v21
  v_pk_add_f32 v[16:17], v[16:17], 1.0 op_sel_hi:[1,0]
  v_pk_add_f32 v[20:21], v[20:21], 1.0 op_sel_hi:[1,0]
  v_rcp_f32 v16, v16
  v_rcp_f32 v17, v17
  v_rcp_f32 v20, v20
  v_rcp_f32 v21, v21
  v_pk_mul_f32 v[16:17], v[16:17], v[212:213]
  v_pk_mul_f32 v[20:21], v[20:21], v[214:215]
  v_cvt_pk_bf16_f32 v210, v16, v17
  v_cvt_pk_bf16_f32 v211, v20, v21
  v_pk_mul_f32 v[16:17], v[216:217], v[216:217]
  v_pk_mul_f32 v[20:21], v[218:219], v[218:219]
  v_pk_fma_f32 v[16:17], v[16:17], s[44:45], v[30:31]
  v_pk_fma_f32 v[20:21], v[20:21], s[44:45], v[30:31]
  v_pk_mul_f32 v[16:17], v[16:17], v[216:217]
  v_pk_mul_f32 v[20:21], v[20:21], v[218:219]
  v_exp_f32 v16, v16
  v_exp_f32 v17, v17
  v_exp_f32 v20, v20
  v_exp_f32 v21, v21
  v_pk_add_f32 v[16:17], v[16:17], 1.0 op_sel_hi:[1,0]
  v_pk_add_f32 v[20:21], v[20:21], 1.0 op_sel_hi:[1,0]
  v_rcp_f32 v16, v16
  v_rcp_f32 v17, v17
  v_rcp_f32 v20, v20
  v_rcp_f32 v21, v21
  v_pk_mul_f32 v[16:17], v[16:17], v[216:217]
  v_pk_mul_f32 v[20:21], v[20:21], v[218:219]
  v_cvt_pk_bf16_f32 v212, v16, v17
  v_cvt_pk_bf16_f32 v213, v20, v21
  v_pk_mul_f32 v[16:17], v[220:221], v[220:221]
  v_pk_mul_f32 v[20:21], v[222:223], v[222:223]
  v_pk_fma_f32 v[16:17], v[16:17], s[44:45], v[30:31]
  v_pk_fma_f32 v[20:21], v[20:21], s[44:45], v[30:31]
  v_pk_mul_f32 v[16:17], v[16:17], v[220:221]
  v_pk_mul_f32 v[20:21], v[20:21], v[222:223]
  v_exp_f32 v16, v16
  v_exp_f32 v17, v17
  v_exp_f32 v20, v20
  v_exp_f32 v21, v21
  v_pk_add_f32 v[16:17], v[16:17], 1.0 op_sel_hi:[1,0]
  v_pk_add_f32 v[20:21], v[20:21], 1.0 op_sel_hi:[1,0]
  v_rcp_f32 v16, v16
  v_rcp_f32 v17, v17
  v_rcp_f32 v20, v20
  v_rcp_f32 v21, v21
  v_pk_mul_f32 v[16:17], v[16:17], v[220:221]
  v_pk_mul_f32 v[20:21], v[20:21], v[222:223]
  v_cvt_pk_bf16_f32 v214, v16, v17
  v_cvt_pk_bf16_f32 v215, v20, v21
  ds_write_b128 v24, v[208:211] offset:12480
  ds_write_b128 v24, v[212:215] offset:14560
  v_pk_mul_f32 v[16:17], v[224:225], v[224:225]
  v_pk_mul_f32 v[20:21], v[226:227], v[226:227]
  v_pk_fma_f32 v[16:17], v[16:17], s[44:45], v[30:31]
  v_pk_fma_f32 v[20:21], v[20:21], s[44:45], v[30:31]
  v_pk_mul_f32 v[16:17], v[16:17], v[224:225]
  v_pk_mul_f32 v[20:21], v[20:21], v[226:227]
  v_exp_f32 v16, v16
  v_exp_f32 v17, v17
  v_exp_f32 v20, v20
  v_exp_f32 v21, v21
  v_pk_add_f32 v[16:17], v[16:17], 1.0 op_sel_hi:[1,0]
  v_pk_add_f32 v[20:21], v[20:21], 1.0 op_sel_hi:[1,0]
  v_rcp_f32 v16, v16
  v_rcp_f32 v17, v17
  v_rcp_f32 v20, v20
  v_rcp_f32 v21, v21
  v_pk_mul_f32 v[16:17], v[16:17], v[224:225]
  v_pk_mul_f32 v[20:21], v[20:21], v[226:227]
  v_cvt_pk_bf16_f32 v224, v16, v17
  v_cvt_pk_bf16_f32 v225, v20, v21
  v_pk_mul_f32 v[16:17], v[228:229], v[228:229]
  v_pk_mul_f32 v[20:21], v[230:231], v[230:231]
  v_pk_fma_f32 v[16:17], v[16:17], s[44:45], v[30:31]
  v_pk_fma_f32 v[20:21], v[20:21], s[44:45], v[30:31]
  v_pk_mul_f32 v[16:17], v[16:17], v[228:229]
  v_pk_mul_f32 v[20:21], v[20:21], v[230:231]
  v_exp_f32 v16, v16
  v_exp_f32 v17, v17
  v_exp_f32 v20, v20
  v_exp_f32 v21, v21
  v_pk_add_f32 v[16:17], v[16:17], 1.0 op_sel_hi:[1,0]
  v_pk_add_f32 v[20:21], v[20:21], 1.0 op_sel_hi:[1,0]
  v_rcp_f32 v16, v16
  v_rcp_f32 v17, v17
  v_rcp_f32 v20, v20
  v_rcp_f32 v21, v21
  v_pk_mul_f32 v[16:17], v[16:17], v[228:229]
  v_pk_mul_f32 v[20:21], v[20:21], v[230:231]
  v_cvt_pk_bf16_f32 v226, v16, v17
  v_cvt_pk_bf16_f32 v227, v20, v21
  v_pk_mul_f32 v[16:17], v[232:233], v[232:233]
  v_pk_mul_f32 v[20:21], v[234:235], v[234:235]
  v_pk_fma_f32 v[16:17], v[16:17], s[44:45], v[30:31]
  v_pk_fma_f32 v[20:21], v[20:21], s[44:45], v[30:31]
  v_pk_mul_f32 v[16:17], v[16:17], v[232:233]
  v_pk_mul_f32 v[20:21], v[20:21], v[234:235]
  v_exp_f32 v16, v16
  v_exp_f32 v17, v17
  v_exp_f32 v20, v20
  v_exp_f32 v21, v21
  v_pk_add_f32 v[16:17], v[16:17], 1.0 op_sel_hi:[1,0]
  v_pk_add_f32 v[20:21], v[20:21], 1.0 op_sel_hi:[1,0]
  v_rcp_f32 v16, v16
  v_rcp_f32 v17, v17
  v_rcp_f32 v20, v20
  v_rcp_f32 v21, v21
  v_pk_mul_f32 v[16:17], v[16:17], v[232:233]
  v_pk_mul_f32 v[20:21], v[20:21], v[234:235]
  v_cvt_pk_bf16_f32 v228, v16, v17
  v_cvt_pk_bf16_f32 v229, v20, v21
  v_pk_mul_f32 v[16:17], v[236:237], v[236:237]
  v_pk_mul_f32 v[20:21], v[238:239], v[238:239]
  v_pk_fma_f32 v[16:17], v[16:17], s[44:45], v[30:31]
  v_pk_fma_f32 v[20:21], v[20:21], s[44:45], v[30:31]
  v_pk_mul_f32 v[16:17], v[16:17], v[236:237]
  v_pk_mul_f32 v[20:21], v[20:21], v[238:239]
  v_exp_f32 v16, v16
  v_exp_f32 v17, v17
  v_exp_f32 v20, v20
  v_exp_f32 v21, v21
  v_pk_add_f32 v[16:17], v[16:17], 1.0 op_sel_hi:[1,0]
  v_pk_add_f32 v[20:21], v[20:21], 1.0 op_sel_hi:[1,0]
  v_rcp_f32 v16, v16
  v_rcp_f32 v17, v17
  v_rcp_f32 v20, v20
  v_rcp_f32 v21, v21
  v_pk_mul_f32 v[16:17], v[16:17], v[236:237]
  v_pk_mul_f32 v[20:21], v[20:21], v[238:239]
  v_cvt_pk_bf16_f32 v230, v16, v17
  v_cvt_pk_bf16_f32 v231, v20, v21
  ds_write_b128 v24, v[224:227] offset:13504
  ds_write_b128 v24, v[228:231] offset:15584
  v_pk_mul_f32 v[16:17], v[240:241], v[240:241]
  v_pk_mul_f32 v[20:21], v[242:243], v[242:243]
  v_pk_fma_f32 v[16:17], v[16:17], s[44:45], v[30:31]
  v_pk_fma_f32 v[20:21], v[20:21], s[44:45], v[30:31]
  v_pk_mul_f32 v[16:17], v[16:17], v[240:241]
  v_pk_mul_f32 v[20:21], v[20:21], v[242:243]
  v_exp_f32 v16, v16
  v_exp_f32 v17, v17
  v_exp_f32 v20, v20
  v_exp_f32 v21, v21
  v_pk_add_f32 v[16:17], v[16:17], 1.0 op_sel_hi:[1,0]
  v_pk_add_f32 v[20:21], v[20:21], 1.0 op_sel_hi:[1,0]
  v_rcp_f32 v16, v16
  v_rcp_f32 v17, v17
  v_rcp_f32 v20, v20
  v_rcp_f32 v21, v21
  v_pk_mul_f32 v[16:17], v[16:17], v[240:241]
  v_pk_mul_f32 v[20:21], v[20:21], v[242:243]
  v_cvt_pk_bf16_f32 v240, v16, v17
  v_cvt_pk_bf16_f32 v241, v20, v21
  ds_write_b64 v25, v[240:241] offset:0
  v_pk_mul_f32 v[16:17], v[244:245], v[244:245]
  v_pk_mul_f32 v[20:21], v[246:247], v[246:247]
  v_pk_fma_f32 v[16:17], v[16:17], s[44:45], v[30:31]
  v_pk_fma_f32 v[20:21], v[20:21], s[44:45], v[30:31]
  v_pk_mul_f32 v[16:17], v[16:17], v[244:245]
  v_pk_mul_f32 v[20:21], v[20:21], v[246:247]
  v_exp_f32 v16, v16
  v_exp_f32 v17, v17
  v_exp_f32 v20, v20
  v_exp_f32 v21, v21
  v_pk_add_f32 v[16:17], v[16:17], 1.0 op_sel_hi:[1,0]
  v_pk_add_f32 v[20:21], v[20:21], 1.0 op_sel_hi:[1,0]
  v_rcp_f32 v16, v16
  v_rcp_f32 v17, v17
  v_rcp_f32 v20, v20
  v_rcp_f32 v21, v21
  v_pk_mul_f32 v[16:17], v[16:17], v[244:245]
  v_pk_mul_f32 v[20:21], v[20:21], v[246:247]
  v_cvt_pk_bf16_f32 v244, v16, v17
  v_cvt_pk_bf16_f32 v245, v20, v21
  ds_write_b64 v25, v[244:245] offset:256
  v_pk_mul_f32 v[16:17], v[248:249], v[248:249]
  v_pk_mul_f32 v[20:21], v[250:251], v[250:251]
  v_pk_fma_f32 v[16:17], v[16:17], s[44:45], v[30:31]
  v_pk_fma_f32 v[20:21], v[20:21], s[44:45], v[30:31]
  v_pk_mul_f32 v[16:17], v[16:17], v[248:249]
  v_pk_mul_f32 v[20:21], v[20:21], v[250:251]
  v_exp_f32 v16, v16
  v_exp_f32 v17, v17
  v_exp_f32 v20, v20
  v_exp_f32 v21, v21
  v_pk_add_f32 v[16:17], v[16:17], 1.0 op_sel_hi:[1,0]
  v_pk_add_f32 v[20:21], v[20:21], 1.0 op_sel_hi:[1,0]
  v_rcp_f32 v16, v16
  v_rcp_f32 v17, v17
  v_rcp_f32 v20, v20
  v_rcp_f32 v21, v21
  v_pk_mul_f32 v[16:17], v[16:17], v[248:249]
  v_pk_mul_f32 v[20:21], v[20:21], v[250:251]
  v_cvt_pk_bf16_f32 v248, v16, v17
  v_cvt_pk_bf16_f32 v249, v20, v21
  ds_write_b64 v25, v[248:249] offset:1024
  v_pk_mul_f32 v[16:17], v[252:253], v[252:253]
  v_pk_mul_f32 v[20:21], v[254:255], v[254:255]
  v_pk_fma_f32 v[16:17], v[16:17], s[44:45], v[30:31]
  v_pk_fma_f32 v[20:21], v[20:21], s[44:45], v[30:31]
  v_pk_mul_f32 v[16:17], v[16:17], v[252:253]
  v_pk_mul_f32 v[20:21], v[20:21], v[254:255]
  v_exp_f32 v16, v16
  v_exp_f32 v17, v17
  v_exp_f32 v20, v20
  v_exp_f32 v21, v21
  v_pk_add_f32 v[16:17], v[16:17], 1.0 op_sel_hi:[1,0]
  v_pk_add_f32 v[20:21], v[20:21], 1.0 op_sel_hi:[1,0]
  v_rcp_f32 v16, v16
  v_rcp_f32 v17, v17
  v_rcp_f32 v20, v20
  v_rcp_f32 v21, v21
  v_pk_mul_f32 v[16:17], v[16:17], v[252:253]
  v_pk_mul_f32 v[20:21], v[20:21], v[254:255]
  v_cvt_pk_bf16_f32 v252, v16, v17
  v_cvt_pk_bf16_f32 v253, v20, v21
  ds_write_b64 v25, v[252:253] offset:1280
  s_waitcnt lgkmcnt(0)
  s_mov_b64 exec, 1
  ds_add_u32 v84, v85 offset:8
  s_mov_b64 exec, -1

  s_setprio 0
  v_sub_f32 v86, 1.0, v86
  v_sub_f32 v87, 1.0, v87
  v_sub_f32 v88, 1.0, v88
  v_sub_f32 v89, 1.0, v89
  v_sub_f32 v90, 1.0, v90
  v_sub_f32 v91, 1.0, v91
  v_mov_b32 v16, v105
  v_mov_b32 v17, 0
  v_mov_b32 v18, 0
  v_mov_b32 v19, 0
  v_mov_b32 v20, v106
  v_mov_b32 v21, 0
  v_mov_b32 v22, 0
  v_mov_b32 v23, 0
  v_mov_b32 v24, v107
  v_mov_b32 v25, 0
  v_mov_b32 v26, 0
  v_mov_b32 v27, 0
  v_mov_b32 v28, v108
  v_mov_b32 v29, 0
  v_mov_b32 v30, 0
  v_mov_b32 v31, 0
  v_mov_b32 v64, v109
  v_mov_b32 v65, 0
  v_mov_b32 v66, 0
  v_mov_b32 v67, 0
  v_mov_b32 v15, 0x3f80
  v_cmp_gt_u32 vcc, 32, v1
  v_mov_b32 v33, 0
  v_mov_b32 v34, 0
  v_cndmask_b32 v32, 0, v15, vcc
  v_mov_b32 v35, 0
  v_cmp_gt_u32 vcc, 16, v1
  v_mov_b32 v69, 0
  v_mov_b32 v70, 0
  v_cndmask_b32 v68, 0, v15, vcc
  v_mov_b32 v71, 0
  s_nop 1

  v_mfma_f32_32x32x16_bf16 v[112:127], v[16:19], v[32:35], 0
  v_mfma_f32_32x32x16_bf16 v[128:143], v[16:19], v[32:35], 0
  v_mfma_f32_32x32x16_bf16 v[144:159], v[20:23], v[32:35], 0
  v_mfma_f32_32x32x16_bf16 v[160:175], v[20:23], v[32:35], 0
  v_mfma_f32_32x32x16_bf16 v[176:191], v[24:27], v[32:35], 0
  v_mfma_f32_32x32x16_bf16 v[192:207], v[24:27], v[32:35], 0
  v_mfma_f32_32x32x16_bf16 v[208:223], v[28:31], v[32:35], 0
  v_mfma_f32_32x32x16_bf16 v[224:239], v[28:31], v[32:35], 0
  v_mfma_f32_16x16x32_bf16 v[240:243], v[64:67], v[68:71], 0
  v_mfma_f32_16x16x32_bf16 v[244:247], v[64:67], v[68:71], 0
  v_mfma_f32_16x16x32_bf16 v[248:251], v[64:67], v[68:71], 0
  v_mfma_f32_16x16x32_bf16 v[252:255], v[64:67], v[68:71], 0
  v_lshrrev_b32 v16, 5, v1
  v_bfe_u32 v17, v1, 4, 1
  v_bfe_u32 v18, v1, 2, 2
  v_and_b32 v19, 3, v1
  v_lshl_add_u32 v20, v16, 2, v18
  v_lshlrev_b32 v20, 8, v20
  v_lshl_add_u32 v20, v17, 5, v20
  v_lshl_add_u32 v20, v19, 3, v20
  v_add_u32 v20, s33, v20

  v_xor_b32 v21, 0, v18
  v_lshl_add_u32 v8, v21, 6, v20
  v_xor_b32 v21, 1, v18
  v_lshl_add_u32 v9, v21, 6, v20
  v_xor_b32 v21, 2, v18
  v_lshl_add_u32 v10, v21, 6, v20
  v_xor_b32 v21, 3, v18
  v_lshl_add_u32 v11, v21, 6, v20
  v_lshlrev_b32 v21, 4, v16
  v_lshl_add_u32 v21, v17, 2, v21
  v_add_u32 v21, v21, v18
  v_lshlrev_b32 v21, 5, v21
  v_lshl_add_u32 v21, v19, 3, v21
  v_add_u32 v12, s33, v21

  v_lshlrev_b32 v2, 4, v1
  v_add_u32 v2, 0, v2
  v_lshrrev_b32 v16, 5, v1
  v_mul_u32_u24 v16, 2080, v16
  v_bfe_u32 v17, v1, 4, 1
  v_lshl_add_u32 v16, v17, 9, v16
  v_and_b32 v17, 15, v1
  v_lshl_add_u32 v16, v17, 4, v16
  v_add_u32 v6, 0, v16

  s_mov_b32 s39, 0x40000
WAITC_15:
  ds_read_b32 v15, v84 offset:8
  s_waitcnt lgkmcnt(0)
  v_readfirstlane_b32 s38, v15
  s_cmp_ge_u32 s38, 4
  s_cbranch_scc1 WAITD_16
  s_sleep 1
  s_sub_u32 s39, s39, 1
  s_cmp_lg_u32 s39, 0
  s_cbranch_scc1 WAITC_15

WAITD_16:
  ds_read_b128 v[32:35], v2 offset:0
  ds_read_b128 v[36:39], v2 offset:1024
  ds_read_b64_tr_b16 v[16:17], v8 offset:0
  ds_read_b64_tr_b16 v[18:19], v8 offset:2048
  ds_read_b64_tr_b16 v[20:21], v9 offset:0
  ds_read_b64_tr_b16 v[22:23], v9 offset:2048
  ds_read_b64_tr_b16 v[24:25], v10 offset:0
  ds_read_b64_tr_b16 v[26:27], v10 offset:2048
  ds_read_b64_tr_b16 v[28:29], v11 offset:0
  ds_read_b64_tr_b16 v[30:31], v11 offset:2048
  s_mov_b32 s34, 8
.p2align 6
G2_LOOP:
  s_waitcnt vmcnt(9) lgkmcnt(0)
  v_mfma_f32_32x32x16_bf16 v[112:127], v[16:19], v[32:35], v[112:127]
  ds_read_b128 v[56:59], v2 offset:2080
  ds_read_b128 v[60:63], v2 offset:3104
  ds_read_b64_tr_b16 v[40:41], v8 offset:4096
  v_mfma_f32_32x32x16_bf16 v[128:143], v[16:19], v[36:39], v[128:143]
  ds_read_b64_tr_b16 v[42:43], v8 offset:6144
  ds_read_b64_tr_b16 v[44:45], v9 offset:4096
  ds_read_b64_tr_b16 v[46:47], v9 offset:6144
  v_mfma_f32_32x32x16_bf16 v[144:159], v[20:23], v[32:35], v[144:159]
  ds_read_b64_tr_b16 v[48:49], v10 offset:4096
  ds_read_b64_tr_b16 v[50:51], v10 offset:6144
  ds_read_b64_tr_b16 v[52:53], v11 offset:4096
  v_mfma_f32_32x32x16_bf16 v[160:175], v[20:23], v[36:39], v[160:175]
  ds_read_b64_tr_b16 v[54:55], v11 offset:6144
  ds_read_b64_tr_b16 v[64:65], v12 offset:8192
  ds_read_b64_tr_b16 v[66:67], v12 offset:8448
  v_mfma_f32_32x32x16_bf16 v[176:191], v[24:27], v[32:35], v[176:191]
  ds_read_b128 v[68:71], v6 offset:0
  ds_read_b128 v[72:75], v6 offset:256
  ds_read_b128 v[76:79], v6 offset:1024
  s_add_u32 m0, s33, 0
  s_nop 0
  buffer_load_dwordx4 v92, s[4:7], s31 offen lds
  s_add_u32 s31, s31, s32
  v_mfma_f32_32x32x16_bf16 v[192:207], v[24:27], v[36:39], v[192:207]
  ds_read_b128 v[80:83], v6 offset:1280
  s_add_u32 m0, s33, 1024
  s_nop 0
  buffer_load_dwordx4 v92, s[4:7], s31 offen lds
  s_add_u32 s31, s31, s32
  v_mfma_f32_32x32x16_bf16 v[208:223], v[28:31], v[32:35], v[208:223]
  s_add_u32 m0, s33, 2048
  s_nop 0
  buffer_load_dwordx4 v92, s[4:7], s31 offen lds
  s_add_u32 s31, s31, s32
  v_mfma_f32_32x32x16_bf16 v[224:239], v[28:31], v[36:39], v[224:239]
  s_add_u32 m0, s33, 3072
  s_nop 0
  buffer_load_dwordx4 v92, s[4:7], s31 offen lds
  s_add_u32 s31, s31, s32
  s_waitcnt vmcnt(9) lgkmcnt(0)
  v_mfma_f32_32x32x16_bf16 v[112:127], v[40:43], v[56:59], v[112:127]
  ds_read_b128 v[32:35], v2 offset:4160
  ds_read_b128 v[36:39], v2 offset:5184
  ds_read_b64_tr_b16 v[16:17], v8 offset:36864
  v_mfma_f32_32x32x16_bf16 v[128:143], v[40:43], v[60:63], v[128:143]
  ds_read_b64_tr_b16 v[18:19], v8 offset:38912
  ds_read_b64_tr_b16 v[20:21], v9 offset:36864
  ds_read_b64_tr_b16 v[22:23], v9 offset:38912
  v_mfma_f32_32x32x16_bf16 v[144:159], v[44:47], v[56:59], v[144:159]
  ds_read_b64_tr_b16 v[24:25], v10 offset:36864
  ds_read_b64_tr_b16 v[26:27], v10 offset:38912
  ds_read_b64_tr_b16 v[28:29], v11 offset:36864
  s_add_u32 m0, s33, 4096
  s_nop 0
  buffer_load_dwordx4 v92, s[4:7], s31 offen lds
  s_add_u32 s31, s31, s32
  v_mfma_f32_32x32x16_bf16 v[160:175], v[44:47], v[60:63], v[160:175]
  ds_read_b64_tr_b16 v[30:31], v11 offset:38912
  s_add_u32 m0, s33, 5120
  s_nop 0
  buffer_load_dwordx4 v92, s[4:7], s31 offen lds
  s_add_u32 s31, s31, s32
  v_mfma_f32_32x32x16_bf16 v[176:191], v[48:51], v[56:59], v[176:191]
  s_add_u32 m0, s33, 6144
  s_nop 0
  buffer_load_dwordx4 v92, s[4:7], s31 offen lds
  s_add_u32 s31, s31, s32
  v_mfma_f32_32x32x16_bf16 v[192:207], v[48:51], v[60:63], v[192:207]
  s_add_u32 m0, s33, 7168
  s_nop 0
  buffer_load_dwordx4 v92, s[4:7], s31 offen lds
  s_add_u32 s31, s31, s32
  v_mfma_f32_32x32x16_bf16 v[208:223], v[52:55], v[56:59], v[208:223]
  s_add_u32 m0, s33, 8192
  s_lshl_b32 s35, s32, 3
  s_sub_u32 s35, s31, s35
  buffer_load_dwordx4 v93, s[4:7], s35 offen lds
  v_mfma_f32_32x32x16_bf16 v[224:239], v[52:55], v[60:63], v[224:239]
  v_mfma_f32_16x16x32_bf16 v[240:243], v[64:67], v[68:71], v[240:243]
  v_mfma_f32_16x16x32_bf16 v[244:247], v[64:67], v[72:75], v[244:247]
  v_mfma_f32_16x16x32_bf16 v[248:251], v[64:67], v[76:79], v[248:251]
  v_mfma_f32_16x16x32_bf16 v[252:255], v[64:67], v[80:83], v[252:255]
  s_waitcnt vmcnt(9) lgkmcnt(0)
  v_mfma_f32_32x32x16_bf16 v[112:127], v[16:19], v[32:35], v[112:127]
  ds_read_b128 v[56:59], v2 offset:6240
  ds_read_b128 v[60:63], v2 offset:7264
  ds_read_b64_tr_b16 v[40:41], v8 offset:40960
  v_mfma_f32_32x32x16_bf16 v[128:143], v[16:19], v[36:39], v[128:143]
  ds_read_b64_tr_b16 v[42:43], v8 offset:43008
  ds_read_b64_tr_b16 v[44:45], v9 offset:40960
  ds_read_b64_tr_b16 v[46:47], v9 offset:43008
  v_mfma_f32_32x32x16_bf16 v[144:159], v[20:23], v[32:35], v[144:159]
  ds_read_b64_tr_b16 v[48:49], v10 offset:40960
  ds_read_b64_tr_b16 v[50:51], v10 offset:43008
  ds_read_b64_tr_b16 v[52:53], v11 offset:40960
  v_mfma_f32_32x32x16_bf16 v[160:175], v[20:23], v[36:39], v[160:175]
  ds_read_b64_tr_b16 v[54:55], v11 offset:43008
  ds_read_b64_tr_b16 v[64:65], v12 offset:45056
  ds_read_b64_tr_b16 v[66:67], v12 offset:45312
  v_mfma_f32_32x32x16_bf16 v[176:191], v[24:27], v[32:35], v[176:191]
  ds_read_b128 v[68:71], v6 offset:4160
  ds_read_b128 v[72:75], v6 offset:4416
  ds_read_b128 v[76:79], v6 offset:5184
  s_add_u32 m0, s33, 36864
  s_nop 0
  buffer_load_dwordx4 v92, s[4:7], s31 offen lds
  s_add_u32 s31, s31, s32
  v_mfma_f32_32x32x16_bf16 v[192:207], v[24:27], v[36:39], v[192:207]
  ds_read_b128 v[80:83], v6 offset:5440
  s_add_u32 m0, s33, 37888
  s_nop 0
  buffer_load_dwordx4 v92, s[4:7], s31 offen lds
  s_add_u32 s31, s31, s32
  v_mfma_f32_32x32x16_bf16 v[208:223], v[28:31], v[32:35], v[208:223]
  s_add_u32 m0, s33, 38912
  s_nop 0
  buffer_load_dwordx4 v92, s[4:7], s31 offen lds
  s_add_u32 s31, s31, s32
  v_mfma_f32_32x32x16_bf16 v[224:239], v[28:31], v[36:39], v[224:239]
  s_add_u32 m0, s33, 39936
  s_nop 0
  buffer_load_dwordx4 v92, s[4:7], s31 offen lds
  s_add_u32 s31, s31, s32
  s_waitcnt vmcnt(9) lgkmcnt(0)
  v_mfma_f32_32x32x16_bf16 v[112:127], v[40:43], v[56:59], v[112:127]
  ds_read_b128 v[32:35], v2 offset:8320
  ds_read_b128 v[36:39], v2 offset:9344
  ds_read_b64_tr_b16 v[16:17], v8 offset:0
  v_mfma_f32_32x32x16_bf16 v[128:143], v[40:43], v[60:63], v[128:143]
  ds_read_b64_tr_b16 v[18:19], v8 offset:2048
  ds_read_b64_tr_b16 v[20:21], v9 offset:0
  ds_read_b64_tr_b16 v[22:23], v9 offset:2048
  v_mfma_f32_32x32x16_bf16 v[144:159], v[44:47], v[56:59], v[144:159]
  ds_read_b64_tr_b16 v[24:25], v10 offset:0
  ds_read_b64_tr_b16 v[26:27], v10 offset:2048
  ds_read_b64_tr_b16 v[28:29], v11 offset:0
  s_add_u32 m0, s33, 40960
  s_nop 0
  buffer_load_dwordx4 v92, s[4:7], s31 offen lds
  s_add_u32 s31, s31, s32
  v_mfma_f32_32x32x16_bf16 v[160:175], v[44:47], v[60:63], v[160:175]
  ds_read_b64_tr_b16 v[30:31], v11 offset:2048
  s_add_u32 m0, s33, 41984
  s_nop 0
  buffer_load_dwordx4 v92, s[4:7], s31 offen lds
  s_add_u32 s31, s31, s32
  v_mfma_f32_32x32x16_bf16 v[176:191], v[48:51], v[56:59], v[176:191]
  s_add_u32 m0, s33, 43008
  s_nop 0
  buffer_load_dwordx4 v92, s[4:7], s31 offen lds
  s_add_u32 s31, s31, s32
  v_mfma_f32_32x32x16_bf16 v[192:207], v[48:51], v[60:63], v[192:207]
  s_add_u32 m0, s33, 44032
  s_nop 0
  buffer_load_dwordx4 v92, s[4:7], s31 offen lds
  s_add_u32 s31, s31, s32
  v_mfma_f32_32x32x16_bf16 v[208:223], v[52:55], v[56:59], v[208:223]
  s_add_u32 m0, s33, 45056
  s_lshl_b32 s35, s32, 3
  s_sub_u32 s35, s31, s35
  buffer_load_dwordx4 v93, s[4:7], s35 offen lds
  v_mfma_f32_32x32x16_bf16 v[224:239], v[52:55], v[60:63], v[224:239]
  v_mfma_f32_16x16x32_bf16 v[240:243], v[64:67], v[68:71], v[240:243]
  v_mfma_f32_16x16x32_bf16 v[244:247], v[64:67], v[72:75], v[244:247]
  v_mfma_f32_16x16x32_bf16 v[248:251], v[64:67], v[76:79], v[248:251]
  v_mfma_f32_16x16x32_bf16 v[252:255], v[64:67], v[80:83], v[252:255]
  s_cmp_lg_u32 s34, 5
  s_cbranch_scc1 G2H_17
  s_mov_b64 exec, 1
  ds_add_u32 v84, v85 offset:12
  s_mov_b64 exec, -1

G2H_17:
  v_add_u32 v2, 8320, v2
  v_add_u32 v6, 8320, v6
  s_sub_u32 s34, s34, 1
  s_cmp_lg_u32 s34, 0
  s_cbranch_scc1 G2_LOOP

  s_waitcnt vmcnt(9) lgkmcnt(0)
  v_mfma_f32_32x32x16_bf16 v[112:127], v[16:19], v[32:35], v[112:127]
  ds_read_b128 v[56:59], v2 offset:2080
  ds_read_b128 v[60:63], v2 offset:3104
  ds_read_b64_tr_b16 v[40:41], v8 offset:4096
  v_mfma_f32_32x32x16_bf16 v[128:143], v[16:19], v[36:39], v[128:143]
  ds_read_b64_tr_b16 v[42:43], v8 offset:6144
  ds_read_b64_tr_b16 v[44:45], v9 offset:4096
  ds_read_b64_tr_b16 v[46:47], v9 offset:6144
  v_mfma_f32_32x32x16_bf16 v[144:159], v[20:23], v[32:35], v[144:159]
  ds_read_b64_tr_b16 v[48:49], v10 offset:4096
  ds_read_b64_tr_b16 v[50:51], v10 offset:6144
  ds_read_b64_tr_b16 v[52:53], v11 offset:4096
  v_mfma_f32_32x32x16_bf16 v[160:175], v[20:23], v[36:39], v[160:175]
  ds_read_b64_tr_b16 v[54:55], v11 offset:6144
  ds_read_b64_tr_b16 v[64:65], v12 offset:8192
  ds_read_b64_tr_b16 v[66:67], v12 offset:8448
  v_mfma_f32_32x32x16_bf16 v[176:191], v[24:27], v[32:35], v[176:191]
  ds_read_b128 v[68:71], v6 offset:0
  ds_read_b128 v[72:75], v6 offset:256
  ds_read_b128 v[76:79], v6 offset:1024
  s_add_u32 m0, s33, 0
  s_mov_b32 s35, 0
  buffer_load_dwordx4 v94, s[16:19], s35 offen lds
  v_mfma_f32_32x32x16_bf16 v[192:207], v[24:27], v[36:39], v[192:207]
  ds_read_b128 v[80:83], v6 offset:1280
  s_add_u32 m0, s33, 1024
  s_mov_b32 s35, 4608
  buffer_load_dwordx4 v94, s[16:19], s35 offen lds
  v_mfma_f32_32x32x16_bf16 v[208:223], v[28:31], v[32:35], v[208:223]
  s_add_u32 m0, s33, 2048
  s_mov_b32 s35, 9216
  buffer_load_dwordx4 v94, s[16:19], s35 offen lds
  v_mfma_f32_32x32x16_bf16 v[224:239], v[28:31], v[36:39], v[224:239]
  s_add_u32 m0, s33, 3072
  s_mov_b32 s35, 13824
  buffer_load_dwordx4 v94, s[16:19], s35 offen lds
  s_waitcnt vmcnt(9) lgkmcnt(0)
  v_mfma_f32_32x32x16_bf16 v[112:127], v[40:43], v[56:59], v[112:127]
  ds_read_b128 v[32:35], v2 offset:4160
  ds_read_b128 v[36:39], v2 offset:5184
  ds_read_b64_tr_b16 v[16:17], v8 offset:36864
  v_mfma_f32_32x32x16_bf16 v[128:143], v[40:43], v[60:63], v[128:143]
  ds_read_b64_tr_b16 v[18:19], v8 offset:38912
  ds_read_b64_tr_b16 v[20:21], v9 offset:36864
  ds_read_b64_tr_b16 v[22:23], v9 offset:38912
  v_mfma_f32_32x32x16_bf16 v[144:159], v[44:47], v[56:59], v[144:159]
  ds_read_b64_tr_b16 v[24:25], v10 offset:36864
  ds_read_b64_tr_b16 v[26:27], v10 offset:38912
  ds_read_b64_tr_b16 v[28:29], v11 offset:36864
  s_add_u32 m0, s33, 4096
  s_mov_b32 s35, 18432
  buffer_load_dwordx4 v95, s[16:19], s35 offen lds
  v_mfma_f32_32x32x16_bf16 v[160:175], v[44:47], v[60:63], v[160:175]
  ds_read_b64_tr_b16 v[30:31], v11 offset:38912
  s_add_u32 m0, s33, 5120
  s_mov_b32 s35, 0
  buffer_load_dwordx4 v96, s[16:19], s35 offen lds
  v_mfma_f32_32x32x16_bf16 v[176:191], v[48:51], v[56:59], v[176:191]
  s_add_u32 m0, s33, 6144
  s_mov_b32 s35, 20736
  buffer_load_dwordx4 v94, s[16:19], s35 offen lds
  v_mfma_f32_32x32x16_bf16 v[192:207], v[48:51], v[60:63], v[192:207]
  s_add_u32 m0, s33, 7168
  s_mov_b32 s35, 25344
  buffer_load_dwordx4 v94, s[16:19], s35 offen lds
  v_mfma_f32_32x32x16_bf16 v[208:223], v[52:55], v[56:59], v[208:223]
  s_add_u32 m0, s33, 8192
  s_nop 0
  buffer_load_dwordx4 v97, s[16:19], 0 offen lds
  v_mfma_f32_32x32x16_bf16 v[224:239], v[52:55], v[60:63], v[224:239]
  v_mfma_f32_16x16x32_bf16 v[240:243], v[64:67], v[68:71], v[240:243]
  v_mfma_f32_16x16x32_bf16 v[244:247], v[64:67], v[72:75], v[244:247]
  v_mfma_f32_16x16x32_bf16 v[248:251], v[64:67], v[76:79], v[248:251]
  v_mfma_f32_16x16x32_bf16 v[252:255], v[64:67], v[80:83], v[252:255]
  s_waitcnt vmcnt(9) lgkmcnt(0)
  v_mfma_f32_32x32x16_bf16 v[112:127], v[16:19], v[32:35], v[112:127]
  ds_read_b128 v[56:59], v2 offset:6240
  ds_read_b128 v[60:63], v2 offset:7264
  ds_read_b64_tr_b16 v[40:41], v8 offset:40960
  v_mfma_f32_32x32x16_bf16 v[128:143], v[16:19], v[36:39], v[128:143]
  ds_read_b64_tr_b16 v[42:43], v8 offset:43008
  ds_read_b64_tr_b16 v[44:45], v9 offset:40960
  ds_read_b64_tr_b16 v[46:47], v9 offset:43008
  v_mfma_f32_32x32x16_bf16 v[144:159], v[20:23], v[32:35], v[144:159]
  ds_read_b64_tr_b16 v[48:49], v10 offset:40960
  ds_read_b64_tr_b16 v[50:51], v10 offset:43008
  ds_read_b64_tr_b16 v[52:53], v11 offset:40960
  v_mfma_f32_32x32x16_bf16 v[160:175], v[20:23], v[36:39], v[160:175]
  ds_read_b64_tr_b16 v[54:55], v11 offset:43008
  ds_read_b64_tr_b16 v[64:65], v12 offset:45056
  ds_read_b64_tr_b16 v[66:67], v12 offset:45312
  v_mfma_f32_32x32x16_bf16 v[176:191], v[24:27], v[32:35], v[176:191]
  ds_read_b128 v[68:71], v6 offset:4160
  ds_read_b128 v[72:75], v6 offset:4416
  ds_read_b128 v[76:79], v6 offset:5184
  s_add_u32 m0, s33, 36864
  s_mov_b32 s35, 29952
  buffer_load_dwordx4 v94, s[16:19], s35 offen lds
  v_mfma_f32_32x32x16_bf16 v[192:207], v[24:27], v[36:39], v[192:207]
  ds_read_b128 v[80:83], v6 offset:5440
  s_add_u32 m0, s33, 37888
  s_mov_b32 s35, 34560
  buffer_load_dwordx4 v94, s[16:19], s35 offen lds
  v_mfma_f32_32x32x16_bf16 v[208:223], v[28:31], v[32:35], v[208:223]
  s_add_u32 m0, s33, 38912
  s_mov_b32 s35, 39168
  buffer_load_dwordx4 v95, s[16:19], s35 offen lds
  v_mfma_f32_32x32x16_bf16 v[224:239], v[28:31], v[36:39], v[224:239]
  s_add_u32 m0, s33, 39936
  s_mov_b32 s35, 0
  buffer_load_dwordx4 v96, s[16:19], s35 offen lds
  s_waitcnt vmcnt(9) lgkmcnt(0)
  v_mfma_f32_32x32x16_bf16 v[112:127], v[40:43], v[56:59], v[112:127]
  s_add_u32 m0, s33, 40960
  s_mov_b32 s35, 41472
  buffer_load_dwordx4 v94, s[16:19], s35 offen lds
  v_mfma_f32_32x32x16_bf16 v[128:143], v[40:43], v[60:63], v[128:143]
  s_add_u32 m0, s33, 41984
  s_mov_b32 s35, 46080
  buffer_load_dwordx4 v94, s[16:19], s35 offen lds
  v_mfma_f32_32x32x16_bf16 v[144:159], v[44:47], v[56:59], v[144:159]
  s_add_u32 m0, s33, 43008
  s_mov_b32 s35, 50688
  buffer_load_dwordx4 v94, s[16:19], s35 offen lds
  v_mfma_f32_32x32x16_bf16 v[160:175], v[44:47], v[60:63], v[160:175]
  s_add_u32 m0, s33, 44032
  s_mov_b32 s35, 55296
  buffer_load_dwordx4 v94, s[16:19], s35 offen lds
  v_mfma_f32_32x32x16_bf16 v[176:191], v[48:51], v[56:59], v[176:191]
  s_add_u32 m0, s33, 45056
  s_nop 0
  buffer_load_dwordx4 v98, s[16:19], 0 offen lds
  v_mfma_f32_32x32x16_bf16 v[192:207], v[48:51], v[60:63], v[192:207]
  v_mfma_f32_32x32x16_bf16 v[208:223], v[52:55], v[56:59], v[208:223]
  v_mfma_f32_32x32x16_bf16 v[224:239], v[52:55], v[60:63], v[224:239]
  v_mfma_f32_16x16x32_bf16 v[240:243], v[64:67], v[68:71], v[240:243]
  v_mfma_f32_16x16x32_bf16 v[244:247], v[64:67], v[72:75], v[244:247]
  v_mfma_f32_16x16x32_bf16 v[248:251], v[64:67], v[76:79], v[248:251]
  v_mfma_f32_16x16x32_bf16 v[252:255], v[64:67], v[80:83], v[252:255]
  s_waitcnt lgkmcnt(0)
  s_mov_b64 exec, 1
  ds_add_u32 v84, v85 offset:84
  s_mov_b64 exec, -1

  s_nop 15
  v_pk_mul_f32 v[112:113], v[112:113], v[86:87] op_sel:[0,0] op_sel_hi:[1,0]
  v_pk_mul_f32 v[114:115], v[114:115], v[86:87] op_sel:[0,0] op_sel_hi:[1,0]
  v_pk_mul_f32 v[116:117], v[116:117], v[86:87] op_sel:[0,0] op_sel_hi:[1,0]
  v_pk_mul_f32 v[118:119], v[118:119], v[86:87] op_sel:[0,0] op_sel_hi:[1,0]
  v_pk_mul_f32 v[120:121], v[120:121], v[86:87] op_sel:[0,0] op_sel_hi:[1,0]
  v_pk_mul_f32 v[122:123], v[122:123], v[86:87] op_sel:[0,0] op_sel_hi:[1,0]
  v_pk_mul_f32 v[124:125], v[124:125], v[86:87] op_sel:[0,0] op_sel_hi:[1,0]
  v_pk_mul_f32 v[126:127], v[126:127], v[86:87] op_sel:[0,0] op_sel_hi:[1,0]
  v_pk_mul_f32 v[128:129], v[128:129], v[86:87] op_sel:[0,1] op_sel_hi:[1,1]
  v_pk_mul_f32 v[130:131], v[130:131], v[86:87] op_sel:[0,1] op_sel_hi:[1,1]
  v_pk_mul_f32 v[132:133], v[132:133], v[86:87] op_sel:[0,1] op_sel_hi:[1,1]
  v_pk_mul_f32 v[134:135], v[134:135], v[86:87] op_sel:[0,1] op_sel_hi:[1,1]
  v_pk_mul_f32 v[136:137], v[136:137], v[86:87] op_sel:[0,1] op_sel_hi:[1,1]
  v_pk_mul_f32 v[138:139], v[138:139], v[86:87] op_sel:[0,1] op_sel_hi:[1,1]
  v_pk_mul_f32 v[140:141], v[140:141], v[86:87] op_sel:[0,1] op_sel_hi:[1,1]
  v_pk_mul_f32 v[142:143], v[142:143], v[86:87] op_sel:[0,1] op_sel_hi:[1,1]
  v_pk_mul_f32 v[144:145], v[144:145], v[86:87] op_sel:[0,0] op_sel_hi:[1,0]
  v_pk_mul_f32 v[146:147], v[146:147], v[86:87] op_sel:[0,0] op_sel_hi:[1,0]
  v_pk_mul_f32 v[148:149], v[148:149], v[86:87] op_sel:[0,0] op_sel_hi:[1,0]
  v_pk_mul_f32 v[150:151], v[150:151], v[86:87] op_sel:[0,0] op_sel_hi:[1,0]
  v_pk_mul_f32 v[152:153], v[152:153], v[86:87] op_sel:[0,0] op_sel_hi:[1,0]
  v_pk_mul_f32 v[154:155], v[154:155], v[86:87] op_sel:[0,0] op_sel_hi:[1,0]
  v_pk_mul_f32 v[156:157], v[156:157], v[86:87] op_sel:[0,0] op_sel_hi:[1,0]
  v_pk_mul_f32 v[158:159], v[158:159], v[86:87] op_sel:[0,0] op_sel_hi:[1,0]
  v_pk_mul_f32 v[160:161], v[160:161], v[86:87] op_sel:[0,1] op_sel_hi:[1,1]
  v_pk_mul_f32 v[162:163], v[162:163], v[86:87] op_sel:[0,1] op_sel_hi:[1,1]
  v_pk_mul_f32 v[164:165], v[164:165], v[86:87] op_sel:[0,1] op_sel_hi:[1,1]
  v_pk_mul_f32 v[166:167], v[166:167], v[86:87] op_sel:[0,1] op_sel_hi:[1,1]
  v_pk_mul_f32 v[168:169], v[168:169], v[86:87] op_sel:[0,1] op_sel_hi:[1,1]
  v_pk_mul_f32 v[170:171], v[170:171], v[86:87] op_sel:[0,1] op_sel_hi:[1,1]
  v_pk_mul_f32 v[172:173], v[172:173], v[86:87] op_sel:[0,1] op_sel_hi:[1,1]
  v_pk_mul_f32 v[174:175], v[174:175], v[86:87] op_sel:[0,1] op_sel_hi:[1,1]
  v_pk_mul_f32 v[176:177], v[176:177], v[86:87] op_sel:[0,0] op_sel_hi:[1,0]
  v_pk_mul_f32 v[178:179], v[178:179], v[86:87] op_sel:[0,0] op_sel_hi:[1,0]
  v_pk_mul_f32 v[180:181], v[180:181], v[86:87] op_sel:[0,0] op_sel_hi:[1,0]
  v_pk_mul_f32 v[182:183], v[182:183], v[86:87] op_sel:[0,0] op_sel_hi:[1,0]
  v_pk_mul_f32 v[184:185], v[184:185], v[86:87] op_sel:[0,0] op_sel_hi:[1,0]
  v_pk_mul_f32 v[186:187], v[186:187], v[86:87] op_sel:[0,0] op_sel_hi:[1,0]
  v_pk_mul_f32 v[188:189], v[188:189], v[86:87] op_sel:[0,0] op_sel_hi:[1,0]
  v_pk_mul_f32 v[190:191], v[190:191], v[86:87] op_sel:[0,0] op_sel_hi:[1,0]
  v_pk_mul_f32 v[192:193], v[192:193], v[86:87] op_sel:[0,1] op_sel_hi:[1,1]
  v_pk_mul_f32 v[194:195], v[194:195], v[86:87] op_sel:[0,1] op_sel_hi:[1,1]
  v_pk_mul_f32 v[196:197], v[196:197], v[86:87] op_sel:[0,1] op_sel_hi:[1,1]
  v_pk_mul_f32 v[198:199], v[198:199], v[86:87] op_sel:[0,1] op_sel_hi:[1,1]
  v_pk_mul_f32 v[200:201], v[200:201], v[86:87] op_sel:[0,1] op_sel_hi:[1,1]
  v_pk_mul_f32 v[202:203], v[202:203], v[86:87] op_sel:[0,1] op_sel_hi:[1,1]
  v_pk_mul_f32 v[204:205], v[204:205], v[86:87] op_sel:[0,1] op_sel_hi:[1,1]
  v_pk_mul_f32 v[206:207], v[206:207], v[86:87] op_sel:[0,1] op_sel_hi:[1,1]
  v_pk_mul_f32 v[208:209], v[208:209], v[86:87] op_sel:[0,0] op_sel_hi:[1,0]
  v_pk_mul_f32 v[210:211], v[210:211], v[86:87] op_sel:[0,0] op_sel_hi:[1,0]
  v_pk_mul_f32 v[212:213], v[212:213], v[86:87] op_sel:[0,0] op_sel_hi:[1,0]
  v_pk_mul_f32 v[214:215], v[214:215], v[86:87] op_sel:[0,0] op_sel_hi:[1,0]
  v_pk_mul_f32 v[216:217], v[216:217], v[86:87] op_sel:[0,0] op_sel_hi:[1,0]
  v_pk_mul_f32 v[218:219], v[218:219], v[86:87] op_sel:[0,0] op_sel_hi:[1,0]
  v_pk_mul_f32 v[220:221], v[220:221], v[86:87] op_sel:[0,0] op_sel_hi:[1,0]
  v_pk_mul_f32 v[222:223], v[222:223], v[86:87] op_sel:[0,0] op_sel_hi:[1,0]
  v_pk_mul_f32 v[224:225], v[224:225], v[86:87] op_sel:[0,1] op_sel_hi:[1,1]
  v_pk_mul_f32 v[226:227], v[226:227], v[86:87] op_sel:[0,1] op_sel_hi:[1,1]
  v_pk_mul_f32 v[228:229], v[228:229], v[86:87] op_sel:[0,1] op_sel_hi:[1,1]
  v_pk_mul_f32 v[230:231], v[230:231], v[86:87] op_sel:[0,1] op_sel_hi:[1,1]
  v_pk_mul_f32 v[232:233], v[232:233], v[86:87] op_sel:[0,1] op_sel_hi:[1,1]
  v_pk_mul_f32 v[234:235], v[234:235], v[86:87] op_sel:[0,1] op_sel_hi:[1,1]
  v_pk_mul_f32 v[236:237], v[236:237], v[86:87] op_sel:[0,1] op_sel_hi:[1,1]
  v_pk_mul_f32 v[238:239], v[238:239], v[86:87] op_sel:[0,1] op_sel_hi:[1,1]
  v_pk_mul_f32 v[240:241], v[240:241], v[88:89] op_sel:[0,0] op_sel_hi:[1,0]
  v_pk_mul_f32 v[242:243], v[242:243], v[88:89] op_sel:[0,0] op_sel_hi:[1,0]
  v_pk_mul_f32 v[244:245], v[244:245], v[88:89] op_sel:[0,1] op_sel_hi:[1,1]
  v_pk_mul_f32 v[246:247], v[246:247], v[88:89] op_sel:[0,1] op_sel_hi:[1,1]
  v_pk_mul_f32 v[248:249], v[248:249], v[90:91] op_sel:[0,0] op_sel_hi:[1,0]
  v_pk_mul_f32 v[250:251], v[250:251], v[90:91] op_sel:[0,0] op_sel_hi:[1,0]
  v_pk_mul_f32 v[252:253], v[252:253], v[90:91] op_sel:[0,1] op_sel_hi:[1,1]
  v_pk_mul_f32 v[254:255], v[254:255], v[90:91] op_sel:[0,1] op_sel_hi:[1,1]
  v_lshlrev_b32 v2, 4, v1
  v_add_u32 v2, 148608, v2
  v_lshrrev_b32 v16, 5, v1
  v_mul_u32_u24 v16, 2080, v16
  v_bfe_u32 v17, v1, 4, 1
  v_lshl_add_u32 v16, v17, 9, v16
  v_and_b32 v17, 15, v1
  v_lshl_add_u32 v16, v17, 4, v16
  v_add_u32 v6, 148608, v16

  v_subrev_u32 v3, 42112, v8
  v_subrev_u32 v4, 42112, v9
  v_subrev_u32 v5, 42112, v10
  v_subrev_u32 v7, 42112, v11
  s_mov_b32 s39, 0x40000
WAITC_18:
  ds_read_b32 v15, v84 offset:84
  s_waitcnt lgkmcnt(0)
  v_readfirstlane_b32 s38, v15
  s_cmp_ge_u32 s38, 4
  s_cbranch_scc1 WAITD_19
  s_sleep 1
  s_sub_u32 s39, s39, 1
  s_cmp_lg_u32 s39, 0
  s_cbranch_scc1 WAITC_18

WAITD_19:
  s_sub_u32 s44, s33, 42112
  s_add_u32 m0, s44, 0
  s_mov_b32 s35, 59904
  buffer_load_dwordx4 v95, s[16:19], s35 offen lds
  s_add_u32 m0, s44, 1024
  s_mov_b32 s35, 0
  buffer_load_dwordx4 v96, s[16:19], s35 offen lds
  s_add_u32 m0, s44, 2048
  s_mov_b32 s35, 62208
  buffer_load_dwordx4 v94, s[16:19], s35 offen lds
  s_add_u32 m0, s44, 3072
  s_mov_b32 s35, 66816
  buffer_load_dwordx4 v94, s[16:19], s35 offen lds
  s_add_u32 m0, s44, 4096
  s_mov_b32 s35, 71424
  buffer_load_dwordx4 v94, s[16:19], s35 offen lds
  s_add_u32 m0, s44, 5120
  s_mov_b32 s35, 76032
  buffer_load_dwordx4 v94, s[16:19], s35 offen lds
  s_add_u32 m0, s44, 6144
  s_mov_b32 s35, 80640
  buffer_load_dwordx4 v95, s[16:19], s35 offen lds
  s_add_u32 m0, s44, 7168
  s_mov_b32 s35, 0
  buffer_load_dwordx4 v96, s[16:19], s35 offen lds
  s_add_u32 m0, s44, 8192
  s_nop 0
  buffer_load_dwordx4 v99, s[16:19], 0 offen lds
  v_mov_b32 v13, 1
  v_mov_b32 v14, 161088
  s_mul_i32 s45, s3, 72
  s_mul_i32 s36, s30, 18
  s_add_u32 s45, s45, s36
  s_lshl_b32 s45, s45, 10
  s_add_u32 s45, s45, 1048576

  s_mov_b32 s39, 0x40000
WAITC_20:
  ds_read_b32 v15, v14 offset:20
  s_waitcnt lgkmcnt(0)
  v_readfirstlane_b32 s38, v15
  s_cmp_ge_u32 s38, 4
  s_cbranch_scc1 WAITD_21
  s_sleep 1
  s_sub_u32 s39, s39, 1
  s_cmp_lg_u32 s39, 0
  s_cbranch_scc1 WAITC_20

WAITD_21:
  ds_read_b32 v15, v14 offset:36
  ds_read_b128 v[16:19], v2 offset:0
  ds_read_b128 v[20:23], v2 offset:1024
  ds_read_b128 v[24:27], v2 offset:2080
  ds_read_b128 v[28:31], v2 offset:3104
  ds_read_b128 v[32:35], v2 offset:4160
  ds_read_b128 v[36:39], v2 offset:5184
  ds_read_b128 v[40:43], v2 offset:6240
  ds_read_b128 v[44:47], v2 offset:7264
  ds_read_b128 v[48:51], v2 offset:8320
  ds_read_b128 v[52:55], v2 offset:9344
  ds_read_b128 v[56:59], v2 offset:10400
  ds_read_b128 v[60:63], v2 offset:11424
  s_waitcnt vmcnt(0) lgkmcnt(0)
  v_readfirstlane_b32 s47, v15
  v_lshlrev_b32 v15, 4, v1
  s_mov_b32 s56, s20
  s_mov_b32 s57, s21
  s_mov_b32 s59, 0x00020000
  s_lshr_b32 s52, s29, 1
  s_cmp_eq_u32 s52, s30
  s_cselect_b32 s52, 1, 0
  s_and_b32 s53, s29, 1
  s_xor_b32 s54, s53, 1
  s_and_b32 s54, s54, s52
  s_and_b32 s53, s53, s52

  ds_read_b64_tr_b16 v[64:65], v8 offset:0
  ds_read_b64_tr_b16 v[66:67], v8 offset:2048
  ds_read_b64_tr_b16 v[68:69], v8 offset:4096
  ds_read_b64_tr_b16 v[70:71], v8 offset:6144
  ds_read_b64_tr_b16 v[72:73], v8 offset:36864
  ds_read_b64_tr_b16 v[74:75], v8 offset:38912
  ds_read_b64_tr_b16 v[76:77], v8 offset:40960
  ds_read_b64_tr_b16 v[78:79], v8 offset:43008
  ds_read_b64_tr_b16 v[80:81], v3 offset:0
  ds_read_b64_tr_b16 v[82:83], v3 offset:2048
  ds_read_b64_tr_b16 v[84:85], v3 offset:4096
  ds_read_b64_tr_b16 v[86:87], v3 offset:6144
  s_waitcnt lgkmcnt(0)
  v_mfma_f32_32x32x16_bf16 v[112:127], v[64:67], v[16:19], v[112:127]
  ds_read_b64_tr_b16 v[88:89], v9 offset:0
  ds_read_b64_tr_b16 v[90:91], v9 offset:2048
  v_mfma_f32_32x32x16_bf16 v[128:143], v[64:67], v[20:23], v[128:143]
  ds_read_b64_tr_b16 v[92:93], v9 offset:4096
  ds_read_b64_tr_b16 v[94:95], v9 offset:6144
  v_mfma_f32_32x32x16_bf16 v[112:127], v[68:71], v[24:27], v[112:127]
  ds_read_b64_tr_b16 v[96:97], v9 offset:36864
  ds_read_b64_tr_b16 v[98:99], v9 offset:38912
  v_mfma_f32_32x32x16_bf16 v[128:143], v[68:71], v[28:31], v[128:143]
  ds_read_b64_tr_b16 v[100:101], v9 offset:40960
  ds_read_b64_tr_b16 v[102:103], v9 offset:43008
  v_mfma_f32_32x32x16_bf16 v[112:127], v[72:75], v[32:35], v[112:127]
  ds_read_b64_tr_b16 v[104:105], v4 offset:0
  ds_read_b64_tr_b16 v[106:107], v4 offset:2048
  v_mfma_f32_32x32x16_bf16 v[128:143], v[72:75], v[36:39], v[128:143]
  ds_read_b64_tr_b16 v[108:109], v4 offset:4096
  ds_read_b64_tr_b16 v[110:111], v4 offset:6144
  v_mfma_f32_32x32x16_bf16 v[112:127], v[76:79], v[40:43], v[112:127]
  v_mfma_f32_32x32x16_bf16 v[128:143], v[76:79], v[44:47], v[128:143]
  v_mfma_f32_32x32x16_bf16 v[112:127], v[80:83], v[48:51], v[112:127]
  v_mfma_f32_32x32x16_bf16 v[128:143], v[80:83], v[52:55], v[128:143]
  v_mfma_f32_32x32x16_bf16 v[112:127], v[84:87], v[56:59], v[112:127]
  v_mfma_f32_32x32x16_bf16 v[128:143], v[84:87], v[60:63], v[128:143]
  s_waitcnt lgkmcnt(0)
  v_mfma_f32_32x32x16_bf16 v[144:159], v[88:91], v[16:19], v[144:159]
  ds_read_b64_tr_b16 v[64:65], v10 offset:0
  ds_read_b64_tr_b16 v[66:67], v10 offset:2048
  v_mfma_f32_32x32x16_bf16 v[160:175], v[88:91], v[20:23], v[160:175]
  ds_read_b64_tr_b16 v[68:69], v10 offset:4096
  ds_read_b64_tr_b16 v[70:71], v10 offset:6144
  v_mfma_f32_32x32x16_bf16 v[144:159], v[92:95], v[24:27], v[144:159]
  ds_read_b64_tr_b16 v[72:73], v10 offset:36864
  ds_read_b64_tr_b16 v[74:75], v10 offset:38912
  v_mfma_f32_32x32x16_bf16 v[160:175], v[92:95], v[28:31], v[160:175]
  ds_read_b64_tr_b16 v[76:77], v10 offset:40960
  ds_read_b64_tr_b16 v[78:79], v10 offset:43008
  v_cvt_pk_bf16_f32 v112, v112, v113
  v_cvt_pk_bf16_f32 v113, v114, v115
  v_cvt_pk_bf16_f32 v114, v116, v117
  v_mfma_f32_32x32x16_bf16 v[144:159], v[96:99], v[32:35], v[144:159]
  ds_read_b64_tr_b16 v[80:81], v5 offset:0
  ds_read_b64_tr_b16 v[82:83], v5 offset:2048
  v_cvt_pk_bf16_f32 v115, v118, v119
  v_cvt_pk_bf16_f32 v116, v120, v121
  v_cvt_pk_bf16_f32 v117, v122, v123
  v_mfma_f32_32x32x16_bf16 v[160:175], v[96:99], v[36:39], v[160:175]
  ds_read_b64_tr_b16 v[84:85], v5 offset:4096
  ds_read_b64_tr_b16 v[86:87], v5 offset:6144
  v_cvt_pk_bf16_f32 v118, v124, v125
  v_cvt_pk_bf16_f32 v119, v126, v127
  s_cmp_eq_u32 s54, 1
  s_cselect_b32 s58, 0, 0x10000000
  s_cselect_b64 exec, -1, 0
  ds_write_b128 v15, v[112:115] offset:0
  s_mov_b64 exec, -1
  buffer_store_dwordx4 v[112:115], v15, s[56:59], s45 offen offset:0 sc1
  v_mfma_f32_32x32x16_bf16 v[144:159], v[100:103], v[40:43], v[144:159]
  s_cmp_eq_u32 s54, 1
  s_cselect_b32 s58, 0, 0x10000000
  s_cselect_b64 exec, -1, 0
  ds_write_b128 v15, v[116:119] offset:1024
  s_mov_b64 exec, -1
  buffer_store_dwordx4 v[116:119], v15, s[56:59], s45 offen offset:1024 sc1
  v_cvt_pk_bf16_f32 v128, v128, v129
  v_cvt_pk_bf16_f32 v129, v130, v131
  v_mfma_f32_32x32x16_bf16 v[160:175], v[100:103], v[44:47], v[160:175]
  v_cvt_pk_bf16_f32 v130, v132, v133
  v_cvt_pk_bf16_f32 v131, v134, v135
  v_cvt_pk_bf16_f32 v132, v136, v137
  v_mfma_f32_32x32x16_bf16 v[144:159], v[104:107], v[48:51], v[144:159]
  v_cvt_pk_bf16_f32 v133, v138, v139
  v_cvt_pk_bf16_f32 v134, v140, v141
  v_cvt_pk_bf16_f32 v135, v142, v143
  v_mfma_f32_32x32x16_bf16 v[160:175], v[104:107], v[52:55], v[160:175]
  s_cmp_eq_u32 s54, 1
  s_cselect_b32 s58, 0, 0x10000000
  s_cselect_b64 exec, -1, 0
  ds_write_b128 v15, v[128:131] offset:2048
  s_mov_b64 exec, -1
  buffer_store_dwordx4 v[128:131], v15, s[56:59], s45 offen offset:2048 sc1
  s_cmp_eq_u32 s54, 1
  s_cselect_b32 s58, 0, 0x10000000
  s_cselect_b64 exec, -1, 0
  ds_write_b128 v15, v[132:135] offset:3072
  s_mov_b64 exec, -1
  buffer_store_dwordx4 v[132:135], v15, s[56:59], s45 offen offset:3072 sc1
  s_add_u32 s45, s45, 4096
  v_mfma_f32_32x32x16_bf16 v[144:159], v[108:111], v[56:59], v[144:159]
  v_mfma_f32_32x32x16_bf16 v[160:175], v[108:111], v[60:63], v[160:175]
  s_waitcnt lgkmcnt(0)
  v_mfma_f32_32x32x16_bf16 v[176:191], v[64:67], v[16:19], v[176:191]
  ds_read_b64_tr_b16 v[88:89], v11 offset:0
  ds_read_b64_tr_b16 v[90:91], v11 offset:2048
  v_mfma_f32_32x32x16_bf16 v[192:207], v[64:67], v[20:23], v[192:207]
  ds_read_b64_tr_b16 v[92:93], v11 offset:4096
  ds_read_b64_tr_b16 v[94:95], v11 offset:6144
  v_mfma_f32_32x32x16_bf16 v[176:191], v[68:71], v[24:27], v[176:191]
  ds_read_b64_tr_b16 v[96:97], v11 offset:36864
  ds_read_b64_tr_b16 v[98:99], v11 offset:38912
  v_mfma_f32_32x32x16_bf16 v[192:207], v[68:71], v[28:31], v[192:207]
  ds_read_b64_tr_b16 v[100:101], v11 offset:40960
  ds_read_b64_tr_b16 v[102:103], v11 offset:43008
  v_cvt_pk_bf16_f32 v144, v144, v145
  v_cvt_pk_bf16_f32 v145, v146, v147
  v_cvt_pk_bf16_f32 v146, v148, v149
  v_mfma_f32_32x32x16_bf16 v[176:191], v[72:75], v[32:35], v[176:191]
  ds_read_b64_tr_b16 v[104:105], v7 offset:0
  ds_read_b64_tr_b16 v[106:107], v7 offset:2048
  v_cvt_pk_bf16_f32 v147, v150, v151
  v_cvt_pk_bf16_f32 v148, v152, v153
  v_cvt_pk_bf16_f32 v149, v154, v155
  v_mfma_f32_32x32x16_bf16 v[192:207], v[72:75], v[36:39], v[192:207]
  ds_read_b64_tr_b16 v[108:109], v7 offset:4096
  ds_read_b64_tr_b16 v[110:111], v7 offset:6144
  v_cvt_pk_bf16_f32 v150, v156, v157
  v_cvt_pk_bf16_f32 v151, v158, v159
  s_cmp_eq_u32 s54, 1
  s_cselect_b32 s58, 0, 0x10000000
  s_cselect_b64 exec, -1, 0
  ds_write_b128 v15, v[144:147] offset:4096
  s_mov_b64 exec, -1
  buffer_store_dwordx4 v[144:147], v15, s[56:59], s45 offen offset:0 sc1
  v_mfma_f32_32x32x16_bf16 v[176:191], v[76:79], v[40:43], v[176:191]
  s_cmp_eq_u32 s54, 1
  s_cselect_b32 s58, 0, 0x10000000
  s_cselect_b64 exec, -1, 0
  ds_write_b128 v15, v[148:151] offset:5120
  s_mov_b64 exec, -1
  buffer_store_dwordx4 v[148:151], v15, s[56:59], s45 offen offset:1024 sc1
  v_cvt_pk_bf16_f32 v160, v160, v161
  v_cvt_pk_bf16_f32 v161, v162, v163
  v_mfma_f32_32x32x16_bf16 v[192:207], v[76:79], v[44:47], v[192:207]
  v_cvt_pk_bf16_f32 v162, v164, v165
  v_cvt_pk_bf16_f32 v163, v166, v167
  v_cvt_pk_bf16_f32 v164, v168, v169
  v_mfma_f32_32x32x16_bf16 v[176:191], v[80:83], v[48:51], v[176:191]
  v_cvt_pk_bf16_f32 v165, v170, v171
  v_cvt_pk_bf16_f32 v166, v172, v173
  v_cvt_pk_bf16_f32 v167, v174, v175
  v_mfma_f32_32x32x16_bf16 v[192:207], v[80:83], v[52:55], v[192:207]
  s_cmp_eq_u32 s54, 1
  s_cselect_b32 s58, 0, 0x10000000
  s_cselect_b64 exec, -1, 0
  ds_write_b128 v15, v[160:163] offset:6144
  s_mov_b64 exec, -1
  buffer_store_dwordx4 v[160:163], v15, s[56:59], s45 offen offset:2048 sc1
  s_cmp_eq_u32 s54, 1
  s_cselect_b32 s58, 0, 0x10000000
  s_cselect_b64 exec, -1, 0
  ds_write_b128 v15, v[164:167] offset:7168
  s_mov_b64 exec, -1
  buffer_store_dwordx4 v[164:167], v15, s[56:59], s45 offen offset:3072 sc1
  s_add_u32 s45, s45, 4096
  v_mfma_f32_32x32x16_bf16 v[176:191], v[84:87], v[56:59], v[176:191]
  v_mfma_f32_32x32x16_bf16 v[192:207], v[84:87], v[60:63], v[192:207]
  s_waitcnt lgkmcnt(0)
  v_mfma_f32_32x32x16_bf16 v[208:223], v[88:91], v[16:19], v[208:223]
  v_mfma_f32_32x32x16_bf16 v[224:239], v[88:91], v[20:23], v[224:239]
  v_mfma_f32_32x32x16_bf16 v[208:223], v[92:95], v[24:27], v[208:223]
  v_mfma_f32_32x32x16_bf16 v[224:239], v[92:95], v[28:31], v[224:239]
  v_mfma_f32_32x32x16_bf16 v[208:223], v[96:99], v[32:35], v[208:223]
  v_mfma_f32_32x32x16_bf16 v[224:239], v[96:99], v[36:39], v[224:239]
  v_mfma_f32_32x32x16_bf16 v[208:223], v[100:103], v[40:43], v[208:223]
  v_mfma_f32_32x32x16_bf16 v[224:239], v[100:103], v[44:47], v[224:239]
  v_mfma_f32_32x32x16_bf16 v[208:223], v[104:107], v[48:51], v[208:223]
  v_mfma_f32_32x32x16_bf16 v[224:239], v[104:107], v[52:55], v[224:239]
  v_mfma_f32_32x32x16_bf16 v[208:223], v[108:111], v[56:59], v[208:223]
  v_mfma_f32_32x32x16_bf16 v[224:239], v[108:111], v[60:63], v[224:239]
  v_cvt_pk_bf16_f32 v176, v176, v177
  v_cvt_pk_bf16_f32 v177, v178, v179
  v_cvt_pk_bf16_f32 v178, v180, v181
  v_cvt_pk_bf16_f32 v179, v182, v183
  v_cvt_pk_bf16_f32 v180, v184, v185
  v_cvt_pk_bf16_f32 v181, v186, v187
  v_cvt_pk_bf16_f32 v182, v188, v189
  v_cvt_pk_bf16_f32 v183, v190, v191
  s_cmp_eq_u32 s54, 1
  s_cselect_b32 s58, 0, 0x10000000
  s_cselect_b64 exec, -1, 0
  ds_write_b128 v15, v[176:179] offset:8192
  s_mov_b64 exec, -1
  buffer_store_dwordx4 v[176:179], v15, s[56:59], s45 offen offset:0 sc1
  s_cmp_eq_u32 s53, 1
  s_cselect_b32 s58, 0, 0x10000000
  s_cselect_b64 exec, -1, 0
  ds_write_b128 v15, v[180:183] offset:0
  s_mov_b64 exec, -1
  buffer_store_dwordx4 v[180:183], v15, s[56:59], s45 offen offset:1024 sc1
  v_cvt_pk_bf16_f32 v192, v192, v193
  v_cvt_pk_bf16_f32 v193, v194, v195
  v_cvt_pk_bf16_f32 v194, v196, v197
  v_cvt_pk_bf16_f32 v195, v198, v199
  v_cvt_pk_bf16_f32 v196, v200, v201
  v_cvt_pk_bf16_f32 v197, v202, v203
  v_cvt_pk_bf16_f32 v198, v204, v205
  v_cvt_pk_bf16_f32 v199, v206, v207
  s_cmp_eq_u32 s53, 1
  s_cselect_b32 s58, 0, 0x10000000
  s_cselect_b64 exec, -1, 0
  ds_write_b128 v15, v[192:195] offset:1024
  s_mov_b64 exec, -1
  buffer_store_dwordx4 v[192:195], v15, s[56:59], s45 offen offset:2048 sc1
  s_cmp_eq_u32 s53, 1
  s_cselect_b32 s58, 0, 0x10000000
  s_cselect_b64 exec, -1, 0
  ds_write_b128 v15, v[196:199] offset:2048
  s_mov_b64 exec, -1
  buffer_store_dwordx4 v[196:199], v15, s[56:59], s45 offen offset:3072 sc1
  s_add_u32 s45, s45, 4096
  v_subrev_u32 v3, 42112, v12
  ds_read_b64_tr_b16 v[64:65], v12 offset:8192
  ds_read_b64_tr_b16 v[66:67], v12 offset:8448
  ds_read_b64_tr_b16 v[68:69], v12 offset:45056
  ds_read_b64_tr_b16 v[70:71], v12 offset:45312
  ds_read_b64_tr_b16 v[72:73], v3 offset:8192
  ds_read_b64_tr_b16 v[74:75], v3 offset:8448
  ds_read_b128 v[16:19], v6 offset:0
  ds_read_b128 v[20:23], v6 offset:256
  ds_read_b128 v[24:27], v6 offset:1024
  ds_read_b128 v[28:31], v6 offset:1280
  ds_read_b128 v[32:35], v6 offset:4160
  ds_read_b128 v[36:39], v6 offset:4416
  ds_read_b128 v[40:43], v6 offset:5184
  ds_read_b128 v[44:47], v6 offset:5440
  s_waitcnt lgkmcnt(4)
  ds_read_b128 v[48:51], v6 offset:8320
  ds_read_b128 v[52:55], v6 offset:8576
  ds_read_b128 v[56:59], v6 offset:9344
  ds_read_b128 v[60:63], v6 offset:9600
  v_cvt_pk_bf16_f32 v208, v208, v209
  v_cvt_pk_bf16_f32 v209, v210, v211
  v_cvt_pk_bf16_f32 v210, v212, v213
  v_cvt_pk_bf16_f32 v211, v214, v215
  v_cvt_pk_bf16_f32 v212, v216, v217
  v_cvt_pk_bf16_f32 v213, v218, v219
  v_cvt_pk_bf16_f32 v214, v220, v221
  v_cvt_pk_bf16_f32 v215, v222, v223
  s_cmp_eq_u32 s53, 1
  s_cselect_b32 s58, 0, 0x10000000
  s_cselect_b64 exec, -1, 0
  ds_write_b128 v15, v[208:211] offset:3072
  s_mov_b64 exec, -1
  buffer_store_dwordx4 v[208:211], v15, s[56:59], s45 offen offset:0 sc1
  s_cmp_eq_u32 s53, 1
  s_cselect_b32 s58, 0, 0x10000000
  s_cselect_b64 exec, -1, 0
  ds_write_b128 v15, v[212:215] offset:4096
  s_mov_b64 exec, -1
  buffer_store_dwordx4 v[212:215], v15, s[56:59], s45 offen offset:1024 sc1
  v_cvt_pk_bf16_f32 v224, v224, v225
  v_cvt_pk_bf16_f32 v225, v226, v227
  v_cvt_pk_bf16_f32 v226, v228, v229
  v_cvt_pk_bf16_f32 v227, v230, v231
  v_cvt_pk_bf16_f32 v228, v232, v233
  v_cvt_pk_bf16_f32 v229, v234, v235
  v_cvt_pk_bf16_f32 v230, v236, v237
  v_cvt_pk_bf16_f32 v231, v238, v239
  s_cmp_eq_u32 s53, 1
  s_cselect_b32 s58, 0, 0x10000000
  s_cselect_b64 exec, -1, 0
  ds_write_b128 v15, v[224:227] offset:5120
  s_mov_b64 exec, -1
  buffer_store_dwordx4 v[224:227], v15, s[56:59], s45 offen offset:2048 sc1
  s_cmp_eq_u32 s53, 1
  s_cselect_b32 s58, 0, 0x10000000
  s_cselect_b64 exec, -1, 0
  ds_write_b128 v15, v[228:231] offset:6144
  s_mov_b64 exec, -1
  buffer_store_dwordx4 v[228:231], v15, s[56:59], s45 offen offset:3072 sc1
  s_add_u32 s45, s45, 4096
  s_waitcnt lgkmcnt(0)
  v_mfma_f32_16x16x32_bf16 v[240:243], v[64:67], v[16:19], v[240:243]
  v_mfma_f32_16x16x32_bf16 v[244:247], v[64:67], v[20:23], v[244:247]
  v_mfma_f32_16x16x32_bf16 v[248:251], v[64:67], v[24:27], v[248:251]
  v_mfma_f32_16x16x32_bf16 v[252:255], v[64:67], v[28:31], v[252:255]
  v_mfma_f32_16x16x32_bf16 v[240:243], v[68:71], v[32:35], v[240:243]
  v_mfma_f32_16x16x32_bf16 v[244:247], v[68:71], v[36:39], v[244:247]
  v_mfma_f32_16x16x32_bf16 v[248:251], v[68:71], v[40:43], v[248:251]
  v_mfma_f32_16x16x32_bf16 v[252:255], v[68:71], v[44:47], v[252:255]
  v_mfma_f32_16x16x32_bf16 v[240:243], v[72:75], v[48:51], v[240:243]
  v_mfma_f32_16x16x32_bf16 v[244:247], v[72:75], v[52:55], v[244:247]
  v_mfma_f32_16x16x32_bf16 v[248:251], v[72:75], v[56:59], v[248:251]
  v_mfma_f32_16x16x32_bf16 v[252:255], v[72:75], v[60:63], v[252:255]
  s_nop 7
  v_cvt_pk_bf16_f32 v240, v240, v241
  v_cvt_pk_bf16_f32 v241, v242, v243
  v_cvt_pk_bf16_f32 v242, v244, v245
  v_cvt_pk_bf16_f32 v243, v246, v247
  s_cmp_eq_u32 s53, 1
  s_cselect_b32 s58, 0, 0x10000000
  s_cselect_b64 exec, -1, 0
  ds_write_b128 v15, v[240:243] offset:7168
  s_mov_b64 exec, -1
  buffer_store_dwordx4 v[240:243], v15, s[56:59], s45 offen offset:0 sc1
  v_cvt_pk_bf16_f32 v248, v248, v249
  v_cvt_pk_bf16_f32 v249, v250, v251
  v_cvt_pk_bf16_f32 v250, v252, v253
  v_cvt_pk_bf16_f32 v251, v254, v255
  s_cmp_eq_u32 s53, 1
  s_cselect_b32 s58, 0, 0x10000000
  s_cselect_b64 exec, -1, 0
  ds_write_b128 v15, v[248:251] offset:8192
  s_mov_b64 exec, -1
  buffer_store_dwordx4 v[248:251], v15, s[56:59], s45 offen offset:1024 sc1
  v_mov_b32 v84, 161088
  v_mov_b32 v85, 1
  s_waitcnt lgkmcnt(0)
  s_waitcnt vmcnt(0)
  s_mov_b64 exec, 1
  ds_add_rtn_u32 v16, v84, v85 offset:24
  s_waitcnt lgkmcnt(0)
  v_readfirstlane_b32 s35, v16
  s_cmp_lg_u32 s35, 3
  s_cbranch_scc1 M_NOFLAG
  s_lshl_b32 s35, s28, 7
  s_lshl_b32 s36, s29, 2
  s_add_u32 s35, s35, s36
  s_add_u32 s35, s35, 270336
  v_mov_b32 v16, s47
  v_mov_b32 v17, 0
  buffer_store_dword v16, v17, s[20:23], s35 offen sc1

M_NOFLAG:
  s_mov_b64 exec, -1
  s_load_dwordx2 s[48:49], s[0:1], 88
  v_mov_b32 v18, 161088
  v_mov_b32 v19, 1
  v_lshlrev_b32 v20, 4, v1
  s_waitcnt lgkmcnt(0)

  s_mov_b32 s24, s48
  s_and_b32 s25, s49, 0xffff
  s_mov_b32 s26, 2359296
  s_mov_b32 s27, 0x00020000

  s_mul_i32 s35, s29, 9
  s_add_u32 s35, s35, s30
  s_lshl_b32 s36, s28, 3
  s_mul_i32 s36, s36, 73728
  s_lshl_b32 s37, s35, 10
  s_add_u32 s36, s36, s37
  s_add_u32 s50, s36, 1048576
  s_mul_hi_u32 s40, s35, 238609295
  s_mul_i32 s41, s40, 18
  s_sub_u32 s41, s35, s41
  s_lshl_b32 s42, s28, 6
  s_cmp_ge_u32 s41, 16
  s_cselect_b32 s52, 1, 0

  s_cbranch_scc1 RX_22
  s_lshr_b32 s44, s41, 1
  s_and_b32 s45, s44, 1
  s_lshr_b32 s44, s44, 1
  s_lshl_b32 s45, s45, 5
  s_add_u32 s42, s42, s45
  s_mul_i32 s42, s42, 1152
  s_lshl_b32 s45, s40, 8
  s_add_u32 s42, s42, s45
  s_lshl_b32 s45, s44, 6
  s_add_u32 s42, s42, s45
  s_and_b32 s45, s41, 1
  s_lshl_b32 s45, s45, 5
  s_add_u32 s51, s42, s45
  v_and_b32 v21, 31, v1
  v_mul_u32_u24 v21, 1152, v21
  v_lshrrev_b32 v16, 5, v1
  v_lshl_add_u32 v21, v16, 4, v21
  s_branch RD_23

RX_22:
  s_sub_u32 s45, s41, 16
  s_lshl_b32 s45, s45, 5
  s_add_u32 s42, s42, s45
  s_mul_i32 s42, s42, 1152
  s_lshl_b32 s45, s40, 5
  s_add_u32 s42, s42, s45
  s_add_u32 s51, s42, 1024
  v_and_b32 v21, 15, v1
  v_mul_u32_u24 v21, 1152, v21
  v_lshrrev_b32 v16, 4, v1
  v_lshl_add_u32 v21, v16, 3, v21

RD_23:
  s_mul_i32 s35, s29, 9
  s_add_u32 s35, s35, 8
  s_lshl_b32 s36, s28, 3
  s_mul_i32 s36, s36, 73728
  s_lshl_b32 s37, s35, 10
  s_add_u32 s36, s36, s37
  s_add_u32 s53, s36, 1048576
  s_mul_hi_u32 s40, s35, 238609295
  s_mul_i32 s41, s40, 18
  s_sub_u32 s41, s35, s41
  s_lshl_b32 s42, s28, 6
  s_cmp_ge_u32 s41, 16
  s_cselect_b32 s55, 1, 0

  s_cbranch_scc1 RX_24
  s_lshr_b32 s44, s41, 1
  s_and_b32 s45, s44, 1
  s_lshr_b32 s44, s44, 1
  s_lshl_b32 s45, s45, 5
  s_add_u32 s42, s42, s45
  s_mul_i32 s42, s42, 1152
  s_lshl_b32 s45, s40, 8
  s_add_u32 s42, s42, s45
  s_lshl_b32 s45, s44, 6
  s_add_u32 s42, s42, s45
  s_and_b32 s45, s41, 1
  s_lshl_b32 s45, s45, 5
  s_add_u32 s54, s42, s45
  v_and_b32 v22, 31, v1
  v_mul_u32_u24 v22, 1152, v22
  v_lshrrev_b32 v16, 5, v1
  v_lshl_add_u32 v22, v16, 4, v22
  s_branch RD_25

RX_24:
  s_sub_u32 s45, s41, 16
  s_lshl_b32 s45, s45, 5
  s_add_u32 s42, s42, s45
  s_mul_i32 s42, s42, 1152
  s_lshl_b32 s45, s40, 5
  s_add_u32 s42, s42, s45
  s_add_u32 s54, s42, 1024
  v_and_b32 v22, 15, v1
  v_mul_u32_u24 v22, 1152, v22
  v_lshrrev_b32 v16, 4, v1
  v_lshl_add_u32 v22, v16, 3, v22

RD_25:
  s_cmp_lg_u32 s30, 7
  s_cbranch_scc1 XFW_28
  s_lshl_b32 s35, s28, 7
  s_add_u32 s35, s35, 270336
  v_and_b32 v16, 7, v1
  v_lshlrev_b32 v16, 2, v16
  s_mov_b32 s39, 0x10000

XFP_26:
  buffer_load_dword v17, v16, s[20:23], s35 offen sc1
  s_waitcnt vmcnt(0)
  v_cmp_ne_u32 vcc, s47, v17
  s_nop 1
  s_cmp_eq_u64 vcc, 0
  s_cbranch_scc1 XFD_27
  s_sleep 1
  s_sub_u32 s39, s39, 1
  s_cmp_lg_u32 s39, 0
  s_cbranch_scc1 XFP_26

XFD_27:
  s_mov_b64 exec, 1
  ds_add_u32 v18, v19 offset:60
  s_mov_b64 exec, -1

XFW_28:
  s_mov_b32 s39, 0x40000
WAITC_29:
  ds_read_b32 v16, v18 offset:60
  s_waitcnt lgkmcnt(0)
  v_readfirstlane_b32 s38, v16
  s_cmp_ge_u32 s38, 1
  s_cbranch_scc1 WAITD_30
  s_sleep 1
  s_sub_u32 s39, s39, 1
  s_cmp_lg_u32 s39, 0
  s_cbranch_scc1 WAITC_29

WAITD_30:
  s_mov_b32 s56, s20
  s_mov_b32 s57, s21
  s_mov_b32 s59, 0x00020000
  s_cmp_eq_u32 s29, 0
  s_cselect_b32 s58, 0, 0x10000000
  buffer_load_dwordx4 v[24:27], v20, s[56:59], s50 offen sc1
  s_add_u32 s50, s50, 73728
  s_cmp_eq_u32 s29, 1
  s_cselect_b32 s58, 0, 0x10000000
  buffer_load_dwordx4 v[28:31], v20, s[56:59], s50 offen sc1
  s_add_u32 s50, s50, 73728
  s_cmp_eq_u32 s29, 2
  s_cselect_b32 s58, 0, 0x10000000
  buffer_load_dwordx4 v[32:35], v20, s[56:59], s50 offen sc1
  s_add_u32 s50, s50, 73728
  s_cmp_eq_u32 s29, 3
  s_cselect_b32 s58, 0, 0x10000000
  buffer_load_dwordx4 v[36:39], v20, s[56:59], s50 offen sc1
  s_add_u32 s50, s50, 73728
  s_cmp_eq_u32 s29, 4
  s_cselect_b32 s58, 0, 0x10000000
  buffer_load_dwordx4 v[40:43], v20, s[56:59], s50 offen sc1
  s_add_u32 s50, s50, 73728
  s_cmp_eq_u32 s29, 5
  s_cselect_b32 s58, 0, 0x10000000
  buffer_load_dwordx4 v[44:47], v20, s[56:59], s50 offen sc1
  s_add_u32 s50, s50, 73728
  s_cmp_eq_u32 s29, 6
  s_cselect_b32 s58, 0, 0x10000000
  buffer_load_dwordx4 v[48:51], v20, s[56:59], s50 offen sc1
  s_add_u32 s50, s50, 73728
  s_cmp_eq_u32 s29, 7
  s_cselect_b32 s58, 0, 0x10000000
  buffer_load_dwordx4 v[52:55], v20, s[56:59], s50 offen sc1
  s_lshl_b32 s35, s30, 10
  s_add_u32 s35, s35, 0
  v_add_u32 v116, s35, v20
  ds_read_b128 v[116:119], v116
  s_cmp_eq_u32 s30, 4
  s_cbranch_scc1 R2_32
  s_waitcnt vmcnt(7)
  v_lshlrev_b32 v96, 16, v24
  v_and_b32 v97, 0xffff0000, v24
  v_lshlrev_b32 v98, 16, v25
  v_and_b32 v99, 0xffff0000, v25
  v_lshlrev_b32 v100, 16, v26
  v_and_b32 v101, 0xffff0000, v26
  v_lshlrev_b32 v102, 16, v27
  v_and_b32 v103, 0xffff0000, v27
  s_waitcnt vmcnt(6)
  v_lshlrev_b32 v104, 16, v28
  v_and_b32 v105, 0xffff0000, v28
  v_lshlrev_b32 v106, 16, v29
  v_and_b32 v107, 0xffff0000, v29
  v_lshlrev_b32 v108, 16, v30
  v_and_b32 v109, 0xffff0000, v30
  v_lshlrev_b32 v110, 16, v31
  v_and_b32 v111, 0xffff0000, v31
  v_pk_add_f32 v[96:97], v[96:97], v[104:105]
  v_pk_add_f32 v[98:99], v[98:99], v[106:107]
  v_pk_add_f32 v[100:101], v[100:101], v[108:109]
  v_pk_add_f32 v[102:103], v[102:103], v[110:111]
  s_waitcnt vmcnt(5)
  v_lshlrev_b32 v104, 16, v32
  v_and_b32 v105, 0xffff0000, v32
  v_lshlrev_b32 v106, 16, v33
  v_and_b32 v107, 0xffff0000, v33
  v_lshlrev_b32 v108, 16, v34
  v_and_b32 v109, 0xffff0000, v34
  v_lshlrev_b32 v110, 16, v35
  v_and_b32 v111, 0xffff0000, v35
  v_pk_add_f32 v[96:97], v[96:97], v[104:105]
  v_pk_add_f32 v[98:99], v[98:99], v[106:107]
  v_pk_add_f32 v[100:101], v[100:101], v[108:109]
  v_pk_add_f32 v[102:103], v[102:103], v[110:111]
  s_waitcnt vmcnt(4)
  v_lshlrev_b32 v104, 16, v36
  v_and_b32 v105, 0xffff0000, v36
  v_lshlrev_b32 v106, 16, v37
  v_and_b32 v107, 0xffff0000, v37
  v_lshlrev_b32 v108, 16, v38
  v_and_b32 v109, 0xffff0000, v38
  v_lshlrev_b32 v110, 16, v39
  v_and_b32 v111, 0xffff0000, v39
  v_pk_add_f32 v[96:97], v[96:97], v[104:105]
  v_pk_add_f32 v[98:99], v[98:99], v[106:107]
  v_pk_add_f32 v[100:101], v[100:101], v[108:109]
  v_pk_add_f32 v[102:103], v[102:103], v[110:111]
  s_waitcnt vmcnt(3)
  v_lshlrev_b32 v104, 16, v40
  v_and_b32 v105, 0xffff0000, v40
  v_lshlrev_b32 v106, 16, v41
  v_and_b32 v107, 0xffff0000, v41
  v_lshlrev_b32 v108, 16, v42
  v_and_b32 v109, 0xffff0000, v42
  v_lshlrev_b32 v110, 16, v43
  v_and_b32 v111, 0xffff0000, v43
  v_pk_add_f32 v[96:97], v[96:97], v[104:105]
  v_pk_add_f32 v[98:99], v[98:99], v[106:107]
  v_pk_add_f32 v[100:101], v[100:101], v[108:109]
  v_pk_add_f32 v[102:103], v[102:103], v[110:111]
  s_waitcnt vmcnt(2)
  v_lshlrev_b32 v104, 16, v44
  v_and_b32 v105, 0xffff0000, v44
  v_lshlrev_b32 v106, 16, v45
  v_and_b32 v107, 0xffff0000, v45
  v_lshlrev_b32 v108, 16, v46
  v_and_b32 v109, 0xffff0000, v46
  v_lshlrev_b32 v110, 16, v47
  v_and_b32 v111, 0xffff0000, v47
  v_pk_add_f32 v[96:97], v[96:97], v[104:105]
  v_pk_add_f32 v[98:99], v[98:99], v[106:107]
  v_pk_add_f32 v[100:101], v[100:101], v[108:109]
  v_pk_add_f32 v[102:103], v[102:103], v[110:111]
  s_waitcnt vmcnt(1)
  v_lshlrev_b32 v104, 16, v48
  v_and_b32 v105, 0xffff0000, v48
  v_lshlrev_b32 v106, 16, v49
  v_and_b32 v107, 0xffff0000, v49
  v_lshlrev_b32 v108, 16, v50
  v_and_b32 v109, 0xffff0000, v50
  v_lshlrev_b32 v110, 16, v51
  v_and_b32 v111, 0xffff0000, v51
  v_pk_add_f32 v[96:97], v[96:97], v[104:105]
  v_pk_add_f32 v[98:99], v[98:99], v[106:107]
  v_pk_add_f32 v[100:101], v[100:101], v[108:109]
  v_pk_add_f32 v[102:103], v[102:103], v[110:111]
  s_waitcnt vmcnt(0)
  v_lshlrev_b32 v104, 16, v52
  v_and_b32 v105, 0xffff0000, v52
  v_lshlrev_b32 v106, 16, v53
  v_and_b32 v107, 0xffff0000, v53
  v_lshlrev_b32 v108, 16, v54
  v_and_b32 v109, 0xffff0000, v54
  v_lshlrev_b32 v110, 16, v55
  v_and_b32 v111, 0xffff0000, v55
  v_pk_add_f32 v[96:97], v[96:97], v[104:105]
  v_pk_add_f32 v[98:99], v[98:99], v[106:107]
  v_pk_add_f32 v[100:101], v[100:101], v[108:109]
  v_pk_add_f32 v[102:103], v[102:103], v[110:111]
  s_waitcnt lgkmcnt(0)
  v_lshlrev_b32 v104, 16, v116
  v_and_b32 v105, 0xffff0000, v116
  v_lshlrev_b32 v106, 16, v117
  v_and_b32 v107, 0xffff0000, v117
  v_lshlrev_b32 v108, 16, v118
  v_and_b32 v109, 0xffff0000, v118
  v_lshlrev_b32 v110, 16, v119
  v_and_b32 v111, 0xffff0000, v119
  v_pk_add_f32 v[96:97], v[96:97], v[104:105]
  v_pk_add_f32 v[98:99], v[98:99], v[106:107]
  v_pk_add_f32 v[100:101], v[100:101], v[108:109]
  v_pk_add_f32 v[102:103], v[102:103], v[110:111]
  v_cvt_pk_bf16_f32 v104, v96, v97
  v_cvt_pk_bf16_f32 v105, v98, v99
  v_cvt_pk_bf16_f32 v106, v100, v101
  v_cvt_pk_bf16_f32 v107, v102, v103
  s_cmp_eq_u32 s52, 1
  s_cbranch_scc1 RX_33
  s_nop 0
  v_permlane32_swap_b32 v104, v106
  v_permlane32_swap_b32 v105, v107
  s_nop 1
  buffer_store_dwordx4 v[104:107], v21, s[24:27], s51 offen
  s_branch RD_34

RX_33:
  s_add_u32 s45, s51, 18432
  buffer_store_dwordx2 v[104:105], v21, s[24:27], s51 offen
  buffer_store_dwordx2 v[106:107], v21, s[24:27], s45 offen

RD_34:
  s_branch RE_31
R2_32:
  s_mov_b32 s56, s20
  s_mov_b32 s57, s21
  s_mov_b32 s59, 0x00020000
  s_cmp_eq_u32 s29, 0
  s_cselect_b32 s58, 0, 0x10000000
  buffer_load_dwordx4 v[56:59], v20, s[56:59], s53 offen sc1
  s_add_u32 s53, s53, 73728
  s_cmp_eq_u32 s29, 1
  s_cselect_b32 s58, 0, 0x10000000
  buffer_load_dwordx4 v[60:63], v20, s[56:59], s53 offen sc1
  s_add_u32 s53, s53, 73728
  s_cmp_eq_u32 s29, 2
  s_cselect_b32 s58, 0, 0x10000000
  buffer_load_dwordx4 v[64:67], v20, s[56:59], s53 offen sc1
  s_add_u32 s53, s53, 73728
  s_cmp_eq_u32 s29, 3
  s_cselect_b32 s58, 0, 0x10000000
  buffer_load_dwordx4 v[68:71], v20, s[56:59], s53 offen sc1
  s_add_u32 s53, s53, 73728
  s_cmp_eq_u32 s29, 4
  s_cselect_b32 s58, 0, 0x10000000
  buffer_load_dwordx4 v[72:75], v20, s[56:59], s53 offen sc1
  s_add_u32 s53, s53, 73728
  s_cmp_eq_u32 s29, 5
  s_cselect_b32 s58, 0, 0x10000000
  buffer_load_dwordx4 v[76:79], v20, s[56:59], s53 offen sc1
  s_add_u32 s53, s53, 73728
  s_cmp_eq_u32 s29, 6
  s_cselect_b32 s58, 0, 0x10000000
  buffer_load_dwordx4 v[80:83], v20, s[56:59], s53 offen sc1
  s_add_u32 s53, s53, 73728
  s_cmp_eq_u32 s29, 7
  s_cselect_b32 s58, 0, 0x10000000
  buffer_load_dwordx4 v[84:87], v20, s[56:59], s53 offen sc1
  s_lshl_b32 s35, 8, 10
  s_add_u32 s35, s35, 0
  v_add_u32 v120, s35, v20
  ds_read_b128 v[120:123], v120
  s_waitcnt vmcnt(15)
  v_lshlrev_b32 v96, 16, v24
  v_and_b32 v97, 0xffff0000, v24
  v_lshlrev_b32 v98, 16, v25
  v_and_b32 v99, 0xffff0000, v25
  v_lshlrev_b32 v100, 16, v26
  v_and_b32 v101, 0xffff0000, v26
  v_lshlrev_b32 v102, 16, v27
  v_and_b32 v103, 0xffff0000, v27
  s_waitcnt vmcnt(14)
  v_lshlrev_b32 v104, 16, v28
  v_and_b32 v105, 0xffff0000, v28
  v_lshlrev_b32 v106, 16, v29
  v_and_b32 v107, 0xffff0000, v29
  v_lshlrev_b32 v108, 16, v30
  v_and_b32 v109, 0xffff0000, v30
  v_lshlrev_b32 v110, 16, v31
  v_and_b32 v111, 0xffff0000, v31
  v_pk_add_f32 v[96:97], v[96:97], v[104:105]
  v_pk_add_f32 v[98:99], v[98:99], v[106:107]
  v_pk_add_f32 v[100:101], v[100:101], v[108:109]
  v_pk_add_f32 v[102:103], v[102:103], v[110:111]
  s_waitcnt vmcnt(13)
  v_lshlrev_b32 v104, 16, v32
  v_and_b32 v105, 0xffff0000, v32
  v_lshlrev_b32 v106, 16, v33
  v_and_b32 v107, 0xffff0000, v33
  v_lshlrev_b32 v108, 16, v34
  v_and_b32 v109, 0xffff0000, v34
  v_lshlrev_b32 v110, 16, v35
  v_and_b32 v111, 0xffff0000, v35
  v_pk_add_f32 v[96:97], v[96:97], v[104:105]
  v_pk_add_f32 v[98:99], v[98:99], v[106:107]
  v_pk_add_f32 v[100:101], v[100:101], v[108:109]
  v_pk_add_f32 v[102:103], v[102:103], v[110:111]
  s_waitcnt vmcnt(12)
  v_lshlrev_b32 v104, 16, v36
  v_and_b32 v105, 0xffff0000, v36
  v_lshlrev_b32 v106, 16, v37
  v_and_b32 v107, 0xffff0000, v37
  v_lshlrev_b32 v108, 16, v38
  v_and_b32 v109, 0xffff0000, v38
  v_lshlrev_b32 v110, 16, v39
  v_and_b32 v111, 0xffff0000, v39
  v_pk_add_f32 v[96:97], v[96:97], v[104:105]
  v_pk_add_f32 v[98:99], v[98:99], v[106:107]
  v_pk_add_f32 v[100:101], v[100:101], v[108:109]
  v_pk_add_f32 v[102:103], v[102:103], v[110:111]
  s_waitcnt vmcnt(11)
  v_lshlrev_b32 v104, 16, v40
  v_and_b32 v105, 0xffff0000, v40
  v_lshlrev_b32 v106, 16, v41
  v_and_b32 v107, 0xffff0000, v41
  v_lshlrev_b32 v108, 16, v42
  v_and_b32 v109, 0xffff0000, v42
  v_lshlrev_b32 v110, 16, v43
  v_and_b32 v111, 0xffff0000, v43
  v_pk_add_f32 v[96:97], v[96:97], v[104:105]
  v_pk_add_f32 v[98:99], v[98:99], v[106:107]
  v_pk_add_f32 v[100:101], v[100:101], v[108:109]
  v_pk_add_f32 v[102:103], v[102:103], v[110:111]
  s_waitcnt vmcnt(10)
  v_lshlrev_b32 v104, 16, v44
  v_and_b32 v105, 0xffff0000, v44
  v_lshlrev_b32 v106, 16, v45
  v_and_b32 v107, 0xffff0000, v45
  v_lshlrev_b32 v108, 16, v46
  v_and_b32 v109, 0xffff0000, v46
  v_lshlrev_b32 v110, 16, v47
  v_and_b32 v111, 0xffff0000, v47
  v_pk_add_f32 v[96:97], v[96:97], v[104:105]
  v_pk_add_f32 v[98:99], v[98:99], v[106:107]
  v_pk_add_f32 v[100:101], v[100:101], v[108:109]
  v_pk_add_f32 v[102:103], v[102:103], v[110:111]
  s_waitcnt vmcnt(9)
  v_lshlrev_b32 v104, 16, v48
  v_and_b32 v105, 0xffff0000, v48
  v_lshlrev_b32 v106, 16, v49
  v_and_b32 v107, 0xffff0000, v49
  v_lshlrev_b32 v108, 16, v50
  v_and_b32 v109, 0xffff0000, v50
  v_lshlrev_b32 v110, 16, v51
  v_and_b32 v111, 0xffff0000, v51
  v_pk_add_f32 v[96:97], v[96:97], v[104:105]
  v_pk_add_f32 v[98:99], v[98:99], v[106:107]
  v_pk_add_f32 v[100:101], v[100:101], v[108:109]
  v_pk_add_f32 v[102:103], v[102:103], v[110:111]
  s_waitcnt vmcnt(8)
  v_lshlrev_b32 v104, 16, v52
  v_and_b32 v105, 0xffff0000, v52
  v_lshlrev_b32 v106, 16, v53
  v_and_b32 v107, 0xffff0000, v53
  v_lshlrev_b32 v108, 16, v54
  v_and_b32 v109, 0xffff0000, v54
  v_lshlrev_b32 v110, 16, v55
  v_and_b32 v111, 0xffff0000, v55
  v_pk_add_f32 v[96:97], v[96:97], v[104:105]
  v_pk_add_f32 v[98:99], v[98:99], v[106:107]
  v_pk_add_f32 v[100:101], v[100:101], v[108:109]
  v_pk_add_f32 v[102:103], v[102:103], v[110:111]
  s_waitcnt lgkmcnt(0)
  v_lshlrev_b32 v104, 16, v116
  v_and_b32 v105, 0xffff0000, v116
  v_lshlrev_b32 v106, 16, v117
  v_and_b32 v107, 0xffff0000, v117
  v_lshlrev_b32 v108, 16, v118
  v_and_b32 v109, 0xffff0000, v118
  v_lshlrev_b32 v110, 16, v119
  v_and_b32 v111, 0xffff0000, v119
  v_pk_add_f32 v[96:97], v[96:97], v[104:105]
  v_pk_add_f32 v[98:99], v[98:99], v[106:107]
  v_pk_add_f32 v[100:101], v[100:101], v[108:109]
  v_pk_add_f32 v[102:103], v[102:103], v[110:111]
  v_cvt_pk_bf16_f32 v104, v96, v97
  v_cvt_pk_bf16_f32 v105, v98, v99
  v_cvt_pk_bf16_f32 v106, v100, v101
  v_cvt_pk_bf16_f32 v107, v102, v103
  s_cmp_eq_u32 s52, 1
  s_cbranch_scc1 RX_35
  s_nop 0
  v_permlane32_swap_b32 v104, v106
  v_permlane32_swap_b32 v105, v107
  s_nop 1
  buffer_store_dwordx4 v[104:107], v21, s[24:27], s51 offen
  s_branch RD_36

RX_35:
  s_add_u32 s45, s51, 18432
  buffer_store_dwordx2 v[104:105], v21, s[24:27], s51 offen
  buffer_store_dwordx2 v[106:107], v21, s[24:27], s45 offen

RD_36:
  s_waitcnt vmcnt(8)
  v_lshlrev_b32 v96, 16, v56
  v_and_b32 v97, 0xffff0000, v56
  v_lshlrev_b32 v98, 16, v57
  v_and_b32 v99, 0xffff0000, v57
  v_lshlrev_b32 v100, 16, v58
  v_and_b32 v101, 0xffff0000, v58
  v_lshlrev_b32 v102, 16, v59
  v_and_b32 v103, 0xffff0000, v59
  s_waitcnt vmcnt(7)
  v_lshlrev_b32 v104, 16, v60
  v_and_b32 v105, 0xffff0000, v60
  v_lshlrev_b32 v106, 16, v61
  v_and_b32 v107, 0xffff0000, v61
  v_lshlrev_b32 v108, 16, v62
  v_and_b32 v109, 0xffff0000, v62
  v_lshlrev_b32 v110, 16, v63
  v_and_b32 v111, 0xffff0000, v63
  v_pk_add_f32 v[96:97], v[96:97], v[104:105]
  v_pk_add_f32 v[98:99], v[98:99], v[106:107]
  v_pk_add_f32 v[100:101], v[100:101], v[108:109]
  v_pk_add_f32 v[102:103], v[102:103], v[110:111]
  s_waitcnt vmcnt(6)
  v_lshlrev_b32 v104, 16, v64
  v_and_b32 v105, 0xffff0000, v64
  v_lshlrev_b32 v106, 16, v65
  v_and_b32 v107, 0xffff0000, v65
  v_lshlrev_b32 v108, 16, v66
  v_and_b32 v109, 0xffff0000, v66
  v_lshlrev_b32 v110, 16, v67
  v_and_b32 v111, 0xffff0000, v67
  v_pk_add_f32 v[96:97], v[96:97], v[104:105]
  v_pk_add_f32 v[98:99], v[98:99], v[106:107]
  v_pk_add_f32 v[100:101], v[100:101], v[108:109]
  v_pk_add_f32 v[102:103], v[102:103], v[110:111]
  s_waitcnt vmcnt(5)
  v_lshlrev_b32 v104, 16, v68
  v_and_b32 v105, 0xffff0000, v68
  v_lshlrev_b32 v106, 16, v69
  v_and_b32 v107, 0xffff0000, v69
  v_lshlrev_b32 v108, 16, v70
  v_and_b32 v109, 0xffff0000, v70
  v_lshlrev_b32 v110, 16, v71
  v_and_b32 v111, 0xffff0000, v71
  v_pk_add_f32 v[96:97], v[96:97], v[104:105]
  v_pk_add_f32 v[98:99], v[98:99], v[106:107]
  v_pk_add_f32 v[100:101], v[100:101], v[108:109]
  v_pk_add_f32 v[102:103], v[102:103], v[110:111]
  s_waitcnt vmcnt(4)
  v_lshlrev_b32 v104, 16, v72
  v_and_b32 v105, 0xffff0000, v72
  v_lshlrev_b32 v106, 16, v73
  v_and_b32 v107, 0xffff0000, v73
  v_lshlrev_b32 v108, 16, v74
  v_and_b32 v109, 0xffff0000, v74
  v_lshlrev_b32 v110, 16, v75
  v_and_b32 v111, 0xffff0000, v75
  v_pk_add_f32 v[96:97], v[96:97], v[104:105]
  v_pk_add_f32 v[98:99], v[98:99], v[106:107]
  v_pk_add_f32 v[100:101], v[100:101], v[108:109]
  v_pk_add_f32 v[102:103], v[102:103], v[110:111]
  s_waitcnt vmcnt(3)
  v_lshlrev_b32 v104, 16, v76
  v_and_b32 v105, 0xffff0000, v76
  v_lshlrev_b32 v106, 16, v77
  v_and_b32 v107, 0xffff0000, v77
  v_lshlrev_b32 v108, 16, v78
  v_and_b32 v109, 0xffff0000, v78
  v_lshlrev_b32 v110, 16, v79
  v_and_b32 v111, 0xffff0000, v79
  v_pk_add_f32 v[96:97], v[96:97], v[104:105]
  v_pk_add_f32 v[98:99], v[98:99], v[106:107]
  v_pk_add_f32 v[100:101], v[100:101], v[108:109]
  v_pk_add_f32 v[102:103], v[102:103], v[110:111]
  s_waitcnt vmcnt(2)
  v_lshlrev_b32 v104, 16, v80
  v_and_b32 v105, 0xffff0000, v80
  v_lshlrev_b32 v106, 16, v81
  v_and_b32 v107, 0xffff0000, v81
  v_lshlrev_b32 v108, 16, v82
  v_and_b32 v109, 0xffff0000, v82
  v_lshlrev_b32 v110, 16, v83
  v_and_b32 v111, 0xffff0000, v83
  v_pk_add_f32 v[96:97], v[96:97], v[104:105]
  v_pk_add_f32 v[98:99], v[98:99], v[106:107]
  v_pk_add_f32 v[100:101], v[100:101], v[108:109]
  v_pk_add_f32 v[102:103], v[102:103], v[110:111]
  s_waitcnt vmcnt(1)
  v_lshlrev_b32 v104, 16, v84
  v_and_b32 v105, 0xffff0000, v84
  v_lshlrev_b32 v106, 16, v85
  v_and_b32 v107, 0xffff0000, v85
  v_lshlrev_b32 v108, 16, v86
  v_and_b32 v109, 0xffff0000, v86
  v_lshlrev_b32 v110, 16, v87
  v_and_b32 v111, 0xffff0000, v87
  v_pk_add_f32 v[96:97], v[96:97], v[104:105]
  v_pk_add_f32 v[98:99], v[98:99], v[106:107]
  v_pk_add_f32 v[100:101], v[100:101], v[108:109]
  v_pk_add_f32 v[102:103], v[102:103], v[110:111]
  s_waitcnt lgkmcnt(0)
  v_lshlrev_b32 v104, 16, v120
  v_and_b32 v105, 0xffff0000, v120
  v_lshlrev_b32 v106, 16, v121
  v_and_b32 v107, 0xffff0000, v121
  v_lshlrev_b32 v108, 16, v122
  v_and_b32 v109, 0xffff0000, v122
  v_lshlrev_b32 v110, 16, v123
  v_and_b32 v111, 0xffff0000, v123
  v_pk_add_f32 v[96:97], v[96:97], v[104:105]
  v_pk_add_f32 v[98:99], v[98:99], v[106:107]
  v_pk_add_f32 v[100:101], v[100:101], v[108:109]
  v_pk_add_f32 v[102:103], v[102:103], v[110:111]
  v_cvt_pk_bf16_f32 v104, v96, v97
  v_cvt_pk_bf16_f32 v105, v98, v99
  v_cvt_pk_bf16_f32 v106, v100, v101
  v_cvt_pk_bf16_f32 v107, v102, v103
  s_cmp_eq_u32 s55, 1
  s_cbranch_scc1 RX_37
  s_nop 0
  v_permlane32_swap_b32 v104, v106
  v_permlane32_swap_b32 v105, v107
  s_nop 1
  buffer_store_dwordx4 v[104:107], v22, s[24:27], s54 offen
  s_branch RD_38

RX_37:
  s_add_u32 s45, s54, 18432
  buffer_store_dwordx2 v[104:105], v22, s[24:27], s54 offen
  buffer_store_dwordx2 v[106:107], v22, s[24:27], s45 offen

RD_38:
RE_31:
  s_endpgm
K_ATT:
  s_sub_u32 s30, s30, 4
  s_setprio 2
  s_and_b32 s31, s30, 1
  s_lshr_b32 s32, s30, 1
  s_mov_b32 s41, 357913942
  v_mov_b32 v14, 161088
  v_mov_b32 v15, 1
  s_and_b32 s44, s29, 3
  s_lshl_b32 s44, s44, 4
  s_mul_i32 s45, s29, 144
  s_sub_u32 s45, s45, s44

  s_and_b32 s46, s28, 15
  s_mul_i32 s46, s46, 72
  s_add_u32 s47, s46, 71
  s_lshl_b32 s43, s30, 6
  s_add_u32 s46, s46, s43
  v_add_u32 v26, s46, v1
  v_min_u32 v26, s47, v26
  v_lshrrev_b32 v27, 1, v26
  v_and_b32 v26, 1, v26
  v_mul_u32_u24 v27, 1152, v27
  v_mul_u32_u24 v26, 188, v26
  v_add3_u32 v26, v26, v27, s45
  s_waitcnt lgkmcnt(0)
  global_load_dword v13, v26, s[50:51]

  s_add_u32 s46, s30, 0
  s_lshl_b32 s46, s46, 6
  v_add_u32 v26, s46, v1
  v_mul_hi_u32 v27, v26, s41
  v_mul_u32_u24 v3, 12, v27
  v_sub_u32 v26, v26, v3
  v_mul_u32_u24 v27, 1152, v27
  v_lshl_add_u32 v27, v26, 4, v27
  v_add_u32 v8, s45, v27

  s_add_u32 s46, s30, 4
  s_lshl_b32 s46, s46, 6
  v_add_u32 v26, s46, v1
  v_mul_hi_u32 v27, v26, s41
  v_mul_u32_u24 v3, 12, v27
  v_sub_u32 v26, v26, v3
  v_mul_u32_u24 v27, 1152, v27
  v_lshl_add_u32 v27, v26, 4, v27
  v_add_u32 v9, s45, v27

  s_add_u32 s46, s30, 8
  s_lshl_b32 s46, s46, 6
  v_add_u32 v26, s46, v1
  v_mul_hi_u32 v27, v26, s41
  v_mul_u32_u24 v3, 12, v27
  v_sub_u32 v26, v26, v3
  v_mul_u32_u24 v27, 1152, v27
  v_lshl_add_u32 v27, v26, 4, v27
  v_add_u32 v10, s45, v27

  v_lshrrev_b32 v26, 5, v1
  v_bfe_u32 v27, v1, 4, 1
  v_bfe_u32 v28, v1, 2, 2
  v_and_b32 v29, 3, v1
  v_lshl_add_u32 v30, v26, 3, v28
  v_mul_u32_u24 v30, 192, v30
  v_lshl_add_u32 v30, v27, 5, v30
  v_lshl_add_u32 v30, v29, 3, v30
  s_mul_i32 s46, s32, 72
  s_add_u32 s46, s46, s44
  s_add_u32 s46, s46, 74880
  v_add_u32 v11, s46, v30
  v_add_u32 v12, 32, v11

  v_lshrrev_b32 v26, 5, v1
  v_and_b32 v27, 31, v1
  s_lshl_b32 s36, s31, 5
  v_add_u32 v28, s36, v27
  v_mul_u32_u24 v28, 1152, v28
  v_bfe_u32 v29, v27, 1, 3
  v_add_u32 v30, 0, v26
  v_xor_b32 v30, v30, v29
  v_lshl_add_u32 v4, v30, 4, v28
  v_add_u32 v30, 2, v26
  v_xor_b32 v30, v30, v29
  v_lshl_add_u32 v5, v30, 4, v28
  v_add_u32 v30, 4, v26
  v_xor_b32 v30, v30, v29
  v_lshl_add_u32 v6, v30, 4, v28
  v_add_u32 v30, 6, v26
  v_xor_b32 v30, v30, v29
  v_lshl_add_u32 v7, v30, 4, v28
  s_mov_b32 s40, 429496730
  s_add_u32 s46, s30, 0
  s_lshl_b32 s46, s46, 6
  v_add_u32 v26, s46, v1
  v_mul_hi_u32 v27, v26, s40
  v_mul_u32_u24 v3, 10, v27
  v_sub_u32 v26, v26, v3
  v_min_u32 v26, 8, v26
  v_mul_u32_u24 v27, 36, v27
  v_lshl_add_u32 v48, v26, 2, v27

  s_add_u32 s46, s30, 4
  s_lshl_b32 s46, s46, 6
  v_add_u32 v26, s46, v1
  v_mul_hi_u32 v27, v26, s40
  v_mul_u32_u24 v3, 10, v27
  v_sub_u32 v26, v26, v3
  v_min_u32 v26, 8, v26
  v_mul_u32_u24 v27, 36, v27
  v_lshl_add_u32 v49, v26, 2, v27

  s_add_u32 s46, s30, 8
  s_lshl_b32 s46, s46, 6
  v_add_u32 v26, s46, v1
  v_mul_hi_u32 v27, v26, s40
  v_mul_u32_u24 v3, 10, v27
  v_sub_u32 v26, v26, v3
  v_min_u32 v26, 8, v26
  v_mul_u32_u24 v27, 36, v27
  v_lshl_add_u32 v50, v26, 2, v27

  s_add_u32 s46, s30, 12
  s_lshl_b32 s46, s46, 6
  v_add_u32 v26, s46, v1
  v_mul_hi_u32 v27, v26, s40
  v_mul_u32_u24 v3, 10, v27
  v_sub_u32 v26, v26, v3
  v_min_u32 v26, 8, v26
  v_mul_u32_u24 v27, 36, v27
  v_lshl_add_u32 v51, v26, 2, v27

  s_add_u32 s46, s30, 16
  s_lshl_b32 s46, s46, 6
  v_add_u32 v26, s46, v1
  v_mul_hi_u32 v27, v26, s40
  v_mul_u32_u24 v3, 10, v27
  v_sub_u32 v26, v26, v3
  v_min_u32 v26, 8, v26
  v_mul_u32_u24 v27, 36, v27
  v_lshl_add_u32 v52, v26, 2, v27

  v_mov_b32 v3, 161088
  v_mov_b32 v20, 0
  v_mov_b32 v21, 0
  v_mov_b32 v22, 0
  v_mov_b32 v23, 0
  ds_write_b128 v3, v[20:23]
  ds_write_b128 v3, v[20:23] offset:16
  ds_write_b128 v3, v[20:23] offset:32
  ds_write_b128 v3, v[20:23] offset:48
  ds_write_b128 v3, v[20:23] offset:64
  ds_write_b128 v3, v[20:23] offset:80
  ds_write_b128 v3, v[20:23] offset:96

  s_waitcnt lgkmcnt(0)
  s_barrier
  s_mov_b32 s20, s62
  s_and_b32 s21, s63, 0xffff
  s_mov_b32 s22, 268435456
  s_mov_b32 s23, 0x00020000

  s_cmp_ge_u32 s29, 2
  s_cbranch_scc1 PA_NOKVI
  s_cmp_eq_u32 s29, 1
  s_cselect_b32 s42, s54, s52
  s_cselect_b32 s43, s55, s53

  s_mov_b32 s24, s42
  s_and_b32 s25, s43, 0xffff
  s_mov_b32 s26, 20736
  s_mov_b32 s27, 0x00020000

  s_lshl_b32 s46, s30, 8
  s_add_u32 m0, s46, 130176
  s_mov_b32 s47, 0
  buffer_load_dword v48, s[24:27], s47 offen lds

  s_lshl_b32 s46, s30, 8
  s_add_u32 m0, s46, 131200
  s_mov_b32 s47, 0
  buffer_load_dword v49, s[24:27], s47 offen lds

  s_lshl_b32 s46, s30, 8
  s_add_u32 m0, s46, 132224
  s_mov_b32 s47, 0
  buffer_load_dword v50, s[24:27], s47 offen lds

  s_lshl_b32 s46, s30, 8
  s_add_u32 m0, s46, 133248
  s_mov_b32 s47, 0
  buffer_load_dword v51, s[24:27], s47 offen lds

  s_lshl_b32 s46, s30, 8
  s_add_u32 m0, s46, 134272
  s_mov_b32 s47, 0
  buffer_load_dword v52, s[24:27], s47 offen lds

  s_lshl_b32 s46, s30, 8
  s_add_u32 m0, s46, 135296
  s_mov_b32 s47, 4608
  buffer_load_dword v48, s[24:27], s47 offen lds

  s_lshl_b32 s46, s30, 8
  s_add_u32 m0, s46, 136320
  s_mov_b32 s47, 4608
  buffer_load_dword v49, s[24:27], s47 offen lds

  s_lshl_b32 s46, s30, 8
  s_add_u32 m0, s46, 137344
  s_mov_b32 s47, 4608
  buffer_load_dword v50, s[24:27], s47 offen lds

  s_lshl_b32 s46, s30, 8
  s_add_u32 m0, s46, 138368
  s_mov_b32 s47, 4608
  buffer_load_dword v51, s[24:27], s47 offen lds

  s_lshl_b32 s46, s30, 8
  s_add_u32 m0, s46, 139392
  s_mov_b32 s47, 4608
  buffer_load_dword v52, s[24:27], s47 offen lds

  s_lshl_b32 s46, s30, 8
  s_add_u32 m0, s46, 140416
  s_mov_b32 s47, 9216
  buffer_load_dword v48, s[24:27], s47 offen lds

  s_lshl_b32 s46, s30, 8
  s_add_u32 m0, s46, 141440
  s_mov_b32 s47, 9216
  buffer_load_dword v49, s[24:27], s47 offen lds

  s_lshl_b32 s46, s30, 8
  s_add_u32 m0, s46, 142464
  s_mov_b32 s47, 9216
  buffer_load_dword v50, s[24:27], s47 offen lds

  s_lshl_b32 s46, s30, 8
  s_add_u32 m0, s46, 143488
  s_mov_b32 s47, 9216
  buffer_load_dword v51, s[24:27], s47 offen lds

  s_lshl_b32 s46, s30, 8
  s_add_u32 m0, s46, 144512
  s_mov_b32 s47, 9216
  buffer_load_dword v52, s[24:27], s47 offen lds

  s_lshl_b32 s46, s30, 8
  s_add_u32 m0, s46, 145536
  s_mov_b32 s47, 13824
  buffer_load_dword v48, s[24:27], s47 offen lds

  s_lshl_b32 s46, s30, 8
  s_add_u32 m0, s46, 146560
  s_mov_b32 s47, 13824
  buffer_load_dword v49, s[24:27], s47 offen lds

  s_lshl_b32 s46, s30, 8
  s_add_u32 m0, s46, 147584
  s_mov_b32 s47, 13824
  buffer_load_dword v50, s[24:27], s47 offen lds

  s_lshl_b32 s46, s30, 8
  s_add_u32 m0, s46, 148608
  s_mov_b32 s47, 13824
  buffer_load_dword v51, s[24:27], s47 offen lds

  s_lshl_b32 s46, s30, 8
  s_add_u32 m0, s46, 149632
  s_mov_b32 s47, 13824
  buffer_load_dword v52, s[24:27], s47 offen lds

  s_lshl_b32 s46, s30, 8
  s_add_u32 m0, s46, 150656
  s_mov_b32 s47, 18432
  buffer_load_dword v48, s[24:27], s47 offen lds

  s_lshl_b32 s46, s30, 8
  s_add_u32 m0, s46, 151680
  s_mov_b32 s47, 18432
  buffer_load_dword v49, s[24:27], s47 offen lds

  s_cmp_ge_u32 s30, 2
  s_cbranch_scc1 PA_KVI2
  s_lshl_b32 s46, s30, 8
  s_add_u32 m0, s46, 152704
  s_mov_b32 s47, 18432
  buffer_load_dword v50, s[24:27], s47 offen lds

PA_KVI2:
  s_mov_b32 s24, s50
  s_and_b32 s25, s51, 0xffff
  s_mov_b32 s26, 663552
  s_mov_b32 s27, 0x00020000

  s_lshl_b32 s46, s30, 10
  s_add_u32 m0, s46, 74880
  s_mov_b32 s47, 0
  buffer_load_dwordx4 v8, s[24:27], s47 offen lds

  s_lshl_b32 s46, s30, 10
  s_add_u32 m0, s46, 78976
  s_mov_b32 s47, 0
  buffer_load_dwordx4 v9, s[24:27], s47 offen lds

  s_lshl_b32 s46, s30, 10
  s_add_u32 m0, s46, 83072
  s_mov_b32 s47, 0
  buffer_load_dwordx4 v10, s[24:27], s47 offen lds

  s_lshl_b32 s46, s30, 10
  s_add_u32 m0, s46, 87168
  s_mov_b32 s47, 73728
  buffer_load_dwordx4 v8, s[24:27], s47 offen lds

  s_lshl_b32 s46, s30, 10
  s_add_u32 m0, s46, 91264
  s_mov_b32 s47, 73728
  buffer_load_dwordx4 v9, s[24:27], s47 offen lds

  s_lshl_b32 s46, s30, 10
  s_add_u32 m0, s46, 95360
  s_mov_b32 s47, 73728
  buffer_load_dwordx4 v10, s[24:27], s47 offen lds

  s_cmp_ge_u32 s30, 3
  s_cbranch_scc1 PW_SKIP_a0
  s_lshl_b32 s46, s30, 10
  s_add_u32 m0, s46, 99456
  s_mov_b32 s47, 147456
  buffer_load_dwordx4 v8, s[24:27], s47 offen lds

PW_SKIP_a0:
  s_lshl_b32 s46, s30, 10
  s_add_u32 m0, s46, 102528
  s_mov_b32 s47, 165888
  buffer_load_dwordx4 v8, s[24:27], s47 offen lds

  s_lshl_b32 s46, s30, 10
  s_add_u32 m0, s46, 106624
  s_mov_b32 s47, 165888
  buffer_load_dwordx4 v9, s[24:27], s47 offen lds

  s_lshl_b32 s46, s30, 10
  s_add_u32 m0, s46, 110720
  s_mov_b32 s47, 165888
  buffer_load_dwordx4 v10, s[24:27], s47 offen lds

  s_lshl_b32 s46, s30, 10
  s_add_u32 m0, s46, 114816
  s_mov_b32 s47, 239616
  buffer_load_dwordx4 v8, s[24:27], s47 offen lds

  s_lshl_b32 s46, s30, 10
  s_add_u32 m0, s46, 118912
  s_mov_b32 s47, 239616
  buffer_load_dwordx4 v9, s[24:27], s47 offen lds

  s_lshl_b32 s46, s30, 10
  s_add_u32 m0, s46, 123008
  s_mov_b32 s47, 239616
  buffer_load_dwordx4 v10, s[24:27], s47 offen lds

  s_cmp_ge_u32 s30, 3
  s_cbranch_scc1 PW_SKIP_a1
  s_lshl_b32 s46, s30, 10
  s_add_u32 m0, s46, 127104
  s_mov_b32 s47, 313344
  buffer_load_dwordx4 v8, s[24:27], s47 offen lds

PW_SKIP_a1:
  s_branch PA_ISS
PA_NOKVI:
  s_mov_b32 s24, s50
  s_and_b32 s25, s51, 0xffff
  s_mov_b32 s26, 663552
  s_mov_b32 s27, 0x00020000

  s_lshl_b32 s46, s30, 10
  s_add_u32 m0, s46, 74880
  s_mov_b32 s47, 0
  buffer_load_dwordx4 v8, s[24:27], s47 offen lds

  s_lshl_b32 s46, s30, 10
  s_add_u32 m0, s46, 78976
  s_mov_b32 s47, 0
  buffer_load_dwordx4 v9, s[24:27], s47 offen lds

  s_lshl_b32 s46, s30, 10
  s_add_u32 m0, s46, 83072
  s_mov_b32 s47, 0
  buffer_load_dwordx4 v10, s[24:27], s47 offen lds

  s_lshl_b32 s46, s30, 10
  s_add_u32 m0, s46, 87168
  s_mov_b32 s47, 73728
  buffer_load_dwordx4 v8, s[24:27], s47 offen lds

  s_lshl_b32 s46, s30, 10
  s_add_u32 m0, s46, 91264
  s_mov_b32 s47, 73728
  buffer_load_dwordx4 v9, s[24:27], s47 offen lds

  s_lshl_b32 s46, s30, 10
  s_add_u32 m0, s46, 95360
  s_mov_b32 s47, 73728
  buffer_load_dwordx4 v10, s[24:27], s47 offen lds

  s_cmp_ge_u32 s30, 3
  s_cbranch_scc1 PW_SKIP_b0
  s_lshl_b32 s46, s30, 10
  s_add_u32 m0, s46, 99456
  s_mov_b32 s47, 147456
  buffer_load_dwordx4 v8, s[24:27], s47 offen lds

PW_SKIP_b0:
  s_lshl_b32 s46, s30, 10
  s_add_u32 m0, s46, 102528
  s_mov_b32 s47, 165888
  buffer_load_dwordx4 v8, s[24:27], s47 offen lds

  s_lshl_b32 s46, s30, 10
  s_add_u32 m0, s46, 106624
  s_mov_b32 s47, 165888
  buffer_load_dwordx4 v9, s[24:27], s47 offen lds

  s_lshl_b32 s46, s30, 10
  s_add_u32 m0, s46, 110720
  s_mov_b32 s47, 165888
  buffer_load_dwordx4 v10, s[24:27], s47 offen lds

  s_lshl_b32 s46, s30, 10
  s_add_u32 m0, s46, 114816
  s_mov_b32 s47, 239616
  buffer_load_dwordx4 v8, s[24:27], s47 offen lds

  s_lshl_b32 s46, s30, 10
  s_add_u32 m0, s46, 118912
  s_mov_b32 s47, 239616
  buffer_load_dwordx4 v9, s[24:27], s47 offen lds

  s_lshl_b32 s46, s30, 10
  s_add_u32 m0, s46, 123008
  s_mov_b32 s47, 239616
  buffer_load_dwordx4 v10, s[24:27], s47 offen lds

  s_cmp_ge_u32 s30, 3
  s_cbranch_scc1 PW_SKIP_b1
  s_lshl_b32 s46, s30, 10
  s_add_u32 m0, s46, 127104
  s_mov_b32 s47, 313344
  buffer_load_dwordx4 v8, s[24:27], s47 offen lds

PW_SKIP_b1:
  s_lshl_b32 s46, s30, 10
  s_add_u32 m0, s46, 130176
  s_mov_b32 s47, 331776
  buffer_load_dwordx4 v8, s[24:27], s47 offen lds

  s_lshl_b32 s46, s30, 10
  s_add_u32 m0, s46, 134272
  s_mov_b32 s47, 331776
  buffer_load_dwordx4 v9, s[24:27], s47 offen lds

  s_lshl_b32 s46, s30, 10
  s_add_u32 m0, s46, 138368
  s_mov_b32 s47, 331776
  buffer_load_dwordx4 v10, s[24:27], s47 offen lds

  s_lshl_b32 s46, s30, 10
  s_add_u32 m0, s46, 142464
  s_mov_b32 s47, 405504
  buffer_load_dwordx4 v8, s[24:27], s47 offen lds

  s_lshl_b32 s46, s30, 10
  s_add_u32 m0, s46, 146560
  s_mov_b32 s47, 405504
  buffer_load_dwordx4 v9, s[24:27], s47 offen lds

  s_lshl_b32 s46, s30, 10
  s_add_u32 m0, s46, 150656
  s_mov_b32 s47, 405504
  buffer_load_dwordx4 v10, s[24:27], s47 offen lds

  s_cmp_ge_u32 s30, 3
  s_cbranch_scc1 PW_SKIP_b2
  s_lshl_b32 s46, s30, 10
  s_add_u32 m0, s46, 154752
  s_mov_b32 s47, 479232
  buffer_load_dwordx4 v8, s[24:27], s47 offen lds

PW_SKIP_b2:
PA_ISS:
  s_load_dwordx2 s[40:41], s[0:1], 32
  s_load_dwordx4 s[44:47], s[0:1], 48
  s_load_dwordx4 s[52:55], s[0:1], 64
  s_load_dwordx2 s[42:43], s[0:1], 88
  s_waitcnt lgkmcnt(0)
  s_cmp_eq_u32 s30, 3
  s_cbranch_scc1 E_T7
  s_and_b32 s36, s28, 15
  s_lshl_b32 s36, s36, 6
  s_min_u32 s37, s30, 1
  s_mul_i32 s37, s37, 1024
  s_add_u32 s36, s36, s37
  v_add_u32 v26, s36, v1
  s_mov_b32 s36, 477218589
  v_mul_hi_u32 v27, v26, s36
  v_mul_u32_u24 v28, 9, v27
  v_sub_u32 v26, v26, v28
  v_mul_u32_u24 v27, 9216, v27
  v_lshl_add_u32 v26, v26, 7, v27
  s_mul_i32 s37, s29, 1152
  v_add_u32 v26, s37, v26
  global_load_dword v13, v26, s[44:45]
  s_branch E_NOT

E_T7:
  s_mul_i32 s36, s29, 663552
  s_add_u32 s52, s52, s36
  s_addc_u32 s53, s53, 0
  s_mul_i32 s36, s29, 82944
  s_add_u32 s40, s40, s36
  s_addc_u32 s41, s41, 0
  s_mul_i32 s36, s28, 73728
  s_add_u32 s42, s42, s36
  s_addc_u32 s43, s43, 0
  s_mul_i32 s36, s3, 73728
  s_add_u32 s36, s36, 1048576
  s_add_u32 s44, s62, s36
  s_addc_u32 s45, s63, 0
  v_mov_b32 v26, s62
  v_mov_b32 v27, s63
  v_writelane_b32 v26, s52, 0
  v_writelane_b32 v27, s53, 0
  v_writelane_b32 v26, s40, 1
  v_writelane_b32 v27, s41, 1
  v_writelane_b32 v26, s46, 2
  v_writelane_b32 v27, s47, 2
  v_writelane_b32 v26, s54, 3
  v_writelane_b32 v27, s55, 3
  v_writelane_b32 v26, s42, 4
  v_writelane_b32 v27, s43, 4
  v_writelane_b32 v26, s44, 6
  v_writelane_b32 v27, s45, 6
  s_mov_b64 exec, 0xff
  global_load_dword v13, v[26:27], off
  s_mov_b64 exec, -1

E_NOT:
  s_cmp_ge_u32 s29, 2
  s_cbranch_scc1 PA_XW
  s_waitcnt vmcnt(13)
  s_mov_b64 exec, 1
  ds_add_u32 v14, v15 offset:80
  s_mov_b64 exec, -1

PA_XW:
  s_mov_b32 s39, 0x40000
WAITC_39:
  ds_read_b32 v3, v14 offset:64
  s_waitcnt lgkmcnt(0)
  v_readfirstlane_b32 s38, v3
  s_cmp_ge_u32 s38, 4
  s_cbranch_scc1 WAITD_40
  s_sleep 1
  s_sub_u32 s39, s39, 1
  s_cmp_lg_u32 s39, 0
  s_cbranch_scc1 WAITC_39

WAITD_40:
  ds_read_b128 v[64:67], v4 offset:0
  ds_read_b128 v[68:71], v5 offset:0
  ds_read_b128 v[72:75], v6 offset:0
  ds_read_b128 v[76:79], v7 offset:0
  ds_read_b128 v[80:83], v4 offset:128
  ds_read_b128 v[84:87], v5 offset:128
  ds_read_b128 v[88:91], v6 offset:128
  ds_read_b128 v[92:95], v7 offset:128
  ds_read_b128 v[96:99], v4 offset:256
  ds_read_b128 v[100:103], v5 offset:256
  ds_read_b128 v[104:107], v6 offset:256
  ds_read_b128 v[108:111], v7 offset:256
  s_cmp_ge_u32 s29, 2
  s_cbranch_scc1 PA_V12
  s_waitcnt vmcnt(7)
  s_branch PA_VD
PA_V12:
  s_waitcnt vmcnt(13)
PA_VD:
  s_waitcnt vmcnt(63)
  s_waitcnt lgkmcnt(0)
  s_mov_b64 exec, 1
  ds_add_u32 v14, v15 offset:40
  s_mov_b64 exec, -1

  s_mov_b32 s39, 0x40000
WAITC_41:
  ds_read_b32 v3, v14 offset:40
  s_waitcnt lgkmcnt(0)
  v_readfirstlane_b32 s38, v3
  s_cmp_ge_u32 s38, 4
  s_cbranch_scc1 WAITD_42
  s_sleep 1
  s_sub_u32 s39, s39, 1
  s_cmp_lg_u32 s39, 0
  s_cbranch_scc1 WAITC_41

WAITD_42:
  v_add_u32 v2, 0, v11
  v_add_u32 v48, 0, v12
  ds_read_b64_tr_b16 v[16:17], v2 offset:0
  ds_read_b64_tr_b16 v[18:19], v2 offset:768
  ds_read_b64_tr_b16 v[20:21], v48 offset:0
  ds_read_b64_tr_b16 v[22:23], v48 offset:768
  ds_read_b64_tr_b16 v[24:25], v2 offset:3072
  ds_read_b64_tr_b16 v[26:27], v2 offset:3840
  ds_read_b64_tr_b16 v[28:29], v48 offset:3072
  ds_read_b64_tr_b16 v[30:31], v48 offset:3840
  s_waitcnt lgkmcnt(4)
  v_mfma_f32_32x32x16_bf16 v[208:223], v[16:19], v[64:67], 0
  v_mfma_f32_32x32x16_bf16 v[224:239], v[20:23], v[64:67], 0
  ds_read_b128 v[112:115], v4 offset:384
  ds_read_b128 v[116:119], v5 offset:384
  ds_read_b128 v[120:123], v6 offset:384
  ds_read_b64_tr_b16 v[32:33], v2 offset:6144
  ds_read_b64_tr_b16 v[34:35], v2 offset:6912
  ds_read_b64_tr_b16 v[36:37], v48 offset:6144
  ds_read_b64_tr_b16 v[38:39], v48 offset:6912
  s_waitcnt lgkmcnt(7)
  v_mfma_f32_32x32x16_bf16 v[208:223], v[24:27], v[68:71], v[208:223]
  v_mfma_f32_32x32x16_bf16 v[224:239], v[28:31], v[68:71], v[224:239]
  ds_read_b128 v[124:127], v7 offset:384
  ds_read_b128 v[128:131], v4 offset:512
  ds_read_b128 v[132:135], v5 offset:512
  ds_read_b64_tr_b16 v[40:41], v2 offset:9216
  ds_read_b64_tr_b16 v[42:43], v2 offset:9984
  ds_read_b64_tr_b16 v[44:45], v48 offset:9216
  ds_read_b64_tr_b16 v[46:47], v48 offset:9984
  s_waitcnt lgkmcnt(7)
  v_mfma_f32_32x32x16_bf16 v[208:223], v[32:35], v[72:75], v[208:223]
  v_mfma_f32_32x32x16_bf16 v[224:239], v[36:39], v[72:75], v[224:239]
  ds_read_b128 v[136:139], v6 offset:512
  ds_read_b128 v[140:143], v7 offset:512
  ds_read_b128 v[144:147], v4 offset:640
  ds_read_b64_tr_b16 v[16:17], v2 offset:12288
  ds_read_b64_tr_b16 v[18:19], v2 offset:13056
  ds_read_b64_tr_b16 v[20:21], v48 offset:12288
  ds_read_b64_tr_b16 v[22:23], v48 offset:13056
  s_waitcnt lgkmcnt(7)
  v_mfma_f32_32x32x16_bf16 v[208:223], v[40:43], v[76:79], v[208:223]
  v_mfma_f32_32x32x16_bf16 v[224:239], v[44:47], v[76:79], v[224:239]
  ds_read_b128 v[148:151], v5 offset:640
  ds_read_b128 v[152:155], v6 offset:640
  ds_read_b128 v[156:159], v7 offset:640
  ds_read_b64_tr_b16 v[24:25], v2 offset:15360
  ds_read_b64_tr_b16 v[26:27], v2 offset:16128
  ds_read_b64_tr_b16 v[28:29], v48 offset:15360
  ds_read_b64_tr_b16 v[30:31], v48 offset:16128
  s_waitcnt lgkmcnt(7)
  v_mfma_f32_32x32x16_bf16 v[208:223], v[16:19], v[80:83], v[208:223]
  v_mfma_f32_32x32x16_bf16 v[224:239], v[20:23], v[80:83], v[224:239]
  ds_read_b128 v[160:163], v4 offset:768
  ds_read_b128 v[164:167], v5 offset:768
  ds_read_b128 v[168:171], v6 offset:768
  ds_read_b64_tr_b16 v[32:33], v2 offset:18432
  ds_read_b64_tr_b16 v[34:35], v2 offset:19200
  ds_read_b64_tr_b16 v[36:37], v48 offset:18432
  ds_read_b64_tr_b16 v[38:39], v48 offset:19200
  s_waitcnt lgkmcnt(7)
  v_mfma_f32_32x32x16_bf16 v[208:223], v[24:27], v[84:87], v[208:223]
  v_mfma_f32_32x32x16_bf16 v[224:239], v[28:31], v[84:87], v[224:239]
  ds_read_b128 v[172:175], v7 offset:768
  ds_read_b128 v[176:179], v4 offset:896
  ds_read_b128 v[180:183], v5 offset:896
  ds_read_b64_tr_b16 v[40:41], v2 offset:21504
  ds_read_b64_tr_b16 v[42:43], v2 offset:22272
  ds_read_b64_tr_b16 v[44:45], v48 offset:21504
  ds_read_b64_tr_b16 v[46:47], v48 offset:22272
  s_waitcnt lgkmcnt(7)
  v_mfma_f32_32x32x16_bf16 v[208:223], v[32:35], v[88:91], v[208:223]
  v_mfma_f32_32x32x16_bf16 v[224:239], v[36:39], v[88:91], v[224:239]
  ds_read_b128 v[184:187], v6 offset:896
  ds_read_b128 v[188:191], v7 offset:896
  ds_read_b128 v[192:195], v4 offset:1024
  ds_read_b64_tr_b16 v[16:17], v2 offset:24576
  ds_read_b64_tr_b16 v[18:19], v2 offset:25344
  ds_read_b64_tr_b16 v[20:21], v48 offset:24576
  ds_read_b64_tr_b16 v[22:23], v48 offset:25344
  s_waitcnt lgkmcnt(7)
  v_mfma_f32_32x32x16_bf16 v[208:223], v[40:43], v[92:95], v[208:223]
  v_mfma_f32_32x32x16_bf16 v[224:239], v[44:47], v[92:95], v[224:239]
  ds_read_b128 v[196:199], v5 offset:1024
  ds_read_b128 v[200:203], v6 offset:1024
  ds_read_b128 v[204:207], v7 offset:1024
  s_waitcnt lgkmcnt(3)
  v_mfma_f32_32x32x16_bf16 v[208:223], v[16:19], v[96:99], v[208:223]
  v_mfma_f32_32x32x16_bf16 v[224:239], v[20:23], v[96:99], v[224:239]
  s_waitcnt lgkmcnt(0)
  s_mov_b64 exec, 1
  ds_add_u32 v14, v15 offset:76
  s_mov_b64 exec, -1

  s_cmp_ge_u32 s29, 2
  s_cbranch_scc1 PA_GO
  s_mov_b32 s39, 0x40000
WAITC_43:
  ds_read_b32 v3, v14 offset:68
  s_waitcnt lgkmcnt(0)
  v_readfirstlane_b32 s38, v3
  s_cmp_ge_u32 s38, 2
  s_cbranch_scc1 WAITD_44
  s_sleep 1
  s_sub_u32 s39, s39, 1
  s_cmp_lg_u32 s39, 0
  s_cbranch_scc1 WAITC_43

WAITD_44:
  s_lshl_b32 s46, s30, 10
  s_add_u32 m0, s46, 130176
  s_mov_b32 s47, 331776
  buffer_load_dwordx4 v8, s[24:27], s47 offen lds

  s_lshl_b32 s46, s30, 10
  s_add_u32 m0, s46, 134272
  s_mov_b32 s47, 331776
  buffer_load_dwordx4 v9, s[24:27], s47 offen lds

  s_lshl_b32 s46, s30, 10
  s_add_u32 m0, s46, 138368
  s_mov_b32 s47, 331776
  buffer_load_dwordx4 v10, s[24:27], s47 offen lds

  s_lshl_b32 s46, s30, 10
  s_add_u32 m0, s46, 142464
  s_mov_b32 s47, 405504
  buffer_load_dwordx4 v8, s[24:27], s47 offen lds

  s_lshl_b32 s46, s30, 10
  s_add_u32 m0, s46, 146560
  s_mov_b32 s47, 405504
  buffer_load_dwordx4 v9, s[24:27], s47 offen lds

  s_lshl_b32 s46, s30, 10
  s_add_u32 m0, s46, 150656
  s_mov_b32 s47, 405504
  buffer_load_dwordx4 v10, s[24:27], s47 offen lds

  s_cmp_ge_u32 s30, 3
  s_cbranch_scc1 PW_SKIP_a2
  s_lshl_b32 s46, s30, 10
  s_add_u32 m0, s46, 154752
  s_mov_b32 s47, 479232
  buffer_load_dwordx4 v8, s[24:27], s47 offen lds

PW_SKIP_a2:
PA_GO:
  s_waitcnt vmcnt(6)
  s_waitcnt lgkmcnt(0)
  s_mov_b64 exec, 1
  ds_add_u32 v14, v15 offset:40
  s_mov_b64 exec, -1

  s_mov_b32 s39, 0x40000
WAITC_45:
  ds_read_b32 v3, v14 offset:40
  s_waitcnt lgkmcnt(0)
  v_readfirstlane_b32 s38, v3
  s_cmp_ge_u32 s38, 8
  s_cbranch_scc1 WAITD_46
  s_sleep 1
  s_sub_u32 s39, s39, 1
  s_cmp_lg_u32 s39, 0
  s_cbranch_scc1 WAITC_45

WAITD_46:
  s_lshl_b32 s46, s30, 10
  s_add_u32 m0, s46, 74880
  s_mov_b32 s47, 497664
  buffer_load_dwordx4 v8, s[24:27], s47 offen lds

  s_lshl_b32 s46, s30, 10
  s_add_u32 m0, s46, 78976
  s_mov_b32 s47, 497664
  buffer_load_dwordx4 v9, s[24:27], s47 offen lds

  s_lshl_b32 s46, s30, 10
  s_add_u32 m0, s46, 83072
  s_mov_b32 s47, 497664
  buffer_load_dwordx4 v10, s[24:27], s47 offen lds

  s_lshl_b32 s46, s30, 10
  s_add_u32 m0, s46, 87168
  s_mov_b32 s47, 571392
  buffer_load_dwordx4 v8, s[24:27], s47 offen lds

  s_lshl_b32 s46, s30, 10
  s_add_u32 m0, s46, 91264
  s_mov_b32 s47, 571392
  buffer_load_dwordx4 v9, s[24:27], s47 offen lds

  s_lshl_b32 s46, s30, 10
  s_add_u32 m0, s46, 95360
  s_mov_b32 s47, 571392
  buffer_load_dwordx4 v10, s[24:27], s47 offen lds

  s_cmp_ge_u32 s30, 3
  s_cbranch_scc1 PW_SKIP_q3
  s_lshl_b32 s46, s30, 10
  s_add_u32 m0, s46, 99456
  s_mov_b32 s47, 645120
  buffer_load_dwordx4 v8, s[24:27], s47 offen lds

PW_SKIP_q3:
  v_add_u32 v2, 27648, v11
  v_add_u32 v48, 27648, v12
  ds_read_b64_tr_b16 v[16:17], v2 offset:0
  ds_read_b64_tr_b16 v[18:19], v2 offset:768
  ds_read_b64_tr_b16 v[20:21], v48 offset:0
  ds_read_b64_tr_b16 v[22:23], v48 offset:768
  ds_read_b64_tr_b16 v[24:25], v2 offset:3072
  ds_read_b64_tr_b16 v[26:27], v2 offset:3840
  ds_read_b64_tr_b16 v[28:29], v48 offset:3072
  ds_read_b64_tr_b16 v[30:31], v48 offset:3840
  ds_read_b64_tr_b16 v[32:33], v2 offset:6144
  ds_read_b64_tr_b16 v[34:35], v2 offset:6912
  ds_read_b64_tr_b16 v[36:37], v48 offset:6144
  ds_read_b64_tr_b16 v[38:39], v48 offset:6912
  s_waitcnt lgkmcnt(8)
  v_mfma_f32_32x32x16_bf16 v[208:223], v[16:19], v[100:103], v[208:223]
  v_mfma_f32_32x32x16_bf16 v[224:239], v[20:23], v[100:103], v[224:239]
  ds_read_b64_tr_b16 v[40:41], v2 offset:9216
  ds_read_b64_tr_b16 v[42:43], v2 offset:9984
  ds_read_b64_tr_b16 v[44:45], v48 offset:9216
  ds_read_b64_tr_b16 v[46:47], v48 offset:9984
  s_waitcnt lgkmcnt(8)
  v_mfma_f32_32x32x16_bf16 v[208:223], v[24:27], v[104:107], v[208:223]
  v_mfma_f32_32x32x16_bf16 v[224:239], v[28:31], v[104:107], v[224:239]
  ds_read_b64_tr_b16 v[16:17], v2 offset:12288
  ds_read_b64_tr_b16 v[18:19], v2 offset:13056
  ds_read_b64_tr_b16 v[20:21], v48 offset:12288
  ds_read_b64_tr_b16 v[22:23], v48 offset:13056
  s_waitcnt lgkmcnt(8)
  v_mfma_f32_32x32x16_bf16 v[208:223], v[32:35], v[108:111], v[208:223]
  v_mfma_f32_32x32x16_bf16 v[224:239], v[36:39], v[108:111], v[224:239]
  ds_read_b64_tr_b16 v[24:25], v2 offset:15360
  ds_read_b64_tr_b16 v[26:27], v2 offset:16128
  ds_read_b64_tr_b16 v[28:29], v48 offset:15360
  ds_read_b64_tr_b16 v[30:31], v48 offset:16128
  s_waitcnt lgkmcnt(8)
  v_mfma_f32_32x32x16_bf16 v[208:223], v[40:43], v[112:115], v[208:223]
  v_mfma_f32_32x32x16_bf16 v[224:239], v[44:47], v[112:115], v[224:239]
  ds_read_b64_tr_b16 v[32:33], v2 offset:18432
  ds_read_b64_tr_b16 v[34:35], v2 offset:19200
  ds_read_b64_tr_b16 v[36:37], v48 offset:18432
  ds_read_b64_tr_b16 v[38:39], v48 offset:19200
  s_waitcnt lgkmcnt(8)
  v_mfma_f32_32x32x16_bf16 v[208:223], v[16:19], v[116:119], v[208:223]
  v_mfma_f32_32x32x16_bf16 v[224:239], v[20:23], v[116:119], v[224:239]
  ds_read_b64_tr_b16 v[40:41], v2 offset:21504
  ds_read_b64_tr_b16 v[42:43], v2 offset:22272
  ds_read_b64_tr_b16 v[44:45], v48 offset:21504
  ds_read_b64_tr_b16 v[46:47], v48 offset:22272
  s_waitcnt lgkmcnt(8)
  v_mfma_f32_32x32x16_bf16 v[208:223], v[24:27], v[120:123], v[208:223]
  v_mfma_f32_32x32x16_bf16 v[224:239], v[28:31], v[120:123], v[224:239]
  ds_read_b64_tr_b16 v[16:17], v2 offset:24576
  ds_read_b64_tr_b16 v[18:19], v2 offset:25344
  ds_read_b64_tr_b16 v[20:21], v48 offset:24576
  ds_read_b64_tr_b16 v[22:23], v48 offset:25344
  s_waitcnt lgkmcnt(8)
  v_mfma_f32_32x32x16_bf16 v[208:223], v[32:35], v[124:127], v[208:223]
  v_mfma_f32_32x32x16_bf16 v[224:239], v[36:39], v[124:127], v[224:239]
  s_waitcnt lgkmcnt(4)
  v_mfma_f32_32x32x16_bf16 v[208:223], v[40:43], v[128:131], v[208:223]
  v_mfma_f32_32x32x16_bf16 v[224:239], v[44:47], v[128:131], v[224:239]
  s_waitcnt lgkmcnt(0)
  v_mfma_f32_32x32x16_bf16 v[208:223], v[16:19], v[132:135], v[208:223]
  v_mfma_f32_32x32x16_bf16 v[224:239], v[20:23], v[132:135], v[224:239]
  s_waitcnt vmcnt(6)
  s_waitcnt lgkmcnt(0)
  s_mov_b64 exec, 1
  ds_add_u32 v14, v15 offset:40
  s_mov_b64 exec, -1

  s_mov_b32 s39, 0x40000
WAITC_47:
  ds_read_b32 v3, v14 offset:40
  s_waitcnt lgkmcnt(0)
  v_readfirstlane_b32 s38, v3
  s_cmp_ge_u32 s38, 12
  s_cbranch_scc1 WAITD_48
  s_sleep 1
  s_sub_u32 s39, s39, 1
  s_cmp_lg_u32 s39, 0
  s_cbranch_scc1 WAITC_47

WAITD_48:
  v_add_u32 v2, 55296, v11
  v_add_u32 v48, 55296, v12
  ds_read_b64_tr_b16 v[16:17], v2 offset:0
  ds_read_b64_tr_b16 v[18:19], v2 offset:768
  ds_read_b64_tr_b16 v[20:21], v48 offset:0
  ds_read_b64_tr_b16 v[22:23], v48 offset:768
  ds_read_b64_tr_b16 v[24:25], v2 offset:3072
  ds_read_b64_tr_b16 v[26:27], v2 offset:3840
  ds_read_b64_tr_b16 v[28:29], v48 offset:3072
  ds_read_b64_tr_b16 v[30:31], v48 offset:3840
  ds_read_b64_tr_b16 v[32:33], v2 offset:6144
  ds_read_b64_tr_b16 v[34:35], v2 offset:6912
  ds_read_b64_tr_b16 v[36:37], v48 offset:6144
  ds_read_b64_tr_b16 v[38:39], v48 offset:6912
  s_waitcnt lgkmcnt(8)
  v_mfma_f32_32x32x16_bf16 v[208:223], v[16:19], v[136:139], v[208:223]
  v_mfma_f32_32x32x16_bf16 v[224:239], v[20:23], v[136:139], v[224:239]
  ds_read_b64_tr_b16 v[40:41], v2 offset:9216
  ds_read_b64_tr_b16 v[42:43], v2 offset:9984
  ds_read_b64_tr_b16 v[44:45], v48 offset:9216
  ds_read_b64_tr_b16 v[46:47], v48 offset:9984
  s_waitcnt lgkmcnt(8)
  v_mfma_f32_32x32x16_bf16 v[208:223], v[24:27], v[140:143], v[208:223]
  v_mfma_f32_32x32x16_bf16 v[224:239], v[28:31], v[140:143], v[224:239]
  ds_read_b64_tr_b16 v[16:17], v2 offset:12288
  ds_read_b64_tr_b16 v[18:19], v2 offset:13056
  ds_read_b64_tr_b16 v[20:21], v48 offset:12288
  ds_read_b64_tr_b16 v[22:23], v48 offset:13056
  s_waitcnt lgkmcnt(8)
  v_mfma_f32_32x32x16_bf16 v[208:223], v[32:35], v[144:147], v[208:223]
  v_mfma_f32_32x32x16_bf16 v[224:239], v[36:39], v[144:147], v[224:239]
  ds_read_b64_tr_b16 v[24:25], v2 offset:15360
  ds_read_b64_tr_b16 v[26:27], v2 offset:16128
  ds_read_b64_tr_b16 v[28:29], v48 offset:15360
  ds_read_b64_tr_b16 v[30:31], v48 offset:16128
  s_waitcnt lgkmcnt(8)
  v_mfma_f32_32x32x16_bf16 v[208:223], v[40:43], v[148:151], v[208:223]
  v_mfma_f32_32x32x16_bf16 v[224:239], v[44:47], v[148:151], v[224:239]
  ds_read_b64_tr_b16 v[32:33], v2 offset:18432
  ds_read_b64_tr_b16 v[34:35], v2 offset:19200
  ds_read_b64_tr_b16 v[36:37], v48 offset:18432
  ds_read_b64_tr_b16 v[38:39], v48 offset:19200
  s_waitcnt lgkmcnt(8)
  v_mfma_f32_32x32x16_bf16 v[208:223], v[16:19], v[152:155], v[208:223]
  v_mfma_f32_32x32x16_bf16 v[224:239], v[20:23], v[152:155], v[224:239]
  ds_read_b64_tr_b16 v[40:41], v2 offset:21504
  ds_read_b64_tr_b16 v[42:43], v2 offset:22272
  ds_read_b64_tr_b16 v[44:45], v48 offset:21504
  ds_read_b64_tr_b16 v[46:47], v48 offset:22272
  s_waitcnt lgkmcnt(8)
  v_mfma_f32_32x32x16_bf16 v[208:223], v[24:27], v[156:159], v[208:223]
  v_mfma_f32_32x32x16_bf16 v[224:239], v[28:31], v[156:159], v[224:239]
  ds_read_b64_tr_b16 v[16:17], v2 offset:24576
  ds_read_b64_tr_b16 v[18:19], v2 offset:25344
  ds_read_b64_tr_b16 v[20:21], v48 offset:24576
  ds_read_b64_tr_b16 v[22:23], v48 offset:25344
  s_waitcnt lgkmcnt(8)
  v_mfma_f32_32x32x16_bf16 v[208:223], v[32:35], v[160:163], v[208:223]
  v_mfma_f32_32x32x16_bf16 v[224:239], v[36:39], v[160:163], v[224:239]
  s_waitcnt lgkmcnt(4)
  v_mfma_f32_32x32x16_bf16 v[208:223], v[40:43], v[164:167], v[208:223]
  v_mfma_f32_32x32x16_bf16 v[224:239], v[44:47], v[164:167], v[224:239]
  s_waitcnt lgkmcnt(0)
  v_mfma_f32_32x32x16_bf16 v[208:223], v[16:19], v[168:171], v[208:223]
  v_mfma_f32_32x32x16_bf16 v[224:239], v[20:23], v[168:171], v[224:239]
  s_waitcnt vmcnt(0)
  s_waitcnt lgkmcnt(0)
  s_mov_b64 exec, 1
  ds_add_u32 v14, v15 offset:40
  s_mov_b64 exec, -1

  s_mov_b32 s39, 0x40000
WAITC_49:
  ds_read_b32 v3, v14 offset:40
  s_waitcnt lgkmcnt(0)
  v_readfirstlane_b32 s38, v3
  s_cmp_ge_u32 s38, 16
  s_cbranch_scc1 WAITD_50
  s_sleep 1
  s_sub_u32 s39, s39, 1
  s_cmp_lg_u32 s39, 0
  s_cbranch_scc1 WAITC_49

WAITD_50:
  v_add_u32 v2, 0, v11
  v_add_u32 v48, 0, v12
  ds_read_b64_tr_b16 v[16:17], v2 offset:0
  ds_read_b64_tr_b16 v[18:19], v2 offset:768
  ds_read_b64_tr_b16 v[20:21], v48 offset:0
  ds_read_b64_tr_b16 v[22:23], v48 offset:768
  ds_read_b64_tr_b16 v[24:25], v2 offset:3072
  ds_read_b64_tr_b16 v[26:27], v2 offset:3840
  ds_read_b64_tr_b16 v[28:29], v48 offset:3072
  ds_read_b64_tr_b16 v[30:31], v48 offset:3840
  ds_read_b64_tr_b16 v[32:33], v2 offset:6144
  ds_read_b64_tr_b16 v[34:35], v2 offset:6912
  ds_read_b64_tr_b16 v[36:37], v48 offset:6144
  ds_read_b64_tr_b16 v[38:39], v48 offset:6912
  s_waitcnt lgkmcnt(8)
  v_mfma_f32_32x32x16_bf16 v[208:223], v[16:19], v[172:175], v[208:223]
  v_mfma_f32_32x32x16_bf16 v[224:239], v[20:23], v[172:175], v[224:239]
  ds_read_b64_tr_b16 v[40:41], v2 offset:9216
  ds_read_b64_tr_b16 v[42:43], v2 offset:9984
  ds_read_b64_tr_b16 v[44:45], v48 offset:9216
  ds_read_b64_tr_b16 v[46:47], v48 offset:9984
  s_waitcnt lgkmcnt(8)
  v_mfma_f32_32x32x16_bf16 v[208:223], v[24:27], v[176:179], v[208:223]
  v_mfma_f32_32x32x16_bf16 v[224:239], v[28:31], v[176:179], v[224:239]
  ds_read_b64_tr_b16 v[16:17], v2 offset:12288
  ds_read_b64_tr_b16 v[18:19], v2 offset:13056
  ds_read_b64_tr_b16 v[20:21], v48 offset:12288
  ds_read_b64_tr_b16 v[22:23], v48 offset:13056
  s_waitcnt lgkmcnt(8)
  v_mfma_f32_32x32x16_bf16 v[208:223], v[32:35], v[180:183], v[208:223]
  v_mfma_f32_32x32x16_bf16 v[224:239], v[36:39], v[180:183], v[224:239]
  ds_read_b64_tr_b16 v[24:25], v2 offset:15360
  ds_read_b64_tr_b16 v[26:27], v2 offset:16128
  ds_read_b64_tr_b16 v[28:29], v48 offset:15360
  ds_read_b64_tr_b16 v[30:31], v48 offset:16128
  s_waitcnt lgkmcnt(8)
  v_mfma_f32_32x32x16_bf16 v[208:223], v[40:43], v[184:187], v[208:223]
  v_mfma_f32_32x32x16_bf16 v[224:239], v[44:47], v[184:187], v[224:239]
  ds_read_b64_tr_b16 v[32:33], v2 offset:18432
  ds_read_b64_tr_b16 v[34:35], v2 offset:19200
  ds_read_b64_tr_b16 v[36:37], v48 offset:18432
  ds_read_b64_tr_b16 v[38:39], v48 offset:19200
  s_waitcnt lgkmcnt(8)
  v_mfma_f32_32x32x16_bf16 v[208:223], v[16:19], v[188:191], v[208:223]
  v_mfma_f32_32x32x16_bf16 v[224:239], v[20:23], v[188:191], v[224:239]
  ds_read_b64_tr_b16 v[40:41], v2 offset:21504
  ds_read_b64_tr_b16 v[42:43], v2 offset:22272
  ds_read_b64_tr_b16 v[44:45], v48 offset:21504
  ds_read_b64_tr_b16 v[46:47], v48 offset:22272
  s_waitcnt lgkmcnt(8)
  v_mfma_f32_32x32x16_bf16 v[208:223], v[24:27], v[192:195], v[208:223]
  v_mfma_f32_32x32x16_bf16 v[224:239], v[28:31], v[192:195], v[224:239]
  ds_read_b64_tr_b16 v[16:17], v2 offset:24576
  ds_read_b64_tr_b16 v[18:19], v2 offset:25344
  ds_read_b64_tr_b16 v[20:21], v48 offset:24576
  ds_read_b64_tr_b16 v[22:23], v48 offset:25344
  s_waitcnt lgkmcnt(8)
  v_mfma_f32_32x32x16_bf16 v[208:223], v[32:35], v[196:199], v[208:223]
  v_mfma_f32_32x32x16_bf16 v[224:239], v[36:39], v[196:199], v[224:239]
  s_waitcnt lgkmcnt(4)
  v_mfma_f32_32x32x16_bf16 v[208:223], v[40:43], v[200:203], v[208:223]
  v_mfma_f32_32x32x16_bf16 v[224:239], v[44:47], v[200:203], v[224:239]
  s_waitcnt lgkmcnt(0)
  v_mfma_f32_32x32x16_bf16 v[208:223], v[16:19], v[204:207], v[208:223]
  v_mfma_f32_32x32x16_bf16 v[224:239], v[20:23], v[204:207], v[224:239]
  s_waitcnt lgkmcnt(0)
  s_mov_b64 exec, 1
  ds_add_u32 v14, v15 offset:44
  s_mov_b64 exec, -1

  v_lshlrev_b32 v2, 4, v1
  v_lshlrev_b32 v3, 2, v1
  v_mov_b32 v11, 161088
  v_mov_b32 v12, 1
  v_lshrrev_b32 v15, 5, v1
  v_cmp_eq_u32 s[40:41], 0, v15
  s_mov_b32 s44, 0x3eae1a93
  s_mov_b32 s45, 0x3eae1a93

  s_mov_b32 s20, s62
  s_and_b32 s21, s63, 0xffff
  s_mov_b32 s22, 268435456
  s_mov_b32 s23, 0x00020000

  s_cmp_lg_u32 s30, 3
  s_cbranch_scc1 A_KVW
  s_mov_b32 s39, 0x10000
A_KVP:
  global_load_dword v13, v3, s[60:61] sc1
  s_waitcnt vmcnt(0)
  v_cmp_eq_u32 vcc, 0, v13
  s_nop 1
  s_cmp_eq_u64 vcc, 0
  s_cbranch_scc1 A_KVD
  s_sleep 2
  s_sub_u32 s39, s39, 1
  s_cmp_lg_u32 s39, 0
  s_cbranch_scc1 A_KVP

A_KVD:
  s_mov_b64 exec, 1
  ds_write_b32 v11, v13 offset:36
  ds_add_u32 v11, v12 offset:56
  s_mov_b64 exec, -1

A_KVW:
  s_mov_b32 s39, 0x40000
WAITC_51:
  ds_read_b32 v13, v11 offset:56
  s_waitcnt lgkmcnt(0)
  v_readfirstlane_b32 s38, v13
  s_cmp_ge_u32 s38, 1
  s_cbranch_scc1 WAITD_52
  s_sleep 1
  s_sub_u32 s39, s39, 1
  s_cmp_lg_u32 s39, 0
  s_cbranch_scc1 WAITC_51

WAITD_52:
  ds_read_b32 v250, v11 offset:36
  s_mov_b32 s36, 262144
  buffer_load_dword v249, v3, s[20:23], s36 offen sc1
  s_lshl_b32 s33, s32, 17
  s_add_u32 s33, s33, 0

  buffer_load_dwordx4 v[16:19], v2, s[20:23], s33 offen sc1
  buffer_load_dword v28, v3, s[20:23], s33 offen offset:3072 sc1
  buffer_load_dwordx4 v[20:23], v2, s[20:23], s33 offen offset:1024 sc1
  buffer_load_dwordx4 v[24:27], v2, s[20:23], s33 offen offset:2048 sc1
  s_add_u32 s33, s33, 4096

  buffer_load_dwordx4 v[32:35], v2, s[20:23], s33 offen sc1
  buffer_load_dword v44, v3, s[20:23], s33 offen offset:3072 sc1
  buffer_load_dwordx4 v[36:39], v2, s[20:23], s33 offen offset:1024 sc1
  buffer_load_dwordx4 v[40:43], v2, s[20:23], s33 offen offset:2048 sc1
  s_add_u32 s33, s33, 4096

  buffer_load_dwordx4 v[48:51], v2, s[20:23], s33 offen sc1
  buffer_load_dword v60, v3, s[20:23], s33 offen offset:3072 sc1
  buffer_load_dwordx4 v[52:55], v2, s[20:23], s33 offen offset:1024 sc1
  buffer_load_dwordx4 v[56:59], v2, s[20:23], s33 offen offset:2048 sc1
  s_add_u32 s33, s33, 4096

  v_pk_mul_f32 v[208:209], v[208:209], s[44:45]
  v_pk_mul_f32 v[224:225], v[224:225], s[44:45]
  v_pk_mul_f32 v[210:211], v[210:211], s[44:45]
  v_pk_mul_f32 v[226:227], v[226:227], s[44:45]
  v_pk_mul_f32 v[212:213], v[212:213], s[44:45]
  v_pk_mul_f32 v[228:229], v[228:229], s[44:45]
  v_pk_mul_f32 v[214:215], v[214:215], s[44:45]
  v_pk_mul_f32 v[230:231], v[230:231], s[44:45]
  v_pk_mul_f32 v[216:217], v[216:217], s[44:45]
  v_pk_mul_f32 v[232:233], v[232:233], s[44:45]
  v_pk_mul_f32 v[218:219], v[218:219], s[44:45]
  v_pk_mul_f32 v[234:235], v[234:235], s[44:45]
  v_cvt_pk_bf16_f32 v80, v208, v209
  v_cvt_pk_bf16_f32 v81, v210, v211
  v_cvt_pk_bf16_f32 v82, v212, v213
  v_cvt_pk_bf16_f32 v83, v214, v215
  v_cvt_pk_bf16_f32 v84, v216, v217
  v_cvt_pk_bf16_f32 v240, v224, v225
  v_cvt_pk_bf16_f32 v241, v226, v227
  v_cvt_pk_bf16_f32 v242, v228, v229
  v_cvt_pk_bf16_f32 v243, v230, v231
  v_cvt_pk_bf16_f32 v244, v232, v233
  v_cvt_pk_bf16_f32 v245, v234, v235
  v_mov_b32 v86, v241
  v_mov_b32 v88, v243
  v_mov_b32 v90, v245
  v_mov_b32 v248, v242
  s_nop 0
  v_permlane32_swap_b32 v240, v242
  s_nop 1
  v_cndmask_b32 v87, v240, v242, s[40:41]
  v_permlane32_swap_b32 v248, v244
  s_nop 1
  v_cndmask_b32 v89, v248, v244, s[40:41]
  v_cndmask_b32 v84, 0, v84, s[40:41]
  v_cndmask_b32 v90, 0, v90, s[40:41]
  s_mul_i32 s35, s30, 2560
  s_add_u32 s35, s35, 148608
  v_add_u32 v5, s35, v2
  v_add_u32 v6, s35, v3
  ds_write_b128 v5, v[80:83]
  ds_write_b32 v6, v84 offset:1024
  ds_write_b128 v5, v[86:89] offset:1280
  ds_write_b32 v6, v90 offset:2304
  s_xor_b32 s36, s30, 2
  s_mul_i32 s36, s36, 2560
  s_add_u32 s36, s36, 148608
  v_add_u32 v5, s36, v2
  v_add_u32 v6, s36, v3

  s_waitcnt lgkmcnt(0)
  s_mov_b64 exec, 1
  ds_add_u32 v11, v12 offset:48
  s_mov_b64 exec, -1

  v_mov_b32 v208, 0
  v_dot2_f32_bf16 v208, v80, v80, v208
  v_dot2_f32_bf16 v208, v81, v81, v208
  v_dot2_f32_bf16 v208, v82, v82, v208
  v_dot2_f32_bf16 v208, v83, v83, v208
  v_dot2_f32_bf16 v208, v84, v84, v208
  s_nop 3
  v_mov_b32 v4, v208
  s_nop 1
  v_permlane32_swap_b32 v208, v4
  s_nop 1
  v_add_f32 v208, v208, v4

  v_mov_b32 v209, 0
  v_dot2_f32_bf16 v209, v86, v86, v209
  v_dot2_f32_bf16 v209, v87, v87, v209
  v_dot2_f32_bf16 v209, v88, v88, v209
  v_dot2_f32_bf16 v209, v89, v89, v209
  v_dot2_f32_bf16 v209, v90, v90, v209
  s_nop 3
  v_mov_b32 v4, v209
  s_nop 1
  v_permlane32_swap_b32 v209, v4
  s_nop 1
  v_add_f32 v209, v209, v4

  s_mov_b32 s39, 0x40000
WAITC_53:
  ds_read_b32 v13, v11 offset:48
  s_waitcnt lgkmcnt(0)
  v_readfirstlane_b32 s38, v13
  s_cmp_ge_u32 s38, 4
  s_cbranch_scc1 WAITD_54
  s_sleep 1
  s_sub_u32 s39, s39, 1
  s_cmp_lg_u32 s39, 0
  s_cbranch_scc1 WAITC_53

WAITD_54:
  ds_read_b128 v[92:95], v5
  ds_read_b32 v96, v6 offset:1024
  ds_read_b128 v[98:101], v5 offset:1280
  ds_read_b32 v102, v6 offset:2304
  v_mov_b32 v14, 0x00003f80

  v_cndmask_b32 v29, 0, v14, s[40:41]
  v_cndmask_b32 v45, 0, v14, s[40:41]
  v_cndmask_b32 v61, 0, v14, s[40:41]
  v_cndmask_b32 v77, 0, v14, s[40:41]
  s_waitcnt lgkmcnt(0)
  v_mov_b32 v210, 0
  v_dot2_f32_bf16 v210, v92, v92, v210
  v_dot2_f32_bf16 v210, v93, v93, v210
  v_dot2_f32_bf16 v210, v94, v94, v210
  v_dot2_f32_bf16 v210, v95, v95, v210
  v_dot2_f32_bf16 v210, v96, v96, v210
  s_nop 3
  v_mov_b32 v4, v210
  s_nop 1
  v_permlane32_swap_b32 v210, v4
  s_nop 1
  v_add_f32 v210, v210, v4

  v_mov_b32 v211, 0
  v_dot2_f32_bf16 v211, v98, v98, v211
  v_dot2_f32_bf16 v211, v99, v99, v211
  v_dot2_f32_bf16 v211, v100, v100, v211
  v_dot2_f32_bf16 v211, v101, v101, v211
  v_dot2_f32_bf16 v211, v102, v102, v211
  s_nop 3
  v_mov_b32 v4, v211
  s_nop 1
  v_permlane32_swap_b32 v211, v4
  s_nop 1
  v_add_f32 v211, v211, v4

  v_sqrt_f32 v208, v208
  v_sqrt_f32 v209, v209
  v_sqrt_f32 v210, v210
  v_sqrt_f32 v211, v211
  v_and_b32 v8, 31, v1
  v_lshlrev_b32 v8, 2, v8
  s_lshl_b32 s35, s31, 7
  s_add_u32 s35, s35, 162352
  v_add_u32 v213, s35, v8
  s_waitcnt vmcnt(12) lgkmcnt(0)
  v_readfirstlane_b32 s47, v250
  v_mov_b32 v13, v249
  s_nop 1

  v_max_f32_dpp v13, v13, v13 quad_perm:[1,0,3,2] row_mask:0xf bank_mask:0xf
  s_nop 1
  v_max_f32_dpp v13, v13, v13 quad_perm:[2,3,0,1] row_mask:0xf bank_mask:0xf
  s_nop 1
  v_max_f32_dpp v13, v13, v13 row_ror:4 row_mask:0xf bank_mask:0xf
  s_nop 1
  v_max_f32_dpp v13, v13, v13 row_ror:8 row_mask:0xf bank_mask:0xf
  s_nop 1
  ds_swizzle_b32 v14, v13 offset:16415
  s_waitcnt lgkmcnt(0)
  v_max_f32 v13, v13, v14
  v_mov_b32 v14, v13
  s_nop 1
  v_permlane32_swap_b32 v13, v14
  s_nop 1
  v_max_f32 v13, v13, v14
  v_sqrt_f32 v13, v13
  s_nop 0
  v_mul_f32 v13, 0x3f820000, v13

  v_mul_f32 v7, v208, v13
  v_sub_f32 v7, 0, v7
  v_and_b32 v4, 0xffff0000, v7
  v_sub_f32 v5, v7, v4
  v_and_b32 v6, 0xffff0000, v5
  v_sub_f32 v5, v5, v6
  v_lshrrev_b32 v5, 16, v5
  v_lshrrev_b32 v4, 16, v4
  v_or_b32 v4, v4, v6
  v_cndmask_b32 v84, v4, v84, s[40:41]
  v_cndmask_b32 v85, 0, v5, s[40:41]

  v_mul_f32 v7, v209, v13
  v_sub_f32 v7, 0, v7
  v_and_b32 v4, 0xffff0000, v7
  v_sub_f32 v5, v7, v4
  v_and_b32 v6, 0xffff0000, v5
  v_sub_f32 v5, v5, v6
  v_lshrrev_b32 v5, 16, v5
  v_lshrrev_b32 v4, 16, v4
  v_or_b32 v4, v4, v6
  v_cndmask_b32 v90, v4, v90, s[40:41]
  v_cndmask_b32 v91, 0, v5, s[40:41]

  v_mul_f32 v7, v210, v13
  v_sub_f32 v7, 0, v7
  v_and_b32 v4, 0xffff0000, v7
  v_sub_f32 v5, v7, v4
  v_and_b32 v6, 0xffff0000, v5
  v_sub_f32 v5, v5, v6
  v_lshrrev_b32 v5, 16, v5
  v_lshrrev_b32 v4, 16, v4
  v_or_b32 v4, v4, v6
  v_cndmask_b32 v96, v4, v96, s[40:41]
  v_cndmask_b32 v97, 0, v5, s[40:41]

  v_mul_f32 v7, v211, v13
  v_sub_f32 v7, 0, v7
  v_and_b32 v4, 0xffff0000, v7
  v_sub_f32 v5, v7, v4
  v_and_b32 v6, 0xffff0000, v5
  v_sub_f32 v5, v5, v6
  v_lshrrev_b32 v5, 16, v5
  v_lshrrev_b32 v4, 16, v4
  v_or_b32 v4, v4, v6
  v_cndmask_b32 v102, v4, v102, s[40:41]
  v_cndmask_b32 v103, 0, v5, s[40:41]

  s_mov_b32 s46, 4
  s_load_dwordx2 s[56:57], s[0:1], 64
  s_load_dwordx2 s[58:59], s[0:1], 32
  s_load_dwordx2 s[42:43], s[0:1], 48
  s_waitcnt lgkmcnt(0)
  s_mul_i32 s35, s29, 1152
  s_add_u32 s42, s42, s35
  s_addc_u32 s43, s43, 0
  s_sub_u32 s36, 5308416, s35
  s_mul_i32 s35, s29, 663552
  s_add_u32 s56, s56, s35
  s_addc_u32 s57, s57, 0
  s_mul_i32 s35, s29, 82944
  s_add_u32 s58, s58, s35
  s_addc_u32 s59, s59, 0

  s_mov_b32 s24, s42
  s_and_b32 s25, s43, 0xffff
  s_mov_b32 s26, s36
  s_mov_b32 s27, 0x00020000

  s_mov_b32 s48, s56
  s_and_b32 s49, s57, 0xffff
  s_mov_b32 s50, 663552
  s_mov_b32 s51, 0x00020000

  s_mov_b32 s52, s58
  s_and_b32 s53, s59, 0xffff
  s_mov_b32 s54, 82944
  s_mov_b32 s55, 0x00020000

  s_and_b32 s35, s28, 15
  s_lshl_b32 s35, s35, 6
  s_mul_i32 s36, s30, 1024
  s_add_u32 s35, s35, s36
  s_mov_b32 s37, 477218589

  s_add_u32 s36, s35, 2048
  v_add_u32 v4, s36, v1
  v_min_u32 v4, 5183, v4
  v_mul_hi_u32 v5, v4, s37
  v_mul_u32_u24 v6, 9, v5
  v_sub_u32 v4, v4, v6
  v_mul_u32_u24 v5, 9216, v5
  v_lshl_add_u32 v221, v4, 7, v5

  s_and_b32 s35, s28, 15
  s_lshl_b32 s35, s35, 6
  v_add_u32 v215, s35, v1
  v_lshlrev_b32 v215, 7, v215
  s_mul_i32 s36, s30, 131072
  v_add_u32 v214, s36, v215

A_MAIN:
  v_mov_b32 v104, 0
  v_mov_b32 v105, 0
  v_mov_b32 v106, 0
  v_mov_b32 v107, 0
  v_mov_b32 v108, 0
  v_mov_b32 v109, 0
  v_mov_b32 v110, 0
  v_mov_b32 v111, 0
  v_mov_b32 v72, 0
  v_mov_b32 v73, 0
  v_mov_b32 v74, 0
  v_mov_b32 v75, 0
  s_nop 1
  v_mfma_f32_32x32x16_bf16 v[144:159], v[104:107], v[104:107], 0
  v_mfma_f32_32x32x16_bf16 v[160:175], v[104:107], v[104:107], 0
  v_mfma_f32_32x32x16_bf16 v[176:191], v[104:107], v[104:107], 0
  v_mfma_f32_32x32x16_bf16 v[192:207], v[104:107], v[104:107], 0
  s_waitcnt vmcnt(8)
  s_setprio 0
  v_mfma_f32_32x32x16_bf16 v[112:127], v[16:19], v[80:83], 0
  v_mfma_f32_32x32x8_bf16 v[112:127], v[28:29], v[84:85], v[112:127]
  s_mov_b32 s34, 8
  s_nop 15
.p2align 6
ATT_LOOP:
  s_setprio 1
  v_mfma_f32_32x32x16_bf16 v[128:143], v[16:19], v[86:89], 0
  v_exp_f32 v112, v112
  v_exp_f32 v113, v113
  v_exp_f32 v114, v114
  v_exp_f32 v115, v115
  v_cvt_pk_bf16_f32 v104, v112, v113
  v_cvt_pk_bf16_f32 v105, v114, v115
  v_mfma_f32_32x32x16_bf16 v[192:207], v[72:75], v[108:111], v[192:207]
  buffer_load_dwordx4 v[64:67], v2, s[20:23], s33 offen sc1
  buffer_load_dword v76, v3, s[20:23], s33 offen offset:3072 sc1
  buffer_load_dwordx4 v[68:71], v2, s[20:23], s33 offen offset:1024 sc1
  buffer_load_dwordx4 v[72:75], v2, s[20:23], s33 offen offset:2048 sc1
  s_add_u32 s33, s33, 4096

  v_exp_f32 v116, v116
  v_exp_f32 v117, v117
  v_exp_f32 v118, v118
  v_exp_f32 v119, v119
  v_cvt_pk_bf16_f32 v106, v116, v117
  v_cvt_pk_bf16_f32 v107, v118, v119
  v_mfma_f32_32x32x8_bf16 v[128:143], v[28:29], v[90:91], v[128:143]
  v_exp_f32 v120, v120
  v_exp_f32 v121, v121
  v_exp_f32 v122, v122
  v_exp_f32 v123, v123
  v_cvt_pk_bf16_f32 v108, v120, v121
  v_cvt_pk_bf16_f32 v109, v122, v123
  v_mfma_f32_32x32x16_bf16 v[144:159], v[20:23], v[104:107], v[144:159]
  v_exp_f32 v124, v124
  v_exp_f32 v125, v125
  v_exp_f32 v126, v126
  v_exp_f32 v127, v127
  v_cvt_pk_bf16_f32 v110, v124, v125
  v_cvt_pk_bf16_f32 v111, v126, v127
  v_mfma_f32_32x32x16_bf16 v[112:127], v[16:19], v[92:95], 0
  v_exp_f32 v128, v128
  v_exp_f32 v129, v129
  v_exp_f32 v130, v130
  v_exp_f32 v131, v131
  v_cvt_pk_bf16_f32 v104, v128, v129
  v_cvt_pk_bf16_f32 v105, v130, v131
  v_mfma_f32_32x32x16_bf16 v[144:159], v[24:27], v[108:111], v[144:159]
  s_cmp_lg_u32 s30, 0
  s_cbranch_scc1 PFX_55
  s_cmp_lt_u32 s34, 6
  s_cbranch_scc1 PFX_55
  s_cmp_eq_u32 s34, 8
  s_cbranch_scc0 PFY_56
  buffer_load_dword v216, v221, s[24:27], 0 offen
  s_branch PFX_55

PFY_56:
  buffer_load_dword v216, v214, s[48:51], 0 offen
  v_add_u32 v214, 524288, v214

PFX_55:
  v_exp_f32 v132, v132
  v_exp_f32 v133, v133
  v_exp_f32 v134, v134
  v_exp_f32 v135, v135
  v_cvt_pk_bf16_f32 v106, v132, v133
  v_cvt_pk_bf16_f32 v107, v134, v135
  v_mfma_f32_32x32x8_bf16 v[112:127], v[28:29], v[96:97], v[112:127]
  v_exp_f32 v136, v136
  v_exp_f32 v137, v137
  v_exp_f32 v138, v138
  v_exp_f32 v139, v139
  v_cvt_pk_bf16_f32 v108, v136, v137
  v_cvt_pk_bf16_f32 v109, v138, v139
  v_mfma_f32_32x32x16_bf16 v[160:175], v[20:23], v[104:107], v[160:175]
  v_exp_f32 v140, v140
  v_exp_f32 v141, v141
  v_exp_f32 v142, v142
  v_exp_f32 v143, v143
  v_cvt_pk_bf16_f32 v110, v140, v141
  v_cvt_pk_bf16_f32 v111, v142, v143
  v_mfma_f32_32x32x16_bf16 v[128:143], v[16:19], v[98:101], 0
  v_exp_f32 v112, v112
  v_exp_f32 v113, v113
  v_exp_f32 v114, v114
  v_exp_f32 v115, v115
  v_cvt_pk_bf16_f32 v104, v112, v113
  v_cvt_pk_bf16_f32 v105, v114, v115
  v_mfma_f32_32x32x16_bf16 v[160:175], v[24:27], v[108:111], v[160:175]
  v_exp_f32 v116, v116
  v_exp_f32 v117, v117
  v_exp_f32 v118, v118
  v_exp_f32 v119, v119
  v_cvt_pk_bf16_f32 v106, v116, v117
  v_cvt_pk_bf16_f32 v107, v118, v119
  v_mfma_f32_32x32x8_bf16 v[128:143], v[28:29], v[102:103], v[128:143]
  v_exp_f32 v120, v120
  v_exp_f32 v121, v121
  v_exp_f32 v122, v122
  v_exp_f32 v123, v123
  v_cvt_pk_bf16_f32 v108, v120, v121
  v_cvt_pk_bf16_f32 v109, v122, v123
  v_mfma_f32_32x32x16_bf16 v[176:191], v[20:23], v[104:107], v[176:191]
  v_exp_f32 v124, v124
  v_exp_f32 v125, v125
  v_exp_f32 v126, v126
  v_exp_f32 v127, v127
  v_cvt_pk_bf16_f32 v110, v124, v125
  v_cvt_pk_bf16_f32 v111, v126, v127
  s_waitcnt vmcnt(8)
  v_mfma_f32_32x32x16_bf16 v[112:127], v[32:35], v[80:83], 0
  v_exp_f32 v128, v128
  v_exp_f32 v129, v129
  v_exp_f32 v130, v130
  v_exp_f32 v131, v131
  v_cvt_pk_bf16_f32 v104, v128, v129
  v_cvt_pk_bf16_f32 v105, v130, v131
  v_mfma_f32_32x32x16_bf16 v[176:191], v[24:27], v[108:111], v[176:191]
  v_exp_f32 v132, v132
  v_exp_f32 v133, v133
  v_exp_f32 v134, v134
  v_exp_f32 v135, v135
  v_cvt_pk_bf16_f32 v106, v132, v133
  v_cvt_pk_bf16_f32 v107, v134, v135
  v_mfma_f32_32x32x8_bf16 v[112:127], v[44:45], v[84:85], v[112:127]
  v_exp_f32 v136, v136
  v_exp_f32 v137, v137
  v_exp_f32 v138, v138
  v_exp_f32 v139, v139
  v_cvt_pk_bf16_f32 v108, v136, v137
  v_cvt_pk_bf16_f32 v109, v138, v139
  v_mfma_f32_32x32x16_bf16 v[192:207], v[20:23], v[104:107], v[192:207]
  v_exp_f32 v140, v140
  v_exp_f32 v141, v141
  v_exp_f32 v142, v142
  v_exp_f32 v143, v143
  v_cvt_pk_bf16_f32 v110, v140, v141
  v_cvt_pk_bf16_f32 v111, v142, v143
  v_mfma_f32_32x32x16_bf16 v[128:143], v[32:35], v[86:89], 0
  v_exp_f32 v112, v112
  v_exp_f32 v113, v113
  v_exp_f32 v114, v114
  v_exp_f32 v115, v115
  v_cvt_pk_bf16_f32 v104, v112, v113
  v_cvt_pk_bf16_f32 v105, v114, v115
  v_mfma_f32_32x32x16_bf16 v[192:207], v[24:27], v[108:111], v[192:207]
  buffer_load_dwordx4 v[16:19], v2, s[20:23], s33 offen sc1
  buffer_load_dword v28, v3, s[20:23], s33 offen offset:3072 sc1
  buffer_load_dwordx4 v[20:23], v2, s[20:23], s33 offen offset:1024 sc1
  buffer_load_dwordx4 v[24:27], v2, s[20:23], s33 offen offset:2048 sc1
  s_add_u32 s33, s33, 4096

  v_exp_f32 v116, v116
  v_exp_f32 v117, v117
  v_exp_f32 v118, v118
  v_exp_f32 v119, v119
  v_cvt_pk_bf16_f32 v106, v116, v117
  v_cvt_pk_bf16_f32 v107, v118, v119
  v_mfma_f32_32x32x8_bf16 v[128:143], v[44:45], v[90:91], v[128:143]
  v_exp_f32 v120, v120
  v_exp_f32 v121, v121
  v_exp_f32 v122, v122
  v_exp_f32 v123, v123
  v_cvt_pk_bf16_f32 v108, v120, v121
  v_cvt_pk_bf16_f32 v109, v122, v123
  v_mfma_f32_32x32x16_bf16 v[144:159], v[36:39], v[104:107], v[144:159]
  v_exp_f32 v124, v124
  v_exp_f32 v125, v125
  v_exp_f32 v126, v126
  v_exp_f32 v127, v127
  v_cvt_pk_bf16_f32 v110, v124, v125
  v_cvt_pk_bf16_f32 v111, v126, v127
  v_mfma_f32_32x32x16_bf16 v[112:127], v[32:35], v[92:95], 0
  v_exp_f32 v128, v128
  v_exp_f32 v129, v129
  v_exp_f32 v130, v130
  v_exp_f32 v131, v131
  v_cvt_pk_bf16_f32 v104, v128, v129
  v_cvt_pk_bf16_f32 v105, v130, v131
  v_mfma_f32_32x32x16_bf16 v[144:159], v[40:43], v[108:111], v[144:159]
  s_cmp_lg_u32 s30, 1
  s_cbranch_scc1 PFX_58
  s_cmp_lt_u32 s34, 6
  s_cbranch_scc1 PFX_58
  s_cmp_eq_u32 s34, 8
  s_cbranch_scc0 PFY_59
  buffer_load_dword v216, v221, s[24:27], 0 offen
  s_branch PFX_58

PFY_59:
  buffer_load_dword v216, v214, s[48:51], 0 offen
  v_add_u32 v214, 524288, v214

PFX_58:
  v_exp_f32 v132, v132
  v_exp_f32 v133, v133
  v_exp_f32 v134, v134
  v_exp_f32 v135, v135
  v_cvt_pk_bf16_f32 v106, v132, v133
  v_cvt_pk_bf16_f32 v107, v134, v135
  v_mfma_f32_32x32x8_bf16 v[112:127], v[44:45], v[96:97], v[112:127]
  v_exp_f32 v136, v136
  v_exp_f32 v137, v137
  v_exp_f32 v138, v138
  v_exp_f32 v139, v139
  v_cvt_pk_bf16_f32 v108, v136, v137
  v_cvt_pk_bf16_f32 v109, v138, v139
  v_mfma_f32_32x32x16_bf16 v[160:175], v[36:39], v[104:107], v[160:175]
  v_exp_f32 v140, v140
  v_exp_f32 v141, v141
  v_exp_f32 v142, v142
  v_exp_f32 v143, v143
  v_cvt_pk_bf16_f32 v110, v140, v141
  v_cvt_pk_bf16_f32 v111, v142, v143
  v_mfma_f32_32x32x16_bf16 v[128:143], v[32:35], v[98:101], 0
  v_exp_f32 v112, v112
  v_exp_f32 v113, v113
  v_exp_f32 v114, v114
  v_exp_f32 v115, v115
  v_cvt_pk_bf16_f32 v104, v112, v113
  v_cvt_pk_bf16_f32 v105, v114, v115
  v_mfma_f32_32x32x16_bf16 v[160:175], v[40:43], v[108:111], v[160:175]
  v_exp_f32 v116, v116
  v_exp_f32 v117, v117
  v_exp_f32 v118, v118
  v_exp_f32 v119, v119
  v_cvt_pk_bf16_f32 v106, v116, v117
  v_cvt_pk_bf16_f32 v107, v118, v119
  v_mfma_f32_32x32x8_bf16 v[128:143], v[44:45], v[102:103], v[128:143]
  v_exp_f32 v120, v120
  v_exp_f32 v121, v121
  v_exp_f32 v122, v122
  v_exp_f32 v123, v123
  v_cvt_pk_bf16_f32 v108, v120, v121
  v_cvt_pk_bf16_f32 v109, v122, v123
  v_mfma_f32_32x32x16_bf16 v[176:191], v[36:39], v[104:107], v[176:191]
  v_exp_f32 v124, v124
  v_exp_f32 v125, v125
  v_exp_f32 v126, v126
  v_exp_f32 v127, v127
  v_cvt_pk_bf16_f32 v110, v124, v125
  v_cvt_pk_bf16_f32 v111, v126, v127
  s_setprio 0
  s_waitcnt vmcnt(8)
  v_mfma_f32_32x32x16_bf16 v[112:127], v[48:51], v[80:83], 0
  v_exp_f32 v128, v128
  v_exp_f32 v129, v129
  v_exp_f32 v130, v130
  v_exp_f32 v131, v131
  v_cvt_pk_bf16_f32 v104, v128, v129
  v_cvt_pk_bf16_f32 v105, v130, v131
  v_mfma_f32_32x32x16_bf16 v[176:191], v[40:43], v[108:111], v[176:191]
  v_exp_f32 v132, v132
  v_exp_f32 v133, v133
  v_exp_f32 v134, v134
  v_exp_f32 v135, v135
  v_cvt_pk_bf16_f32 v106, v132, v133
  v_cvt_pk_bf16_f32 v107, v134, v135
  v_mfma_f32_32x32x8_bf16 v[112:127], v[60:61], v[84:85], v[112:127]
  v_exp_f32 v136, v136
  v_exp_f32 v137, v137
  v_exp_f32 v138, v138
  v_exp_f32 v139, v139
  v_cvt_pk_bf16_f32 v108, v136, v137
  v_cvt_pk_bf16_f32 v109, v138, v139
  v_mfma_f32_32x32x16_bf16 v[192:207], v[36:39], v[104:107], v[192:207]
  v_exp_f32 v140, v140
  v_exp_f32 v141, v141
  v_exp_f32 v142, v142
  v_exp_f32 v143, v143
  v_cvt_pk_bf16_f32 v110, v140, v141
  v_cvt_pk_bf16_f32 v111, v142, v143
  s_setprio 1
  v_mfma_f32_32x32x16_bf16 v[128:143], v[48:51], v[86:89], 0
  v_exp_f32 v112, v112
  v_exp_f32 v113, v113
  v_exp_f32 v114, v114
  v_exp_f32 v115, v115
  v_cvt_pk_bf16_f32 v104, v112, v113
  v_cvt_pk_bf16_f32 v105, v114, v115
  v_mfma_f32_32x32x16_bf16 v[192:207], v[40:43], v[108:111], v[192:207]
  buffer_load_dwordx4 v[32:35], v2, s[20:23], s33 offen sc1
  buffer_load_dword v44, v3, s[20:23], s33 offen offset:3072 sc1
  buffer_load_dwordx4 v[36:39], v2, s[20:23], s33 offen offset:1024 sc1
  buffer_load_dwordx4 v[40:43], v2, s[20:23], s33 offen offset:2048 sc1
  s_add_u32 s33, s33, 4096

  v_exp_f32 v116, v116
  v_exp_f32 v117, v117
  v_exp_f32 v118, v118
  v_exp_f32 v119, v119
  v_cvt_pk_bf16_f32 v106, v116, v117
  v_cvt_pk_bf16_f32 v107, v118, v119
  v_mfma_f32_32x32x8_bf16 v[128:143], v[60:61], v[90:91], v[128:143]
  v_exp_f32 v120, v120
  v_exp_f32 v121, v121
  v_exp_f32 v122, v122
  v_exp_f32 v123, v123
  v_cvt_pk_bf16_f32 v108, v120, v121
  v_cvt_pk_bf16_f32 v109, v122, v123
  v_mfma_f32_32x32x16_bf16 v[144:159], v[52:55], v[104:107], v[144:159]
  v_exp_f32 v124, v124
  v_exp_f32 v125, v125
  v_exp_f32 v126, v126
  v_exp_f32 v127, v127
  v_cvt_pk_bf16_f32 v110, v124, v125
  v_cvt_pk_bf16_f32 v111, v126, v127
  v_mfma_f32_32x32x16_bf16 v[112:127], v[48:51], v[92:95], 0
  v_exp_f32 v128, v128
  v_exp_f32 v129, v129
  v_exp_f32 v130, v130
  v_exp_f32 v131, v131
  v_cvt_pk_bf16_f32 v104, v128, v129
  v_cvt_pk_bf16_f32 v105, v130, v131
  v_mfma_f32_32x32x16_bf16 v[144:159], v[56:59], v[108:111], v[144:159]
  s_cmp_lg_u32 s30, 2
  s_cbranch_scc1 PFX_61
  s_cmp_lt_u32 s34, 6
  s_cbranch_scc1 PFX_61
  s_cmp_eq_u32 s34, 8
  s_cbranch_scc0 PFY_62
  buffer_load_dword v216, v221, s[24:27], 0 offen
  s_branch PFX_61

PFY_62:
  s_cmp_eq_u32 s34, 6
  s_cbranch_scc0 PFZ_63
  buffer_load_dword v216, v215, s[52:55], 0 offen
  s_branch PFX_61

PFZ_63:
  buffer_load_dword v216, v214, s[48:51], 0 offen
  v_add_u32 v214, 524288, v214

PFX_61:
  v_exp_f32 v132, v132
  v_exp_f32 v133, v133
  v_exp_f32 v134, v134
  v_exp_f32 v135, v135
  v_cvt_pk_bf16_f32 v106, v132, v133
  v_cvt_pk_bf16_f32 v107, v134, v135
  v_mfma_f32_32x32x8_bf16 v[112:127], v[60:61], v[96:97], v[112:127]
  v_exp_f32 v136, v136
  v_exp_f32 v137, v137
  v_exp_f32 v138, v138
  v_exp_f32 v139, v139
  v_cvt_pk_bf16_f32 v108, v136, v137
  v_cvt_pk_bf16_f32 v109, v138, v139
  v_mfma_f32_32x32x16_bf16 v[160:175], v[52:55], v[104:107], v[160:175]
  v_exp_f32 v140, v140
  v_exp_f32 v141, v141
  v_exp_f32 v142, v142
  v_exp_f32 v143, v143
  v_cvt_pk_bf16_f32 v110, v140, v141
  v_cvt_pk_bf16_f32 v111, v142, v143
  v_mfma_f32_32x32x16_bf16 v[128:143], v[48:51], v[98:101], 0
  v_exp_f32 v112, v112
  v_exp_f32 v113, v113
  v_exp_f32 v114, v114
  v_exp_f32 v115, v115
  v_cvt_pk_bf16_f32 v104, v112, v113
  v_cvt_pk_bf16_f32 v105, v114, v115
  v_mfma_f32_32x32x16_bf16 v[160:175], v[56:59], v[108:111], v[160:175]
  v_exp_f32 v116, v116
  v_exp_f32 v117, v117
  v_exp_f32 v118, v118
  v_exp_f32 v119, v119
  v_cvt_pk_bf16_f32 v106, v116, v117
  v_cvt_pk_bf16_f32 v107, v118, v119
  v_mfma_f32_32x32x8_bf16 v[128:143], v[60:61], v[102:103], v[128:143]
  v_exp_f32 v120, v120
  v_exp_f32 v121, v121
  v_exp_f32 v122, v122
  v_exp_f32 v123, v123
  v_cvt_pk_bf16_f32 v108, v120, v121
  v_cvt_pk_bf16_f32 v109, v122, v123
  v_mfma_f32_32x32x16_bf16 v[176:191], v[52:55], v[104:107], v[176:191]
  v_exp_f32 v124, v124
  v_exp_f32 v125, v125
  v_exp_f32 v126, v126
  v_exp_f32 v127, v127
  v_cvt_pk_bf16_f32 v110, v124, v125
  v_cvt_pk_bf16_f32 v111, v126, v127
  s_waitcnt vmcnt(8)
  v_mfma_f32_32x32x16_bf16 v[112:127], v[64:67], v[80:83], 0
  v_exp_f32 v128, v128
  v_exp_f32 v129, v129
  v_exp_f32 v130, v130
  v_exp_f32 v131, v131
  v_cvt_pk_bf16_f32 v104, v128, v129
  v_cvt_pk_bf16_f32 v105, v130, v131
  v_mfma_f32_32x32x16_bf16 v[176:191], v[56:59], v[108:111], v[176:191]
  v_exp_f32 v132, v132
  v_exp_f32 v133, v133
  v_exp_f32 v134, v134
  v_exp_f32 v135, v135
  v_cvt_pk_bf16_f32 v106, v132, v133
  v_cvt_pk_bf16_f32 v107, v134, v135
  v_mfma_f32_32x32x8_bf16 v[112:127], v[76:77], v[84:85], v[112:127]
  v_exp_f32 v136, v136
  v_exp_f32 v137, v137
  v_exp_f32 v138, v138
  v_exp_f32 v139, v139
  v_cvt_pk_bf16_f32 v108, v136, v137
  v_cvt_pk_bf16_f32 v109, v138, v139
  v_mfma_f32_32x32x16_bf16 v[192:207], v[52:55], v[104:107], v[192:207]
  v_exp_f32 v140, v140
  v_exp_f32 v141, v141
  v_exp_f32 v142, v142
  v_exp_f32 v143, v143
  v_cvt_pk_bf16_f32 v110, v140, v141
  v_cvt_pk_bf16_f32 v111, v142, v143
  v_mfma_f32_32x32x16_bf16 v[128:143], v[64:67], v[86:89], 0
  v_exp_f32 v112, v112
  v_exp_f32 v113, v113
  v_exp_f32 v114, v114
  v_exp_f32 v115, v115
  v_cvt_pk_bf16_f32 v104, v112, v113
  v_cvt_pk_bf16_f32 v105, v114, v115
  v_mfma_f32_32x32x16_bf16 v[192:207], v[56:59], v[108:111], v[192:207]
  buffer_load_dwordx4 v[48:51], v2, s[20:23], s33 offen sc1
  buffer_load_dword v60, v3, s[20:23], s33 offen offset:3072 sc1
  buffer_load_dwordx4 v[52:55], v2, s[20:23], s33 offen offset:1024 sc1
  buffer_load_dwordx4 v[56:59], v2, s[20:23], s33 offen offset:2048 sc1
  s_add_u32 s33, s33, 4096

  v_exp_f32 v116, v116
  v_exp_f32 v117, v117
  v_exp_f32 v118, v118
  v_exp_f32 v119, v119
  v_cvt_pk_bf16_f32 v106, v116, v117
  v_cvt_pk_bf16_f32 v107, v118, v119
  v_mfma_f32_32x32x8_bf16 v[128:143], v[76:77], v[90:91], v[128:143]
  v_exp_f32 v120, v120
  v_exp_f32 v121, v121
  v_exp_f32 v122, v122
  v_exp_f32 v123, v123
  v_cvt_pk_bf16_f32 v108, v120, v121
  v_cvt_pk_bf16_f32 v109, v122, v123
  v_mfma_f32_32x32x16_bf16 v[144:159], v[68:71], v[104:107], v[144:159]
  v_exp_f32 v124, v124
  v_exp_f32 v125, v125
  v_exp_f32 v126, v126
  v_exp_f32 v127, v127
  v_cvt_pk_bf16_f32 v110, v124, v125
  v_cvt_pk_bf16_f32 v111, v126, v127
  v_mfma_f32_32x32x16_bf16 v[112:127], v[64:67], v[92:95], 0
  v_exp_f32 v128, v128
  v_exp_f32 v129, v129
  v_exp_f32 v130, v130
  v_exp_f32 v131, v131
  v_cvt_pk_bf16_f32 v104, v128, v129
  v_cvt_pk_bf16_f32 v105, v130, v131
  v_mfma_f32_32x32x16_bf16 v[144:159], v[72:75], v[108:111], v[144:159]
  s_cmp_lg_u32 s30, 3
  s_cbranch_scc1 PFX_64
  s_cmp_lt_u32 s34, 6
  s_cbranch_scc1 PFX_64
  s_cmp_eq_u32 s34, 8
  s_cbranch_scc0 PFY_65
  buffer_load_dword v216, v221, s[24:27], 0 offen
  s_branch PFX_64

PFY_65:
  buffer_load_dword v216, v214, s[48:51], 0 offen
  v_add_u32 v214, 524288, v214

PFX_64:
  v_exp_f32 v132, v132
  v_exp_f32 v133, v133
  v_exp_f32 v134, v134
  v_exp_f32 v135, v135
  v_cvt_pk_bf16_f32 v106, v132, v133
  v_cvt_pk_bf16_f32 v107, v134, v135
  v_mfma_f32_32x32x8_bf16 v[112:127], v[76:77], v[96:97], v[112:127]
  v_exp_f32 v136, v136
  v_exp_f32 v137, v137
  v_exp_f32 v138, v138
  v_exp_f32 v139, v139
  v_cvt_pk_bf16_f32 v108, v136, v137
  v_cvt_pk_bf16_f32 v109, v138, v139
  v_mfma_f32_32x32x16_bf16 v[160:175], v[68:71], v[104:107], v[160:175]
  v_exp_f32 v140, v140
  v_exp_f32 v141, v141
  v_exp_f32 v142, v142
  v_exp_f32 v143, v143
  v_cvt_pk_bf16_f32 v110, v140, v141
  v_cvt_pk_bf16_f32 v111, v142, v143
  v_mfma_f32_32x32x16_bf16 v[128:143], v[64:67], v[98:101], 0
  v_exp_f32 v112, v112
  v_exp_f32 v113, v113
  v_exp_f32 v114, v114
  v_exp_f32 v115, v115
  v_cvt_pk_bf16_f32 v104, v112, v113
  v_cvt_pk_bf16_f32 v105, v114, v115
  v_mfma_f32_32x32x16_bf16 v[160:175], v[72:75], v[108:111], v[160:175]
  v_exp_f32 v116, v116
  v_exp_f32 v117, v117
  v_exp_f32 v118, v118
  v_exp_f32 v119, v119
  v_cvt_pk_bf16_f32 v106, v116, v117
  v_cvt_pk_bf16_f32 v107, v118, v119
  v_mfma_f32_32x32x8_bf16 v[128:143], v[76:77], v[102:103], v[128:143]
  v_exp_f32 v120, v120
  v_exp_f32 v121, v121
  v_exp_f32 v122, v122
  v_exp_f32 v123, v123
  v_cvt_pk_bf16_f32 v108, v120, v121
  v_cvt_pk_bf16_f32 v109, v122, v123
  v_mfma_f32_32x32x16_bf16 v[176:191], v[68:71], v[104:107], v[176:191]
  v_exp_f32 v124, v124
  v_exp_f32 v125, v125
  v_exp_f32 v126, v126
  v_exp_f32 v127, v127
  v_cvt_pk_bf16_f32 v110, v124, v125
  v_cvt_pk_bf16_f32 v111, v126, v127
  s_setprio 0
  s_waitcnt vmcnt(8)
  v_mfma_f32_32x32x16_bf16 v[112:127], v[16:19], v[80:83], 0
  v_exp_f32 v128, v128
  v_exp_f32 v129, v129
  v_exp_f32 v130, v130
  v_exp_f32 v131, v131
  v_cvt_pk_bf16_f32 v104, v128, v129
  v_cvt_pk_bf16_f32 v105, v130, v131
  v_mfma_f32_32x32x16_bf16 v[176:191], v[72:75], v[108:111], v[176:191]
  v_exp_f32 v132, v132
  v_exp_f32 v133, v133
  v_exp_f32 v134, v134
  v_exp_f32 v135, v135
  v_cvt_pk_bf16_f32 v106, v132, v133
  v_cvt_pk_bf16_f32 v107, v134, v135
  v_mfma_f32_32x32x8_bf16 v[112:127], v[28:29], v[84:85], v[112:127]
  v_exp_f32 v136, v136
  v_exp_f32 v137, v137
  v_exp_f32 v138, v138
  v_exp_f32 v139, v139
  v_cvt_pk_bf16_f32 v108, v136, v137
  v_cvt_pk_bf16_f32 v109, v138, v139
  v_mfma_f32_32x32x16_bf16 v[192:207], v[68:71], v[104:107], v[192:207]
  v_exp_f32 v140, v140
  v_exp_f32 v141, v141
  v_exp_f32 v142, v142
  v_exp_f32 v143, v143
  v_cvt_pk_bf16_f32 v110, v140, v141
  v_cvt_pk_bf16_f32 v111, v142, v143
  s_sub_u32 s34, s34, 1
  s_cmp_lg_u32 s34, 0
  s_cbranch_scc1 ATT_LOOP

  s_nop 1
  v_mfma_f32_32x32x16_bf16 v[192:207], v[72:75], v[108:111], v[192:207]
  ds_read_b32 v212, v213
  s_nop 15
  s_setprio 0
  v_min_f32 v4, v154, v170
  v_min_f32 v5, v186, v202
  v_min_f32 v4, v4, v5
  v_mov_b32 v5, 0x12800000
  v_cmp_nge_f32 vcc, v4, v5
  s_nop 1
  s_and_b64 vcc, vcc, s[40:41]
  s_cmp_eq_u64 vcc, 0
  s_cbranch_scc1 A_CHKOK

  s_mov_b64 exec, 1
  ds_add_u32 v11, v12 offset:28
  s_mov_b64 exec, -1

A_CHKOK:
  s_mov_b32 s39, 0x40000
WAITC_67:
  ds_read_b32 v13, v11 offset:12
  s_waitcnt lgkmcnt(0)
  v_readfirstlane_b32 s38, v13
  s_cmp_ge_u32 s38, 4
  s_cbranch_scc1 WAITD_68
  s_sleep 1
  s_sub_u32 s39, s39, 1
  s_cmp_lg_u32 s39, 0
  s_cbranch_scc1 WAITC_67

WAITD_68:
  s_mul_i32 s35, s30, 6144
  v_add_u32 v13, s35, v2
  s_xor_b32 s36, s30, 2
  s_mul_i32 s36, s36, 6144
  v_add_u32 v14, s36, v2

  ds_write_b128 v13, v[176:179] offset:0
  ds_write_b128 v13, v[180:183] offset:1024
  ds_write_b128 v13, v[184:187] offset:2048
  ds_write_b128 v13, v[192:195] offset:3072
  ds_write_b128 v13, v[196:199] offset:4096
  ds_write_b128 v13, v[200:203] offset:5120
  s_waitcnt lgkmcnt(0)
  s_mov_b64 exec, 1
  ds_add_u32 v11, v12 offset:16
  s_mov_b64 exec, -1

  s_mov_b32 s39, 0x40000
WAITC_69:
  ds_read_b32 v15, v11 offset:16
  s_waitcnt lgkmcnt(0)
  v_readfirstlane_b32 s38, v15
  s_cmp_ge_u32 s38, s46
  s_cbranch_scc1 WAITD_70
  s_sleep 1
  s_sub_u32 s39, s39, 1
  s_cmp_lg_u32 s39, 0
  s_cbranch_scc1 WAITC_69

WAITD_70:
  s_cmp_lg_u32 s46, 4
  s_cbranch_scc1 A_NOFB
  ds_read_b32 v15, v11 offset:28
  s_waitcnt lgkmcnt(0)
  v_readfirstlane_b32 s35, v15
  s_cmp_eq_u32 s35, 0
  s_cbranch_scc1 A_NOFB

  v_mov_b32 v208, 0xff800000
  v_cndmask_b32 v84, 0, v84, s[40:41]
  v_mov_b32 v85, 0
  v_mov_b32 v209, 0xff800000
  v_cndmask_b32 v90, 0, v90, s[40:41]
  v_mov_b32 v91, 0
  v_mov_b32 v210, 0xff800000
  v_cndmask_b32 v96, 0, v96, s[40:41]
  v_mov_b32 v97, 0
  v_mov_b32 v211, 0xff800000
  v_cndmask_b32 v102, 0, v102, s[40:41]
  v_mov_b32 v103, 0
  s_lshl_b32 s33, s32, 17
  s_add_u32 s33, s33, 0
  s_mov_b32 s34, 32

A_MAXL:
  buffer_load_dwordx4 v[16:19], v2, s[20:23], s33 offen sc1
  buffer_load_dword v28, v3, s[20:23], s33 offen offset:3072 sc1
  buffer_load_dwordx4 v[20:23], v2, s[20:23], s33 offen offset:1024 sc1
  buffer_load_dwordx4 v[24:27], v2, s[20:23], s33 offen offset:2048 sc1
  s_add_u32 s33, s33, 4096

  s_waitcnt vmcnt(0)
  v_mfma_f32_32x32x16_bf16 v[112:127], v[16:19], v[80:83], 0
  v_mfma_f32_32x32x8_bf16 v[112:127], v[28:29], v[84:85], v[112:127]
  s_nop 15
  s_nop 7
  v_max3_f32 v208, v112, v113, v208
  v_max3_f32 v208, v114, v115, v208
  v_max3_f32 v208, v116, v117, v208
  v_max3_f32 v208, v118, v119, v208
  v_max3_f32 v208, v120, v121, v208
  v_max3_f32 v208, v122, v123, v208
  v_max3_f32 v208, v124, v125, v208
  v_max3_f32 v208, v126, v127, v208
  v_mfma_f32_32x32x16_bf16 v[112:127], v[16:19], v[86:89], 0
  v_mfma_f32_32x32x8_bf16 v[112:127], v[28:29], v[90:91], v[112:127]
  s_nop 15
  s_nop 7
  v_max3_f32 v209, v112, v113, v209
  v_max3_f32 v209, v114, v115, v209
  v_max3_f32 v209, v116, v117, v209
  v_max3_f32 v209, v118, v119, v209
  v_max3_f32 v209, v120, v121, v209
  v_max3_f32 v209, v122, v123, v209
  v_max3_f32 v209, v124, v125, v209
  v_max3_f32 v209, v126, v127, v209
  v_mfma_f32_32x32x16_bf16 v[112:127], v[16:19], v[92:95], 0
  v_mfma_f32_32x32x8_bf16 v[112:127], v[28:29], v[96:97], v[112:127]
  s_nop 15
  s_nop 7
  v_max3_f32 v210, v112, v113, v210
  v_max3_f32 v210, v114, v115, v210
  v_max3_f32 v210, v116, v117, v210
  v_max3_f32 v210, v118, v119, v210
  v_max3_f32 v210, v120, v121, v210
  v_max3_f32 v210, v122, v123, v210
  v_max3_f32 v210, v124, v125, v210
  v_max3_f32 v210, v126, v127, v210
  v_mfma_f32_32x32x16_bf16 v[112:127], v[16:19], v[98:101], 0
  v_mfma_f32_32x32x8_bf16 v[112:127], v[28:29], v[102:103], v[112:127]
  s_nop 15
  s_nop 7
  v_max3_f32 v211, v112, v113, v211
  v_max3_f32 v211, v114, v115, v211
  v_max3_f32 v211, v116, v117, v211
  v_max3_f32 v211, v118, v119, v211
  v_max3_f32 v211, v120, v121, v211
  v_max3_f32 v211, v122, v123, v211
  v_max3_f32 v211, v124, v125, v211
  v_max3_f32 v211, v126, v127, v211
  s_sub_u32 s34, s34, 1
  s_cmp_lg_u32 s34, 0
  s_cbranch_scc1 A_MAXL

  v_mov_b32 v4, v208
  s_nop 1
  v_permlane32_swap_b32 v208, v4
  s_nop 1
  v_max_f32 v208, v208, v4

  v_mov_b32 v4, v209
  s_nop 1
  v_permlane32_swap_b32 v209, v4
  s_nop 1
  v_max_f32 v209, v209, v4

  v_mov_b32 v4, v210
  s_nop 1
  v_permlane32_swap_b32 v210, v4
  s_nop 1
  v_max_f32 v210, v210, v4

  v_mov_b32 v4, v211
  s_nop 1
  v_permlane32_swap_b32 v211, v4
  s_nop 1
  v_max_f32 v211, v211, v4

  s_mul_i32 s35, s30, 6144
  v_add_u32 v13, s35, v3
  s_xor_b32 s36, s30, 2
  s_mul_i32 s36, s36, 6144
  v_add_u32 v14, s36, v3

  ds_write_b32 v13, v208 offset:0
  ds_write_b32 v13, v209 offset:256
  ds_write_b32 v13, v210 offset:512
  ds_write_b32 v13, v211 offset:768
  s_waitcnt lgkmcnt(0)
  s_mov_b64 exec, 1
  ds_add_u32 v11, v12 offset:32
  s_mov_b64 exec, -1

  s_mov_b32 s39, 0x40000
WAITC_71:
  ds_read_b32 v15, v11 offset:32
  s_waitcnt lgkmcnt(0)
  v_readfirstlane_b32 s38, v15
  s_cmp_ge_u32 s38, 4
  s_cbranch_scc1 WAITD_72
  s_sleep 1
  s_sub_u32 s39, s39, 1
  s_cmp_lg_u32 s39, 0
  s_cbranch_scc1 WAITC_71

WAITD_72:
  ds_read_b32 v217, v14 offset:512
  ds_read_b32 v218, v14 offset:768
  ds_read_b32 v219, v14 offset:0
  ds_read_b32 v220, v14 offset:256
  s_waitcnt lgkmcnt(0)
  v_max_f32 v7, v208, v217
  v_sub_f32 v7, 0, v7
  v_and_b32 v4, 0xffff0000, v7
  v_sub_f32 v5, v7, v4
  v_and_b32 v6, 0xffff0000, v5
  v_sub_f32 v5, v5, v6
  v_lshrrev_b32 v5, 16, v5
  v_lshrrev_b32 v4, 16, v4
  v_or_b32 v4, v4, v6
  v_cndmask_b32 v84, v4, v84, s[40:41]
  v_cndmask_b32 v85, 0, v5, s[40:41]

  v_max_f32 v7, v209, v218
  v_sub_f32 v7, 0, v7
  v_and_b32 v4, 0xffff0000, v7
  v_sub_f32 v5, v7, v4
  v_and_b32 v6, 0xffff0000, v5
  v_sub_f32 v5, v5, v6
  v_lshrrev_b32 v5, 16, v5
  v_lshrrev_b32 v4, 16, v4
  v_or_b32 v4, v4, v6
  v_cndmask_b32 v90, v4, v90, s[40:41]
  v_cndmask_b32 v91, 0, v5, s[40:41]

  v_max_f32 v7, v210, v219
  v_sub_f32 v7, 0, v7
  v_and_b32 v4, 0xffff0000, v7
  v_sub_f32 v5, v7, v4
  v_and_b32 v6, 0xffff0000, v5
  v_sub_f32 v5, v5, v6
  v_lshrrev_b32 v5, 16, v5
  v_lshrrev_b32 v4, 16, v4
  v_or_b32 v4, v4, v6
  v_cndmask_b32 v96, v4, v96, s[40:41]
  v_cndmask_b32 v97, 0, v5, s[40:41]

  v_max_f32 v7, v211, v220
  v_sub_f32 v7, 0, v7
  v_and_b32 v4, 0xffff0000, v7
  v_sub_f32 v5, v7, v4
  v_and_b32 v6, 0xffff0000, v5
  v_sub_f32 v5, v5, v6
  v_lshrrev_b32 v5, 16, v5
  v_lshrrev_b32 v4, 16, v4
  v_or_b32 v4, v4, v6
  v_cndmask_b32 v102, v4, v102, s[40:41]
  v_cndmask_b32 v103, 0, v5, s[40:41]

  s_waitcnt lgkmcnt(0)
  s_mov_b64 exec, 1
  ds_add_u32 v11, v12 offset:32
  s_mov_b64 exec, -1

  s_mov_b32 s39, 0x40000
WAITC_73:
  ds_read_b32 v15, v11 offset:32
  s_waitcnt lgkmcnt(0)
  v_readfirstlane_b32 s38, v15
  s_cmp_ge_u32 s38, 8
  s_cbranch_scc1 WAITD_74
  s_sleep 1
  s_sub_u32 s39, s39, 1
  s_cmp_lg_u32 s39, 0
  s_cbranch_scc1 WAITC_73

WAITD_74:
  s_lshl_b32 s33, s32, 17
  s_add_u32 s33, s33, 0
  s_mov_b32 s46, 8

  buffer_load_dwordx4 v[16:19], v2, s[20:23], s33 offen sc1
  buffer_load_dword v28, v3, s[20:23], s33 offen offset:3072 sc1
  buffer_load_dwordx4 v[20:23], v2, s[20:23], s33 offen offset:1024 sc1
  buffer_load_dwordx4 v[24:27], v2, s[20:23], s33 offen offset:2048 sc1
  s_add_u32 s33, s33, 4096

  buffer_load_dwordx4 v[32:35], v2, s[20:23], s33 offen sc1
  buffer_load_dword v44, v3, s[20:23], s33 offen offset:3072 sc1
  buffer_load_dwordx4 v[36:39], v2, s[20:23], s33 offen offset:1024 sc1
  buffer_load_dwordx4 v[40:43], v2, s[20:23], s33 offen offset:2048 sc1
  s_add_u32 s33, s33, 4096

  buffer_load_dwordx4 v[48:51], v2, s[20:23], s33 offen sc1
  buffer_load_dword v60, v3, s[20:23], s33 offen offset:3072 sc1
  buffer_load_dwordx4 v[52:55], v2, s[20:23], s33 offen offset:1024 sc1
  buffer_load_dwordx4 v[56:59], v2, s[20:23], s33 offen offset:2048 sc1
  s_add_u32 s33, s33, 4096

  s_branch A_MAIN
A_NOFB:
  s_xor_b32 s36, s30, 2
  s_mul_i32 s36, s36, 6144
  v_add_u32 v14, s36, v2

  ds_read_b128 v[112:115], v14 offset:0
  ds_read_b128 v[116:119], v14 offset:1024
  ds_read_b128 v[120:123], v14 offset:2048
  ds_read_b128 v[124:127], v14 offset:3072
  ds_read_b128 v[128:131], v14 offset:4096
  ds_read_b128 v[132:135], v14 offset:5120
  s_waitcnt lgkmcnt(0)
  v_add_f32 v176, v144, v112
  v_add_f32 v177, v145, v113
  v_add_f32 v178, v146, v114
  v_add_f32 v179, v147, v115
  v_add_f32 v180, v148, v116
  v_add_f32 v181, v149, v117
  v_add_f32 v182, v150, v118
  v_add_f32 v183, v151, v119
  v_add_f32 v184, v152, v120
  v_add_f32 v185, v153, v121
  v_add_f32 v186, v154, v122
  v_add_f32 v187, v155, v123
  v_add_f32 v188, v160, v124
  v_add_f32 v189, v161, v125
  v_add_f32 v190, v162, v126
  v_add_f32 v191, v163, v127
  v_add_f32 v192, v164, v128
  v_add_f32 v193, v165, v129
  v_add_f32 v194, v166, v130
  v_add_f32 v195, v167, v131
  v_add_f32 v196, v168, v132
  v_add_f32 v197, v169, v133
  v_add_f32 v198, v170, v134
  v_add_f32 v199, v171, v135
  s_lshl_b32 s35, s31, 10
  s_add_u32 s35, s35, 148608
  v_add_u32 v13, s35, v2
  s_mul_i32 s36, s32, 6240
  v_add_u32 v13, s36, v13

  v_mov_b32 v4, v186
  v_mov_b32 v5, v186
  s_nop 1
  v_permlane32_swap_b32 v4, v5
  s_nop 1
  v_rcp_f32 v5, v4
  s_nop 0
  v_mul_f32 v5, v5, v212

  v_mul_f32 v176, v5, v176
  v_mul_f32 v177, v5, v177
  v_mul_f32 v178, v5, v178
  v_mul_f32 v179, v5, v179
  v_mul_f32 v180, v5, v180
  v_mul_f32 v181, v5, v181
  v_mul_f32 v182, v5, v182
  v_mul_f32 v183, v5, v183
  v_mul_f32 v184, v5, v184
  v_mul_f32 v185, v5, v185
  v_cvt_pk_bf16_f32 v200, v176, v177
  v_cvt_pk_bf16_f32 v201, v178, v179
  v_cvt_pk_bf16_f32 v202, v180, v181
  v_cvt_pk_bf16_f32 v203, v182, v183
  v_cvt_pk_bf16_f32 v204, v184, v185
  v_mov_b32 v205, 0
  v_cndmask_b32 v204, 0, v204, s[40:41]

  ds_write_b64 v13, v[200:201] offset:0
  ds_write_b64 v13, v[202:203] offset:8
  ds_write_b64 v13, v[204:205] offset:2080
  v_mov_b32 v4, v198
  v_mov_b32 v5, v198
  s_nop 1
  v_permlane32_swap_b32 v4, v5
  s_nop 1
  v_rcp_f32 v5, v4
  s_nop 0
  v_mul_f32 v5, v5, v212

  v_mul_f32 v188, v5, v188
  v_mul_f32 v189, v5, v189
  v_mul_f32 v190, v5, v190
  v_mul_f32 v191, v5, v191
  v_mul_f32 v192, v5, v192
  v_mul_f32 v193, v5, v193
  v_mul_f32 v194, v5, v194
  v_mul_f32 v195, v5, v195
  v_mul_f32 v196, v5, v196
  v_mul_f32 v197, v5, v197
  v_cvt_pk_bf16_f32 v200, v188, v189
  v_cvt_pk_bf16_f32 v201, v190, v191
  v_cvt_pk_bf16_f32 v202, v192, v193
  v_cvt_pk_bf16_f32 v203, v194, v195
  v_cvt_pk_bf16_f32 v204, v196, v197
  v_mov_b32 v205, 0
  v_cndmask_b32 v204, 0, v204, s[40:41]

  ds_write_b64 v13, v[200:201] offset:2088
  ds_write_b64 v13, v[202:203] offset:4160
  ds_write_b64 v13, v[204:205] offset:4168
  s_waitcnt lgkmcnt(0)
  s_mov_b64 exec, 1
  ds_add_u32 v11, v12 offset:20
  s_mov_b64 exec, -1

  s_add_u32 s30, s30, 4
  s_load_dwordx2 s[48:49], s[0:1], 88
  v_mov_b32 v18, 161088
  v_mov_b32 v19, 1
  v_lshlrev_b32 v20, 4, v1
  s_waitcnt lgkmcnt(0)

  s_mov_b32 s24, s48
  s_and_b32 s25, s49, 0xffff
  s_mov_b32 s26, 2359296
  s_mov_b32 s27, 0x00020000

  s_mul_i32 s35, s29, 9
  s_add_u32 s35, s35, s30
  s_lshl_b32 s36, s28, 3
  s_mul_i32 s36, s36, 73728
  s_lshl_b32 s37, s35, 10
  s_add_u32 s36, s36, s37
  s_add_u32 s50, s36, 1048576
  s_mul_hi_u32 s40, s35, 238609295
  s_mul_i32 s41, s40, 18
  s_sub_u32 s41, s35, s41
  s_lshl_b32 s42, s28, 6
  s_cmp_ge_u32 s41, 16
  s_cselect_b32 s52, 1, 0

  s_cbranch_scc1 RX_75
  s_lshr_b32 s44, s41, 1
  s_and_b32 s45, s44, 1
  s_lshr_b32 s44, s44, 1
  s_lshl_b32 s45, s45, 5
  s_add_u32 s42, s42, s45
  s_mul_i32 s42, s42, 1152
  s_lshl_b32 s45, s40, 8
  s_add_u32 s42, s42, s45
  s_lshl_b32 s45, s44, 6
  s_add_u32 s42, s42, s45
  s_and_b32 s45, s41, 1
  s_lshl_b32 s45, s45, 5
  s_add_u32 s51, s42, s45
  v_and_b32 v21, 31, v1
  v_mul_u32_u24 v21, 1152, v21
  v_lshrrev_b32 v16, 5, v1
  v_lshl_add_u32 v21, v16, 4, v21
  s_branch RD_76

RX_75:
  s_sub_u32 s45, s41, 16
  s_lshl_b32 s45, s45, 5
  s_add_u32 s42, s42, s45
  s_mul_i32 s42, s42, 1152
  s_lshl_b32 s45, s40, 5
  s_add_u32 s42, s42, s45
  s_add_u32 s51, s42, 1024
  v_and_b32 v21, 15, v1
  v_mul_u32_u24 v21, 1152, v21
  v_lshrrev_b32 v16, 4, v1
  v_lshl_add_u32 v21, v16, 3, v21

RD_76:
  s_mul_i32 s35, s29, 9
  s_add_u32 s35, s35, 8
  s_lshl_b32 s36, s28, 3
  s_mul_i32 s36, s36, 73728
  s_lshl_b32 s37, s35, 10
  s_add_u32 s36, s36, s37
  s_add_u32 s53, s36, 1048576
  s_mul_hi_u32 s40, s35, 238609295
  s_mul_i32 s41, s40, 18
  s_sub_u32 s41, s35, s41
  s_lshl_b32 s42, s28, 6
  s_cmp_ge_u32 s41, 16
  s_cselect_b32 s55, 1, 0

  s_cbranch_scc1 RX_77
  s_lshr_b32 s44, s41, 1
  s_and_b32 s45, s44, 1
  s_lshr_b32 s44, s44, 1
  s_lshl_b32 s45, s45, 5
  s_add_u32 s42, s42, s45
  s_mul_i32 s42, s42, 1152
  s_lshl_b32 s45, s40, 8
  s_add_u32 s42, s42, s45
  s_lshl_b32 s45, s44, 6
  s_add_u32 s42, s42, s45
  s_and_b32 s45, s41, 1
  s_lshl_b32 s45, s45, 5
  s_add_u32 s54, s42, s45
  v_and_b32 v22, 31, v1
  v_mul_u32_u24 v22, 1152, v22
  v_lshrrev_b32 v16, 5, v1
  v_lshl_add_u32 v22, v16, 4, v22
  s_branch RD_78

RX_77:
  s_sub_u32 s45, s41, 16
  s_lshl_b32 s45, s45, 5
  s_add_u32 s42, s42, s45
  s_mul_i32 s42, s42, 1152
  s_lshl_b32 s45, s40, 5
  s_add_u32 s42, s42, s45
  s_add_u32 s54, s42, 1024
  v_and_b32 v22, 15, v1
  v_mul_u32_u24 v22, 1152, v22
  v_lshrrev_b32 v16, 4, v1
  v_lshl_add_u32 v22, v16, 3, v22

RD_78:
  s_cmp_lg_u32 s30, 7
  s_cbranch_scc1 XFW_81
  s_lshl_b32 s35, s28, 7
  s_add_u32 s35, s35, 270336
  v_and_b32 v16, 7, v1
  v_lshlrev_b32 v16, 2, v16
  s_mov_b32 s39, 0x10000

XFP_79:
  buffer_load_dword v17, v16, s[20:23], s35 offen sc1
  s_waitcnt vmcnt(0)
  v_cmp_ne_u32 vcc, s47, v17
  s_nop 1
  s_cmp_eq_u64 vcc, 0
  s_cbranch_scc1 XFD_80
  s_sleep 1
  s_sub_u32 s39, s39, 1
  s_cmp_lg_u32 s39, 0
  s_cbranch_scc1 XFP_79

XFD_80:
  s_mov_b64 exec, 1
  ds_add_u32 v18, v19 offset:60
  s_mov_b64 exec, -1

XFW_81:
  s_mov_b32 s39, 0x40000
WAITC_82:
  ds_read_b32 v16, v18 offset:60
  s_waitcnt lgkmcnt(0)
  v_readfirstlane_b32 s38, v16
  s_cmp_ge_u32 s38, 1
  s_cbranch_scc1 WAITD_83
  s_sleep 1
  s_sub_u32 s39, s39, 1
  s_cmp_lg_u32 s39, 0
  s_cbranch_scc1 WAITC_82

WAITD_83:
  s_mov_b32 s56, s20
  s_mov_b32 s57, s21
  s_mov_b32 s59, 0x00020000
  s_cmp_eq_u32 s29, 0
  s_cselect_b32 s58, 0, 0x10000000
  buffer_load_dwordx4 v[24:27], v20, s[56:59], s50 offen sc1
  s_add_u32 s50, s50, 73728
  s_cmp_eq_u32 s29, 1
  s_cselect_b32 s58, 0, 0x10000000
  buffer_load_dwordx4 v[28:31], v20, s[56:59], s50 offen sc1
  s_add_u32 s50, s50, 73728
  s_cmp_eq_u32 s29, 2
  s_cselect_b32 s58, 0, 0x10000000
  buffer_load_dwordx4 v[32:35], v20, s[56:59], s50 offen sc1
  s_add_u32 s50, s50, 73728
  s_cmp_eq_u32 s29, 3
  s_cselect_b32 s58, 0, 0x10000000
  buffer_load_dwordx4 v[36:39], v20, s[56:59], s50 offen sc1
  s_add_u32 s50, s50, 73728
  s_cmp_eq_u32 s29, 4
  s_cselect_b32 s58, 0, 0x10000000
  buffer_load_dwordx4 v[40:43], v20, s[56:59], s50 offen sc1
  s_add_u32 s50, s50, 73728
  s_cmp_eq_u32 s29, 5
  s_cselect_b32 s58, 0, 0x10000000
  buffer_load_dwordx4 v[44:47], v20, s[56:59], s50 offen sc1
  s_add_u32 s50, s50, 73728
  s_cmp_eq_u32 s29, 6
  s_cselect_b32 s58, 0, 0x10000000
  buffer_load_dwordx4 v[48:51], v20, s[56:59], s50 offen sc1
  s_add_u32 s50, s50, 73728
  s_cmp_eq_u32 s29, 7
  s_cselect_b32 s58, 0, 0x10000000
  buffer_load_dwordx4 v[52:55], v20, s[56:59], s50 offen sc1
  s_lshl_b32 s35, s30, 10
  s_add_u32 s35, s35, 0
  v_add_u32 v116, s35, v20
  ds_read_b128 v[116:119], v116
  s_cmp_eq_u32 s30, 4
  s_cbranch_scc1 R2_85
  s_waitcnt vmcnt(7)
  v_lshlrev_b32 v96, 16, v24
  v_and_b32 v97, 0xffff0000, v24
  v_lshlrev_b32 v98, 16, v25
  v_and_b32 v99, 0xffff0000, v25
  v_lshlrev_b32 v100, 16, v26
  v_and_b32 v101, 0xffff0000, v26
  v_lshlrev_b32 v102, 16, v27
  v_and_b32 v103, 0xffff0000, v27
  s_waitcnt vmcnt(6)
  v_lshlrev_b32 v104, 16, v28
  v_and_b32 v105, 0xffff0000, v28
  v_lshlrev_b32 v106, 16, v29
  v_and_b32 v107, 0xffff0000, v29
  v_lshlrev_b32 v108, 16, v30
  v_and_b32 v109, 0xffff0000, v30
  v_lshlrev_b32 v110, 16, v31
  v_and_b32 v111, 0xffff0000, v31
  v_pk_add_f32 v[96:97], v[96:97], v[104:105]
  v_pk_add_f32 v[98:99], v[98:99], v[106:107]
  v_pk_add_f32 v[100:101], v[100:101], v[108:109]
  v_pk_add_f32 v[102:103], v[102:103], v[110:111]
  s_waitcnt vmcnt(5)
  v_lshlrev_b32 v104, 16, v32
  v_and_b32 v105, 0xffff0000, v32
  v_lshlrev_b32 v106, 16, v33
  v_and_b32 v107, 0xffff0000, v33
  v_lshlrev_b32 v108, 16, v34
  v_and_b32 v109, 0xffff0000, v34
  v_lshlrev_b32 v110, 16, v35
  v_and_b32 v111, 0xffff0000, v35
  v_pk_add_f32 v[96:97], v[96:97], v[104:105]
  v_pk_add_f32 v[98:99], v[98:99], v[106:107]
  v_pk_add_f32 v[100:101], v[100:101], v[108:109]
  v_pk_add_f32 v[102:103], v[102:103], v[110:111]
  s_waitcnt vmcnt(4)
  v_lshlrev_b32 v104, 16, v36
  v_and_b32 v105, 0xffff0000, v36
  v_lshlrev_b32 v106, 16, v37
  v_and_b32 v107, 0xffff0000, v37
  v_lshlrev_b32 v108, 16, v38
  v_and_b32 v109, 0xffff0000, v38
  v_lshlrev_b32 v110, 16, v39
  v_and_b32 v111, 0xffff0000, v39
  v_pk_add_f32 v[96:97], v[96:97], v[104:105]
  v_pk_add_f32 v[98:99], v[98:99], v[106:107]
  v_pk_add_f32 v[100:101], v[100:101], v[108:109]
  v_pk_add_f32 v[102:103], v[102:103], v[110:111]
  s_waitcnt vmcnt(3)
  v_lshlrev_b32 v104, 16, v40
  v_and_b32 v105, 0xffff0000, v40
  v_lshlrev_b32 v106, 16, v41
  v_and_b32 v107, 0xffff0000, v41
  v_lshlrev_b32 v108, 16, v42
  v_and_b32 v109, 0xffff0000, v42
  v_lshlrev_b32 v110, 16, v43
  v_and_b32 v111, 0xffff0000, v43
  v_pk_add_f32 v[96:97], v[96:97], v[104:105]
  v_pk_add_f32 v[98:99], v[98:99], v[106:107]
  v_pk_add_f32 v[100:101], v[100:101], v[108:109]
  v_pk_add_f32 v[102:103], v[102:103], v[110:111]
  s_waitcnt vmcnt(2)
  v_lshlrev_b32 v104, 16, v44
  v_and_b32 v105, 0xffff0000, v44
  v_lshlrev_b32 v106, 16, v45
  v_and_b32 v107, 0xffff0000, v45
  v_lshlrev_b32 v108, 16, v46
  v_and_b32 v109, 0xffff0000, v46
  v_lshlrev_b32 v110, 16, v47
  v_and_b32 v111, 0xffff0000, v47
  v_pk_add_f32 v[96:97], v[96:97], v[104:105]
  v_pk_add_f32 v[98:99], v[98:99], v[106:107]
  v_pk_add_f32 v[100:101], v[100:101], v[108:109]
  v_pk_add_f32 v[102:103], v[102:103], v[110:111]
  s_waitcnt vmcnt(1)
  v_lshlrev_b32 v104, 16, v48
  v_and_b32 v105, 0xffff0000, v48
  v_lshlrev_b32 v106, 16, v49
  v_and_b32 v107, 0xffff0000, v49
  v_lshlrev_b32 v108, 16, v50
  v_and_b32 v109, 0xffff0000, v50
  v_lshlrev_b32 v110, 16, v51
  v_and_b32 v111, 0xffff0000, v51
  v_pk_add_f32 v[96:97], v[96:97], v[104:105]
  v_pk_add_f32 v[98:99], v[98:99], v[106:107]
  v_pk_add_f32 v[100:101], v[100:101], v[108:109]
  v_pk_add_f32 v[102:103], v[102:103], v[110:111]
  s_waitcnt vmcnt(0)
  v_lshlrev_b32 v104, 16, v52
  v_and_b32 v105, 0xffff0000, v52
  v_lshlrev_b32 v106, 16, v53
  v_and_b32 v107, 0xffff0000, v53
  v_lshlrev_b32 v108, 16, v54
  v_and_b32 v109, 0xffff0000, v54
  v_lshlrev_b32 v110, 16, v55
  v_and_b32 v111, 0xffff0000, v55
  v_pk_add_f32 v[96:97], v[96:97], v[104:105]
  v_pk_add_f32 v[98:99], v[98:99], v[106:107]
  v_pk_add_f32 v[100:101], v[100:101], v[108:109]
  v_pk_add_f32 v[102:103], v[102:103], v[110:111]
  s_waitcnt lgkmcnt(0)
  v_lshlrev_b32 v104, 16, v116
  v_and_b32 v105, 0xffff0000, v116
  v_lshlrev_b32 v106, 16, v117
  v_and_b32 v107, 0xffff0000, v117
  v_lshlrev_b32 v108, 16, v118
  v_and_b32 v109, 0xffff0000, v118
  v_lshlrev_b32 v110, 16, v119
  v_and_b32 v111, 0xffff0000, v119
  v_pk_add_f32 v[96:97], v[96:97], v[104:105]
  v_pk_add_f32 v[98:99], v[98:99], v[106:107]
  v_pk_add_f32 v[100:101], v[100:101], v[108:109]
  v_pk_add_f32 v[102:103], v[102:103], v[110:111]
  v_cvt_pk_bf16_f32 v104, v96, v97
  v_cvt_pk_bf16_f32 v105, v98, v99
  v_cvt_pk_bf16_f32 v106, v100, v101
  v_cvt_pk_bf16_f32 v107, v102, v103
  s_cmp_eq_u32 s52, 1
  s_cbranch_scc1 RX_86
  s_nop 0
  v_permlane32_swap_b32 v104, v106
  v_permlane32_swap_b32 v105, v107
  s_nop 1
  buffer_store_dwordx4 v[104:107], v21, s[24:27], s51 offen
  s_branch RD_87

RX_86:
  s_add_u32 s45, s51, 18432
  buffer_store_dwordx2 v[104:105], v21, s[24:27], s51 offen
  buffer_store_dwordx2 v[106:107], v21, s[24:27], s45 offen

RD_87:
  s_branch RE_84
R2_85:
  s_mov_b32 s56, s20
  s_mov_b32 s57, s21
  s_mov_b32 s59, 0x00020000
  s_cmp_eq_u32 s29, 0
  s_cselect_b32 s58, 0, 0x10000000
  buffer_load_dwordx4 v[56:59], v20, s[56:59], s53 offen sc1
  s_add_u32 s53, s53, 73728
  s_cmp_eq_u32 s29, 1
  s_cselect_b32 s58, 0, 0x10000000
  buffer_load_dwordx4 v[60:63], v20, s[56:59], s53 offen sc1
  s_add_u32 s53, s53, 73728
  s_cmp_eq_u32 s29, 2
  s_cselect_b32 s58, 0, 0x10000000
  buffer_load_dwordx4 v[64:67], v20, s[56:59], s53 offen sc1
  s_add_u32 s53, s53, 73728
  s_cmp_eq_u32 s29, 3
  s_cselect_b32 s58, 0, 0x10000000
  buffer_load_dwordx4 v[68:71], v20, s[56:59], s53 offen sc1
  s_add_u32 s53, s53, 73728
  s_cmp_eq_u32 s29, 4
  s_cselect_b32 s58, 0, 0x10000000
  buffer_load_dwordx4 v[72:75], v20, s[56:59], s53 offen sc1
  s_add_u32 s53, s53, 73728
  s_cmp_eq_u32 s29, 5
  s_cselect_b32 s58, 0, 0x10000000
  buffer_load_dwordx4 v[76:79], v20, s[56:59], s53 offen sc1
  s_add_u32 s53, s53, 73728
  s_cmp_eq_u32 s29, 6
  s_cselect_b32 s58, 0, 0x10000000
  buffer_load_dwordx4 v[80:83], v20, s[56:59], s53 offen sc1
  s_add_u32 s53, s53, 73728
  s_cmp_eq_u32 s29, 7
  s_cselect_b32 s58, 0, 0x10000000
  buffer_load_dwordx4 v[84:87], v20, s[56:59], s53 offen sc1
  s_lshl_b32 s35, 8, 10
  s_add_u32 s35, s35, 0
  v_add_u32 v120, s35, v20
  ds_read_b128 v[120:123], v120
  s_waitcnt vmcnt(15)
  v_lshlrev_b32 v96, 16, v24
  v_and_b32 v97, 0xffff0000, v24
  v_lshlrev_b32 v98, 16, v25
  v_and_b32 v99, 0xffff0000, v25
  v_lshlrev_b32 v100, 16, v26
  v_and_b32 v101, 0xffff0000, v26
  v_lshlrev_b32 v102, 16, v27
  v_and_b32 v103, 0xffff0000, v27
  s_waitcnt vmcnt(14)
  v_lshlrev_b32 v104, 16, v28
  v_and_b32 v105, 0xffff0000, v28
  v_lshlrev_b32 v106, 16, v29
  v_and_b32 v107, 0xffff0000, v29
  v_lshlrev_b32 v108, 16, v30
  v_and_b32 v109, 0xffff0000, v30
  v_lshlrev_b32 v110, 16, v31
  v_and_b32 v111, 0xffff0000, v31
  v_pk_add_f32 v[96:97], v[96:97], v[104:105]
  v_pk_add_f32 v[98:99], v[98:99], v[106:107]
  v_pk_add_f32 v[100:101], v[100:101], v[108:109]
  v_pk_add_f32 v[102:103], v[102:103], v[110:111]
  s_waitcnt vmcnt(13)
  v_lshlrev_b32 v104, 16, v32
  v_and_b32 v105, 0xffff0000, v32
  v_lshlrev_b32 v106, 16, v33
  v_and_b32 v107, 0xffff0000, v33
  v_lshlrev_b32 v108, 16, v34
  v_and_b32 v109, 0xffff0000, v34
  v_lshlrev_b32 v110, 16, v35
  v_and_b32 v111, 0xffff0000, v35
  v_pk_add_f32 v[96:97], v[96:97], v[104:105]
  v_pk_add_f32 v[98:99], v[98:99], v[106:107]
  v_pk_add_f32 v[100:101], v[100:101], v[108:109]
  v_pk_add_f32 v[102:103], v[102:103], v[110:111]
  s_waitcnt vmcnt(12)
  v_lshlrev_b32 v104, 16, v36
  v_and_b32 v105, 0xffff0000, v36
  v_lshlrev_b32 v106, 16, v37
  v_and_b32 v107, 0xffff0000, v37
  v_lshlrev_b32 v108, 16, v38
  v_and_b32 v109, 0xffff0000, v38
  v_lshlrev_b32 v110, 16, v39
  v_and_b32 v111, 0xffff0000, v39
  v_pk_add_f32 v[96:97], v[96:97], v[104:105]
  v_pk_add_f32 v[98:99], v[98:99], v[106:107]
  v_pk_add_f32 v[100:101], v[100:101], v[108:109]
  v_pk_add_f32 v[102:103], v[102:103], v[110:111]
  s_waitcnt vmcnt(11)
  v_lshlrev_b32 v104, 16, v40
  v_and_b32 v105, 0xffff0000, v40
  v_lshlrev_b32 v106, 16, v41
  v_and_b32 v107, 0xffff0000, v41
  v_lshlrev_b32 v108, 16, v42
  v_and_b32 v109, 0xffff0000, v42
  v_lshlrev_b32 v110, 16, v43
  v_and_b32 v111, 0xffff0000, v43
  v_pk_add_f32 v[96:97], v[96:97], v[104:105]
  v_pk_add_f32 v[98:99], v[98:99], v[106:107]
  v_pk_add_f32 v[100:101], v[100:101], v[108:109]
  v_pk_add_f32 v[102:103], v[102:103], v[110:111]
  s_waitcnt vmcnt(10)
  v_lshlrev_b32 v104, 16, v44
  v_and_b32 v105, 0xffff0000, v44
  v_lshlrev_b32 v106, 16, v45
  v_and_b32 v107, 0xffff0000, v45
  v_lshlrev_b32 v108, 16, v46
  v_and_b32 v109, 0xffff0000, v46
  v_lshlrev_b32 v110, 16, v47
  v_and_b32 v111, 0xffff0000, v47
  v_pk_add_f32 v[96:97], v[96:97], v[104:105]
  v_pk_add_f32 v[98:99], v[98:99], v[106:107]
  v_pk_add_f32 v[100:101], v[100:101], v[108:109]
  v_pk_add_f32 v[102:103], v[102:103], v[110:111]
  s_waitcnt vmcnt(9)
  v_lshlrev_b32 v104, 16, v48
  v_and_b32 v105, 0xffff0000, v48
  v_lshlrev_b32 v106, 16, v49
  v_and_b32 v107, 0xffff0000, v49
  v_lshlrev_b32 v108, 16, v50
  v_and_b32 v109, 0xffff0000, v50
  v_lshlrev_b32 v110, 16, v51
  v_and_b32 v111, 0xffff0000, v51
  v_pk_add_f32 v[96:97], v[96:97], v[104:105]
  v_pk_add_f32 v[98:99], v[98:99], v[106:107]
  v_pk_add_f32 v[100:101], v[100:101], v[108:109]
  v_pk_add_f32 v[102:103], v[102:103], v[110:111]
  s_waitcnt vmcnt(8)
  v_lshlrev_b32 v104, 16, v52
  v_and_b32 v105, 0xffff0000, v52
  v_lshlrev_b32 v106, 16, v53
  v_and_b32 v107, 0xffff0000, v53
  v_lshlrev_b32 v108, 16, v54
  v_and_b32 v109, 0xffff0000, v54
  v_lshlrev_b32 v110, 16, v55
  v_and_b32 v111, 0xffff0000, v55
  v_pk_add_f32 v[96:97], v[96:97], v[104:105]
  v_pk_add_f32 v[98:99], v[98:99], v[106:107]
  v_pk_add_f32 v[100:101], v[100:101], v[108:109]
  v_pk_add_f32 v[102:103], v[102:103], v[110:111]
  s_waitcnt lgkmcnt(0)
  v_lshlrev_b32 v104, 16, v116
  v_and_b32 v105, 0xffff0000, v116
  v_lshlrev_b32 v106, 16, v117
  v_and_b32 v107, 0xffff0000, v117
  v_lshlrev_b32 v108, 16, v118
  v_and_b32 v109, 0xffff0000, v118
  v_lshlrev_b32 v110, 16, v119
  v_and_b32 v111, 0xffff0000, v119
  v_pk_add_f32 v[96:97], v[96:97], v[104:105]
  v_pk_add_f32 v[98:99], v[98:99], v[106:107]
  v_pk_add_f32 v[100:101], v[100:101], v[108:109]
  v_pk_add_f32 v[102:103], v[102:103], v[110:111]
  v_cvt_pk_bf16_f32 v104, v96, v97
  v_cvt_pk_bf16_f32 v105, v98, v99
  v_cvt_pk_bf16_f32 v106, v100, v101
  v_cvt_pk_bf16_f32 v107, v102, v103
  s_cmp_eq_u32 s52, 1
  s_cbranch_scc1 RX_88
  s_nop 0
  v_permlane32_swap_b32 v104, v106
  v_permlane32_swap_b32 v105, v107
  s_nop 1
  buffer_store_dwordx4 v[104:107], v21, s[24:27], s51 offen
  s_branch RD_89

RX_88:
  s_add_u32 s45, s51, 18432
  buffer_store_dwordx2 v[104:105], v21, s[24:27], s51 offen
  buffer_store_dwordx2 v[106:107], v21, s[24:27], s45 offen

RD_89:
  s_waitcnt vmcnt(8)
  v_lshlrev_b32 v96, 16, v56
  v_and_b32 v97, 0xffff0000, v56
  v_lshlrev_b32 v98, 16, v57
  v_and_b32 v99, 0xffff0000, v57
  v_lshlrev_b32 v100, 16, v58
  v_and_b32 v101, 0xffff0000, v58
  v_lshlrev_b32 v102, 16, v59
  v_and_b32 v103, 0xffff0000, v59
  s_waitcnt vmcnt(7)
  v_lshlrev_b32 v104, 16, v60
  v_and_b32 v105, 0xffff0000, v60
  v_lshlrev_b32 v106, 16, v61
  v_and_b32 v107, 0xffff0000, v61
  v_lshlrev_b32 v108, 16, v62
  v_and_b32 v109, 0xffff0000, v62
  v_lshlrev_b32 v110, 16, v63
  v_and_b32 v111, 0xffff0000, v63
  v_pk_add_f32 v[96:97], v[96:97], v[104:105]
  v_pk_add_f32 v[98:99], v[98:99], v[106:107]
  v_pk_add_f32 v[100:101], v[100:101], v[108:109]
  v_pk_add_f32 v[102:103], v[102:103], v[110:111]
  s_waitcnt vmcnt(6)
  v_lshlrev_b32 v104, 16, v64
  v_and_b32 v105, 0xffff0000, v64
  v_lshlrev_b32 v106, 16, v65
  v_and_b32 v107, 0xffff0000, v65
  v_lshlrev_b32 v108, 16, v66
  v_and_b32 v109, 0xffff0000, v66
  v_lshlrev_b32 v110, 16, v67
  v_and_b32 v111, 0xffff0000, v67
  v_pk_add_f32 v[96:97], v[96:97], v[104:105]
  v_pk_add_f32 v[98:99], v[98:99], v[106:107]
  v_pk_add_f32 v[100:101], v[100:101], v[108:109]
  v_pk_add_f32 v[102:103], v[102:103], v[110:111]
  s_waitcnt vmcnt(5)
  v_lshlrev_b32 v104, 16, v68
  v_and_b32 v105, 0xffff0000, v68
  v_lshlrev_b32 v106, 16, v69
  v_and_b32 v107, 0xffff0000, v69
  v_lshlrev_b32 v108, 16, v70
  v_and_b32 v109, 0xffff0000, v70
  v_lshlrev_b32 v110, 16, v71
  v_and_b32 v111, 0xffff0000, v71
  v_pk_add_f32 v[96:97], v[96:97], v[104:105]
  v_pk_add_f32 v[98:99], v[98:99], v[106:107]
  v_pk_add_f32 v[100:101], v[100:101], v[108:109]
  v_pk_add_f32 v[102:103], v[102:103], v[110:111]
  s_waitcnt vmcnt(4)
  v_lshlrev_b32 v104, 16, v72
  v_and_b32 v105, 0xffff0000, v72
  v_lshlrev_b32 v106, 16, v73
  v_and_b32 v107, 0xffff0000, v73
  v_lshlrev_b32 v108, 16, v74
  v_and_b32 v109, 0xffff0000, v74
  v_lshlrev_b32 v110, 16, v75
  v_and_b32 v111, 0xffff0000, v75
  v_pk_add_f32 v[96:97], v[96:97], v[104:105]
  v_pk_add_f32 v[98:99], v[98:99], v[106:107]
  v_pk_add_f32 v[100:101], v[100:101], v[108:109]
  v_pk_add_f32 v[102:103], v[102:103], v[110:111]
  s_waitcnt vmcnt(3)
  v_lshlrev_b32 v104, 16, v76
  v_and_b32 v105, 0xffff0000, v76
  v_lshlrev_b32 v106, 16, v77
  v_and_b32 v107, 0xffff0000, v77
  v_lshlrev_b32 v108, 16, v78
  v_and_b32 v109, 0xffff0000, v78
  v_lshlrev_b32 v110, 16, v79
  v_and_b32 v111, 0xffff0000, v79
  v_pk_add_f32 v[96:97], v[96:97], v[104:105]
  v_pk_add_f32 v[98:99], v[98:99], v[106:107]
  v_pk_add_f32 v[100:101], v[100:101], v[108:109]
  v_pk_add_f32 v[102:103], v[102:103], v[110:111]
  s_waitcnt vmcnt(2)
  v_lshlrev_b32 v104, 16, v80
  v_and_b32 v105, 0xffff0000, v80
  v_lshlrev_b32 v106, 16, v81
  v_and_b32 v107, 0xffff0000, v81
  v_lshlrev_b32 v108, 16, v82
  v_and_b32 v109, 0xffff0000, v82
  v_lshlrev_b32 v110, 16, v83
  v_and_b32 v111, 0xffff0000, v83
  v_pk_add_f32 v[96:97], v[96:97], v[104:105]
  v_pk_add_f32 v[98:99], v[98:99], v[106:107]
  v_pk_add_f32 v[100:101], v[100:101], v[108:109]
  v_pk_add_f32 v[102:103], v[102:103], v[110:111]
  s_waitcnt vmcnt(1)
  v_lshlrev_b32 v104, 16, v84
  v_and_b32 v105, 0xffff0000, v84
  v_lshlrev_b32 v106, 16, v85
  v_and_b32 v107, 0xffff0000, v85
  v_lshlrev_b32 v108, 16, v86
  v_and_b32 v109, 0xffff0000, v86
  v_lshlrev_b32 v110, 16, v87
  v_and_b32 v111, 0xffff0000, v87
  v_pk_add_f32 v[96:97], v[96:97], v[104:105]
  v_pk_add_f32 v[98:99], v[98:99], v[106:107]
  v_pk_add_f32 v[100:101], v[100:101], v[108:109]
  v_pk_add_f32 v[102:103], v[102:103], v[110:111]
  s_waitcnt lgkmcnt(0)
  v_lshlrev_b32 v104, 16, v120
  v_and_b32 v105, 0xffff0000, v120
  v_lshlrev_b32 v106, 16, v121
  v_and_b32 v107, 0xffff0000, v121
  v_lshlrev_b32 v108, 16, v122
  v_and_b32 v109, 0xffff0000, v122
  v_lshlrev_b32 v110, 16, v123
  v_and_b32 v111, 0xffff0000, v123
  v_pk_add_f32 v[96:97], v[96:97], v[104:105]
  v_pk_add_f32 v[98:99], v[98:99], v[106:107]
  v_pk_add_f32 v[100:101], v[100:101], v[108:109]
  v_pk_add_f32 v[102:103], v[102:103], v[110:111]
  v_cvt_pk_bf16_f32 v104, v96, v97
  v_cvt_pk_bf16_f32 v105, v98, v99
  v_cvt_pk_bf16_f32 v106, v100, v101
  v_cvt_pk_bf16_f32 v107, v102, v103
  s_cmp_eq_u32 s55, 1
  s_cbranch_scc1 RX_90
  s_nop 0
  v_permlane32_swap_b32 v104, v106
  v_permlane32_swap_b32 v105, v107
  s_nop 1
  buffer_store_dwordx4 v[104:107], v22, s[24:27], s54 offen
  s_branch RD_91

RX_90:
  s_add_u32 s45, s54, 18432
  buffer_store_dwordx2 v[104:105], v22, s[24:27], s54 offen
  buffer_store_dwordx2 v[106:107], v22, s[24:27], s45 offen

RD_91:
RE_84:
K_END:
K_LAST:
  s_endpgm
.section .rodata,"a"
.p2align 6
.amdhsa_kernel gated_mix__grouped_kv_mqa__mixer_channel_mlp__prompt_kernel
  .amdhsa_next_free_vgpr 256
  .amdhsa_next_free_sgpr 102
  .amdhsa_accum_offset 256
  .amdhsa_group_segment_fixed_size 0
  .amdhsa_kernarg_size 112
  .amdhsa_user_sgpr_count 2
  .amdhsa_user_sgpr_kernarg_segment_ptr 1
  .amdhsa_system_sgpr_workgroup_id_x 1
.end_amdhsa_kernel
```
